```python
import torch

def _softmax(x, axis=-1):
    return torch.softmax(x, dim=axis)
def _gelu(x):
    return torch.nn.functional.gelu(x, approximate="tanh")
def _silu(x):
    return torch.nn.functional.silu(x)
def _sigmoid(x):
    return torch.sigmoid(x)
def _layernorm(x, axis=-1, eps=1e-5):
    m = x.mean(dim=axis, keepdim=True)
    v = x.var(dim=axis, keepdim=True, unbiased=False)
    return (x - m) / torch.sqrt(v + eps)
def _scatter_add(tgt, idx, src, axis=0):
    return tgt.clone().index_add_(axis, idx, src)
def _segment_sum(src, seg, n):
    out = torch.zeros((n,) + src.shape[1:], dtype=src.dtype)
    return out.index_add_(0, seg, src)
def _pad(x, pw):
    flat = tuple(v for pair in reversed(pw) for v in pair)
    return torch.nn.functional.pad(x, flat)

kernel_name = 'recurrent_scan__linear_attn_block__dense_activation_silu__prompt'

def setup_inputs():

    _w = (lambda a: (lambda t: t.to(torch.bfloat16) if t.is_floating_point() else t)(torch.as_tensor(a)))
    def _A_setup():
        B, S, D = 1, 2048, 640
        return {
            "x": _w((lambda *s: torch.randn(*s, dtype=torch.bfloat16) * 0.05)(B, S, D)),
            "wqkv": _w((lambda *s: torch.randn(*s, dtype=torch.bfloat16) * 0.2)(D, 3 * D)),
            "wo": _w((lambda *s: torch.randn(*s, dtype=torch.bfloat16) * 0.2)(D, D)),
        }
    _A_in = _A_setup()

    def _B_setup():
        B, S, D, F = 1, 2048, 640, 1728
        return {
            "x": _w((lambda *s: torch.randn(*s, dtype=torch.bfloat16) * 0.05)(B, S, D)),
            "w1": _w((lambda *s: torch.randn(*s, dtype=torch.bfloat16) * 0.8)(D, F) * (D ** -0.5)),
            "w2": _w((lambda *s: torch.randn(*s, dtype=torch.bfloat16) * 0.1)(F, D) * (F ** -0.5)),
        }
    _B_in = _B_setup()

    return {
        "A_x": _A_in["x"],
        "A_wqkv": _A_in["wqkv"],
        "A_wo": _A_in["wo"],
        "B_x": _B_in["x"],
        "B_w1": _B_in["w1"],
        "B_w2": _B_in["w2"],
    }

def reference(A_x, A_wqkv, A_wo, B_x, B_w1, B_w2):
    def _A_ref(x, wqkv, wo):
        B, S, D = x.shape
        H = 32; Dh = D // H
        qkv = (lambda x, *d: x.permute(*d))((x @ wqkv).reshape(B, S, 3, H, Dh), 2, 0, 3, 1, 4)
        q, k, v = qkv[0], qkv[1], qkv[2]
        phi = lambda t: torch.where(t > 0, t + 1, torch.exp(t)) + 1e-6
        pq, pk = phi(q), phi(k)
        kv = torch.einsum("bhsd,bhse->bhde", pk, v)
        z = torch.einsum("bhsd->bhd", pk)
        num = torch.einsum("bhqd,bhde->bhqe", pq, kv)
        den = torch.einsum("bhqd,bhd->bhq", pq, z)[..., None] + 1e-6
        o = num / den
        return (lambda x, *d: x.permute(*d))(o, 0, 2, 1, 3).reshape(B, S, D) @ wo

    def _B_ref(x, w1, w2):
        h = torch.einsum("bsd,df->bsf", x, w1)
        h = _silu(h)
        out = torch.einsum("bsf,fd->bsd", h, w2)
        return out

    x = A_x
    xn = _layernorm(x, axis=-1)
    s = _A_ref(xn, A_wqkv, A_wo)
    g = _silu(_B_ref(xn, B_w1, B_w2))
    return x + s * g
```

```asm
; @launch grid=(256,1,1) block=(512,1,1) lds=163840
.amdgcn_target "amdgcn-amd-amdhsa--gfx950"
.text
.p2align 12
.fill 832, 4, 0xbf810000
.globl recurrent_scan__linear_attn_block__dense_activation_silu__prompt_kernel
.p2align 8
.type recurrent_scan__linear_attn_block__dense_activation_silu__prompt_kernel,@function
recurrent_scan__linear_attn_block__dense_activation_silu__prompt_kernel:
    s_cmp_ge_u32 s2, 256
    s_cbranch_scc1 L_end
    s_getpc_b64 s[80:81]
L_pc:
    s_load_dwordx16 s[4:19], s[0:1], 0
    s_load_dwordx2 s[20:21], s[0:1], 64
    s_lshr_b32 s73, s2, 3
    v_lshrrev_b32 v1, 4, v0
    v_lshl_add_u32 v1, s73, 5, v1
    v_lshlrev_b32 v1, 7, v1
    v_min_u32 v1, L_end-L_pc, v1
    v_mov_b32 v3, s81
    v_add_co_u32 v2, vcc, s80, v1
    s_nop 1
    v_addc_co_u32 v3, vcc, 0, v3, vcc
    global_load_dword v255, v[2:3], off
    v_lshrrev_b32 v1, 6, v0
    v_and_b32 v0, 63, v0
    v_readfirstlane_b32 s56, v1
    s_lshr_b32 s73, s2, 3
    s_and_b32 s74, s2, 3
    s_and_b32 s75, s73, 3
    s_bfe_u32 s76, s2, 0x10002
    s_mul_i32 s62, s76, 7
    s_lshr_b32 s76, s2, 5
    s_add_u32 s62, s62, s76
    s_sub_u32 s62, s62, 1
    s_cmp_lt_u32 s75, 2
    s_cselect_b32 s57, 1, 0
    s_and_b32 s76, s75, 1
    s_lshl1_add_u32 s59, s74, s76
    s_lshl2_add_u32 s76, s74, s75
    s_cmp_eq_u32 s62, 13
    s_cselect_b32 s57, 0, s57
    s_cselect_b32 s59, 8, s59
    s_cselect_b32 s62, s76, s62
    s_and_b32 s76, s2, 4
    s_add_u32 s76, s76, s73
    s_cmp_lt_u32 s73, 4
    s_cselect_b32 s57, 2, s57
    s_cselect_b32 s59, s74, s59
    s_cselect_b32 s62, s76, s62
    s_cselect_b32 s76, 8, 5
    s_mul_i32 s58, s62, s76
    s_lshl_b32 s58, s58, 5
    s_cmp_lt_u32 s56, 4
    s_cbranch_scc1 L_cons
    s_cmp_ge_u32 s62, 13
    s_cbranch_scc1 L_svcl
    s_sub_u32 s72, s56, 4
    s_mul_i32 s73, s72, s76
    v_lshrrev_b32 v1, 3, v0
    v_and_b32 v2, 7, v0
    s_lshl_b32 s77, s73, 10
    s_lshl3_add_u32 s74, s73, s58
    s_mul_i32 s74, s74, 1280
    s_and_b32 s73, s73, 1
    s_lshl_b32 s73, s73, 2
    v_lshrrev_b32 v3, 4, v0
    v_xor_b32 v3, v3, v2
    v_xor_b32 v3, s73, v3
    v_mul_u32_u24 v8, 1280, v1
    v_lshl_add_u32 v8, v3, 4, v8
    v_add_u32 v8, s74, v8
    v_xor_b32 v9, 64, v8
    v_add_u32 v9, 10240, v9
    v_add_u32 v10, 20480, v8
    v_add_u32 v11, 20480, v9
    v_add_u32 v12, 20480, v10
    s_mov_b32 s26, 2621440
    s_mov_b32 s27, 0x20000
    s_mov_b32 m0, s77
    s_waitcnt lgkmcnt(0)
    s_mov_b32 s24, s4
    s_mov_b32 s25, s5
    buffer_load_dwordx4 v8, s[24:27], 0 offen lds
    s_add_u32 m0, s77, 1024
    s_nop 0
    buffer_load_dwordx4 v9, s[24:27], 0 offen lds
    s_add_u32 m0, s77, 2048
    s_nop 0
    buffer_load_dwordx4 v10, s[24:27], 0 offen lds
    s_add_u32 m0, s77, 3072
    s_nop 0
    buffer_load_dwordx4 v11, s[24:27], 0 offen lds
    s_add_u32 m0, s77, 4096
    s_nop 0
    buffer_load_dwordx4 v12, s[24:27], 0 offen lds
    s_cmp_eq_u32 s57, 1
    s_cbranch_scc1 L_lK
    s_cmp_eq_u32 s57, 2
    s_cbranch_scc1 L_lQ
    s_branch L_lH
L_cons:
    s_and_b32 s72, s2, 7
    s_lshl_b32 s68, s72, 8
    s_and_b32 s72, s2, 0xf8
    s_add_u32 s68, s68, s72
    v_and_b32 v200, 31, v0
    v_lshrrev_b32 v201, 5, v0
    s_lshl1_add_u32 s72, s56, s68
    s_mul_i32 s72, s72, 1280
    v_mul_u32_u24 v201, 1280, v201
    v_lshl_add_u32 v201, v200, 4, v201
    v_cmp_gt_u32 s[80:81], 16, v200
    v_mov_b32 v202, 2130706432
    s_nop 0
    v_cndmask_b32 v202, v202, v201, s[80:81]
    v_lshrrev_b32 v188, 3, v0
    v_and_b32 v198, 7, v0
    s_bfe_u32 s70, s2, 0x20002
    s_and_b32 s73, s2, 3
    s_lshr_b32 s74, s2, 4
    s_sub_u32 s74, s74, 6
    s_mul_i32 s75, s74, 86
    s_lshr_b32 s75, s75, 8
    s_mul_i32 s75, s75, 7
    s_lshr_b32 s69, s74, 1
    s_lshl3_add_u32 s69, s69, 3
    s_bitcmp1_b32 s2, 0
    s_cselect_b32 s69, s69, s75
    s_add_u32 s69, s69, s74
    s_lshr_b32 s75, s73, 1
    s_mul_i32 s75, s75, 5
    s_add_u32 s69, s69, s75
    s_add_u32 s75, s74, s73
    s_add_u32 s75, s75, 47
    s_cmp_ge_u32 s69, 30
    s_cselect_b32 s69, s75, s69
    s_lshl_b32 s75, s73, 2
    s_lshr_b32 s75, 0x7989, s75
    s_and_b32 s75, s75, 15
    s_cmp_lt_i32 s74, s75
    s_cselect_b32 s70, s70, 4
    s_mul_i32 s75, s73, 6
    s_add_u32 s75, s75, s74
    s_add_u32 s75, s75, 36
    s_cmp_lt_i32 s74, 0
    s_cselect_b32 s69, s75, s69
    s_cmp_ge_u32 s69, 30
    s_mov_b32 s75, 3456
    s_cselect_b32 s75, s75, 3840
    s_cselect_b32 s74, 30, 0
    s_mul_i32 s66, s75, 640
    s_mov_b32 s67, 0x20000
    s_sub_u32 s74, s69, s74
    s_lshl_b32 s74, s74, 7
    s_lshl2_add_u32 s73, s70, s56
    s_mul_i32 s73, s73, 40
    s_mul_i32 s73, s73, s75
    s_add_u32 s73, s73, s74
    v_mul_u32_u24 v199, s75, v188
    v_lshl_add_u32 v199, v198, 4, v199
    s_lshl_b32 s75, s75, 3
    s_mov_b32 s26, 2621440
    s_mov_b32 s27, 0x20000
    s_waitcnt lgkmcnt(0)
    s_mov_b32 s24, s4
    s_mov_b32 s25, s5
    buffer_load_dwordx4 v[204:207], v201, s[24:27], s72 offen
    buffer_load_dwordx4 v[208:211], v201, s[24:27], s72 offen offset:512
    buffer_load_dwordx4 v[212:215], v202, s[24:27], s72 offen offset:1024
    s_cmp_ge_u32 s69, 30
    s_cselect_b32 s64, s12, s6
    s_cselect_b32 s65, s13, s7
    buffer_load_dwordx4 v[168:171], v199, s[64:67], s73 offen
    s_add_u32 s73, s73, s75
    buffer_load_dwordx4 v[172:175], v199, s[64:67], s73 offen
    s_add_u32 s73, s73, s75
    buffer_load_dwordx4 v[176:179], v199, s[64:67], s73 offen
    s_add_u32 s73, s73, s75
    buffer_load_dwordx4 v[180:183], v199, s[64:67], s73 offen
    s_add_u32 s73, s73, s75
    buffer_load_dwordx4 v[184:187], v199, s[64:67], s73 offen
    s_mov_b32 s28, s73
    s_mov_b32 s29, s75
    s_add_u32 s36, s20, 10485760
    s_addc_u32 s37, s21, 0
    s_mov_b32 s38, 393216
    s_mov_b32 s39, 0x20000
    s_mov_b32 s32, s20
    s_mov_b32 s33, s21
    s_mov_b32 s34, 9699328
    s_mov_b32 s35, 0x20000
    s_mov_b32 s52, s16
    s_mov_b32 s53, s17
    s_mov_b32 s54, 2621440
    s_mov_b32 s55, 0x20000
    s_bfe_u32 s72, s2, 0x20001
    s_mul_i32 s72, s72, 28
    s_lshr_b32 s73, s2, 3
    s_add_u32 s72, s72, s73
    s_sub_u32 s72, s72, 4
    s_cmp_lt_u32 s72, 110
    s_cselect_b32 s63, 1, 0
    s_mul_i32 s60, s72, 13108
    s_lshr_b32 s60, s60, 16
    s_mul_i32 s61, s60, 5
    s_sub_u32 s61, s72, s61
    s_and_b32 s72, s2, 1
    s_mul_i32 s72, s72, 5
    s_add_u32 s61, s61, s72
    s_cmp_eq_u32 s2, 246
    s_cselect_b32 s63, 1, s63
    s_cselect_b32 s60, 21, s60
    s_cselect_b32 s61, 9, s61
    v_mov_b32 v200, 163744
    v_mov_b32 v202, 0
    v_mov_b32 v203, 0
    ds_write_b64 v200, v[202:203] offset:0
    ds_write_b64 v200, v[202:203] offset:8
    ds_write_b64 v200, v[202:203] offset:16
    ds_write_b64 v200, v[202:203] offset:24
    ds_write_b64 v200, v[202:203] offset:32
    ds_write_b64 v200, v[202:203] offset:40
    ds_write_b64 v200, v[202:203] offset:48
    ds_write_b64 v200, v[202:203] offset:56
    ds_write_b64 v200, v[202:203] offset:64
    ds_write_b64 v200, v[202:203] offset:72
    ds_write_b64 v200, v[202:203] offset:80
    ds_write_b64 v200, v[202:203] offset:88
    s_cmp_ge_u32 s62, 13
    s_cbranch_scc1 L_svcc
    s_cmp_eq_u32 s57, 1
    s_cbranch_scc1 L_cK
    s_cmp_eq_u32 s57, 2
    s_cbranch_scc1 L_cQ
    s_lshr_b32 s74, s56, 1
    s_and_b32 s75, s56, 1
    v_and_b32 v7, 15, v0
    v_lshrrev_b32 v8, 4, v0
    v_lshrrev_b32 v9, 1, v7
    v_xor_b32 v9, v9, v8
    v_lshlrev_b32 v9, 4, v9
    v_lshl_add_u32 v9, v7, 7, v9
    s_mul_i32 s72, s74, 10240
    v_add_u32 v1, s72, v9
    v_xor_b32 v2, 64, v1
    v_lshrrev_b32 v7, 2, v0
    v_and_b32 v7, 3, v7
    v_lshl_add_u32 v9, v8, 3, v7
    v_lshrrev_b32 v7, 1, v7
    v_and_b32 v8, 1, v8
    v_lshl_add_u32 v7, v8, 1, v7
    v_lshlrev_b32 v9, 7, v9
    v_lshl_add_u32 v9, v7, 5, v9
    v_and_b32 v7, 3, v0
    v_lshl_add_u32 v9, v7, 3, v9
    s_mul_i32 s72, s75, 6
    s_add_u32 s72, s72, 0
    s_and_b32 s73, s72, 3
    s_lshl_b32 s73, s73, 5
    s_lshr_b32 s72, s72, 2
    s_lshl_b32 s72, s72, 13
    s_add_u32 s72, s72, 20480
    v_xor_b32 v3, s73, v9
    v_add_u32 v3, s72, v3
    s_mul_i32 s72, s75, 6
    s_add_u32 s72, s72, 1
    s_and_b32 s73, s72, 3
    s_lshl_b32 s73, s73, 5
    s_lshr_b32 s72, s72, 2
    s_lshl_b32 s72, s72, 13
    s_add_u32 s72, s72, 20480
    v_xor_b32 v4, s73, v9
    v_add_u32 v4, s72, v4
    s_mul_i32 s72, s75, 6
    s_add_u32 s72, s72, 2
    s_and_b32 s73, s72, 3
    s_lshl_b32 s73, s73, 5
    s_lshr_b32 s72, s72, 2
    s_lshl_b32 s72, s72, 13
    s_add_u32 s72, s72, 20480
    v_xor_b32 v5, s73, v9
    v_add_u32 v5, s72, v5
    s_mul_i32 s72, s75, 6
    s_add_u32 s72, s72, 3
    s_and_b32 s73, s72, 3
    s_lshl_b32 s73, s73, 5
    s_lshr_b32 s72, s72, 2
    s_lshl_b32 s72, s72, 13
    s_add_u32 s72, s72, 20480
    v_xor_b32 v6, s73, v9
    v_add_u32 v6, s72, v6
    v_pk_mov_b32 v[12:13], 0, 0
    v_pk_mov_b32 v[14:15], 0, 0
    v_pk_mov_b32 v[16:17], 0, 0
    v_pk_mov_b32 v[18:19], 0, 0
    v_pk_mov_b32 v[20:21], 0, 0
    v_pk_mov_b32 v[22:23], 0, 0
    v_pk_mov_b32 v[24:25], 0, 0
    v_pk_mov_b32 v[26:27], 0, 0
    v_pk_mov_b32 v[28:29], 0, 0
    v_pk_mov_b32 v[30:31], 0, 0
    v_pk_mov_b32 v[32:33], 0, 0
    v_pk_mov_b32 v[34:35], 0, 0
    v_pk_mov_b32 v[36:37], 0, 0
    v_pk_mov_b32 v[38:39], 0, 0
    v_pk_mov_b32 v[40:41], 0, 0
    v_pk_mov_b32 v[42:43], 0, 0
    v_pk_mov_b32 v[44:45], 0, 0
    v_pk_mov_b32 v[46:47], 0, 0
    v_pk_mov_b32 v[48:49], 0, 0
    v_pk_mov_b32 v[50:51], 0, 0
    v_pk_mov_b32 v[52:53], 0, 0
    v_pk_mov_b32 v[54:55], 0, 0
    v_pk_mov_b32 v[56:57], 0, 0
    v_pk_mov_b32 v[58:59], 0, 0
    v_pk_mov_b32 v[60:61], 0, 0
    v_pk_mov_b32 v[62:63], 0, 0
    v_pk_mov_b32 v[64:65], 0, 0
    v_pk_mov_b32 v[66:67], 0, 0
    v_pk_mov_b32 v[68:69], 0, 0
    v_pk_mov_b32 v[70:71], 0, 0
    v_pk_mov_b32 v[72:73], 0, 0
    v_pk_mov_b32 v[74:75], 0, 0
    v_pk_mov_b32 v[76:77], 0, 0
    v_pk_mov_b32 v[78:79], 0, 0
    v_pk_mov_b32 v[80:81], 0, 0
    v_pk_mov_b32 v[82:83], 0, 0
    v_pk_mov_b32 v[84:85], 0, 0
    v_pk_mov_b32 v[86:87], 0, 0
    v_pk_mov_b32 v[88:89], 0, 0
    v_pk_mov_b32 v[90:91], 0, 0
    v_pk_mov_b32 v[92:93], 0, 0
    v_pk_mov_b32 v[94:95], 0, 0
    v_pk_mov_b32 v[96:97], 0, 0
    v_pk_mov_b32 v[98:99], 0, 0
    v_pk_mov_b32 v[100:101], 0, 0
    v_pk_mov_b32 v[102:103], 0, 0
    v_pk_mov_b32 v[104:105], 0, 0
    v_pk_mov_b32 v[106:107], 0, 0
    v_pk_mov_b32 v[108:109], 0, 0
    v_pk_mov_b32 v[110:111], 0, 0
    v_pk_mov_b32 v[112:113], 0, 0
    v_pk_mov_b32 v[114:115], 0, 0
    v_pk_mov_b32 v[116:117], 0, 0
    v_pk_mov_b32 v[118:119], 0, 0
    v_pk_mov_b32 v[120:121], 0, 0
    v_pk_mov_b32 v[122:123], 0, 0
    v_pk_mov_b32 v[124:125], 0, 0
    v_pk_mov_b32 v[126:127], 0, 0
    v_pk_mov_b32 v[128:129], 0, 0
    v_pk_mov_b32 v[130:131], 0, 0
    s_waitcnt vmcnt(5)
    v_lshlrev_b32 v216, 16, v204
    v_and_b32 v217, 0xffff0000, v204
    v_lshlrev_b32 v218, 16, v205
    v_and_b32 v219, 0xffff0000, v205
    v_lshlrev_b32 v220, 16, v206
    v_and_b32 v221, 0xffff0000, v206
    v_lshlrev_b32 v222, 16, v207
    v_and_b32 v223, 0xffff0000, v207
    v_lshlrev_b32 v224, 16, v208
    v_and_b32 v225, 0xffff0000, v208
    v_lshlrev_b32 v226, 16, v209
    v_and_b32 v227, 0xffff0000, v209
    v_lshlrev_b32 v228, 16, v210
    v_and_b32 v229, 0xffff0000, v210
    v_lshlrev_b32 v230, 16, v211
    v_and_b32 v231, 0xffff0000, v211
    v_lshlrev_b32 v232, 16, v212
    v_and_b32 v233, 0xffff0000, v212
    v_lshlrev_b32 v234, 16, v213
    v_and_b32 v235, 0xffff0000, v213
    v_lshlrev_b32 v236, 16, v214
    v_and_b32 v237, 0xffff0000, v214
    v_lshlrev_b32 v238, 16, v215
    v_and_b32 v239, 0xffff0000, v215
    v_pk_add_f32 v[240:241], v[216:217], v[218:219]
    v_pk_add_f32 v[240:241], v[240:241], v[220:221]
    v_pk_add_f32 v[240:241], v[240:241], v[222:223]
    v_pk_add_f32 v[240:241], v[240:241], v[224:225]
    v_pk_add_f32 v[240:241], v[240:241], v[226:227]
    v_pk_add_f32 v[240:241], v[240:241], v[228:229]
    v_pk_add_f32 v[240:241], v[240:241], v[230:231]
    v_pk_add_f32 v[240:241], v[240:241], v[232:233]
    v_pk_add_f32 v[240:241], v[240:241], v[234:235]
    v_pk_add_f32 v[240:241], v[240:241], v[236:237]
    v_pk_add_f32 v[240:241], v[240:241], v[238:239]
    v_add_f32 v240, v240, v241
    s_nop 1
    v_add_f32_dpp v240, v240, v240 row_ror:8 row_mask:0xf bank_mask:0xf
    s_nop 1
    v_add_f32_dpp v240, v240, v240 row_ror:4 row_mask:0xf bank_mask:0xf
    s_nop 1
    v_add_f32_dpp v240, v240, v240 row_ror:2 row_mask:0xf bank_mask:0xf
    s_nop 1
    v_add_f32_dpp v240, v240, v240 row_ror:1 row_mask:0xf bank_mask:0xf
    v_mov_b32 v242, v240
    s_nop 1
    v_permlane16_swap_b32 v240, v242
    v_add_f32 v240, v240, v242
    v_mul_f32 v240, 0xbacccccd, v240
    v_cndmask_b32 v241, 0, v240, s[80:81]
    v_pk_add_f32 v[216:217], v[216:217], v[240:241] op_sel_hi:[1,0]
    v_pk_add_f32 v[218:219], v[218:219], v[240:241] op_sel_hi:[1,0]
    v_pk_add_f32 v[220:221], v[220:221], v[240:241] op_sel_hi:[1,0]
    v_pk_add_f32 v[222:223], v[222:223], v[240:241] op_sel_hi:[1,0]
    v_pk_add_f32 v[224:225], v[224:225], v[240:241] op_sel_hi:[1,0]
    v_pk_add_f32 v[226:227], v[226:227], v[240:241] op_sel_hi:[1,0]
    v_pk_add_f32 v[228:229], v[228:229], v[240:241] op_sel_hi:[1,0]
    v_pk_add_f32 v[230:231], v[230:231], v[240:241] op_sel_hi:[1,0]
    v_pk_add_f32 v[232:233], v[232:233], v[240:241] op_sel:[0,1] op_sel_hi:[1,1]
    v_pk_add_f32 v[234:235], v[234:235], v[240:241] op_sel:[0,1] op_sel_hi:[1,1]
    v_pk_add_f32 v[236:237], v[236:237], v[240:241] op_sel:[0,1] op_sel_hi:[1,1]
    v_pk_add_f32 v[238:239], v[238:239], v[240:241] op_sel:[0,1] op_sel_hi:[1,1]
    v_pk_mul_f32 v[244:245], v[216:217], v[216:217]
    v_pk_fma_f32 v[244:245], v[218:219], v[218:219], v[244:245]
    v_pk_fma_f32 v[244:245], v[220:221], v[220:221], v[244:245]
    v_pk_fma_f32 v[244:245], v[222:223], v[222:223], v[244:245]
    v_pk_fma_f32 v[244:245], v[224:225], v[224:225], v[244:245]
    v_pk_fma_f32 v[244:245], v[226:227], v[226:227], v[244:245]
    v_pk_fma_f32 v[244:245], v[228:229], v[228:229], v[244:245]
    v_pk_fma_f32 v[244:245], v[230:231], v[230:231], v[244:245]
    v_pk_fma_f32 v[244:245], v[232:233], v[232:233], v[244:245]
    v_pk_fma_f32 v[244:245], v[234:235], v[234:235], v[244:245]
    v_pk_fma_f32 v[244:245], v[236:237], v[236:237], v[244:245]
    v_pk_fma_f32 v[244:245], v[238:239], v[238:239], v[244:245]
    v_add_f32 v244, v244, v245
    s_nop 1
    v_add_f32_dpp v244, v244, v244 row_ror:8 row_mask:0xf bank_mask:0xf
    s_nop 1
    v_add_f32_dpp v244, v244, v244 row_ror:4 row_mask:0xf bank_mask:0xf
    s_nop 1
    v_add_f32_dpp v244, v244, v244 row_ror:2 row_mask:0xf bank_mask:0xf
    s_nop 1
    v_add_f32_dpp v244, v244, v244 row_ror:1 row_mask:0xf bank_mask:0xf
    v_mov_b32 v242, v244
    s_nop 1
    v_permlane16_swap_b32 v244, v242
    v_add_f32 v244, v244, v242
    v_mul_f32 v244, 0x3acccccd, v244
    v_cvt_pk_bf16_f32 v242, v240, v240
    v_lshlrev_b32 v240, 16, v242
    v_cvt_pk_bf16_f32 v242, v244, v244
    v_lshlrev_b32 v244, 16, v242
    v_add_f32 v244, 0x3727c5ac, v244
    v_cvt_pk_bf16_f32 v242, v244, v244
    v_lshlrev_b32 v244, 16, v242
    v_sqrt_f32 v244, v244
    s_nop 0
    v_cvt_pk_bf16_f32 v242, v244, v244
    v_lshlrev_b32 v244, 16, v242
    v_rcp_f32 v244, v244
    v_lshrrev_b32 v242, 5, v0
    s_lshl_b32 s72, s56, 3
    s_add_u32 s72, s72, 160768
    v_lshl_add_u32 v242, v242, 2, s72
    ds_write_b32 v242, v240
    ds_write_b32 v242, v244 offset:32
    s_mov_b32 s76, 9
    s_mov_b32 s77, 0
    v_mov_b32 v251, 2130706432
    v_writelane_b32 v251, 0, 0
    v_mov_b32 v252, 1
    v_mov_b32 v253, 163744
    s_mul_i32 s72, s60, 96
    s_add_u32 s73, s72, 95
    s_min_u32 s73, s73, 2047
    s_min_u32 s72, s72, 2047
    s_mul_i32 s72, s72, 26215
    s_lshr_b32 s72, s72, 22
    s_mul_i32 s73, s73, 26215
    s_lshr_b32 s73, s73, 22
    v_mov_b32 v249, s72
    v_mov_b32 v250, s73
    v_cmp_gt_u32 vcc, 16, v0
    s_nop 1
    v_cndmask_b32 v250, v250, v249, vcc
    v_and_b32 v249, 15, v0
    v_min_u32 v249, 8, v249
    s_mov_b32 s72, 131072
    s_cmp_eq_u32 s56, 0
    s_cselect_b32 s72, s72, 2130706432
    s_cselect_b32 s3, 1, 0
    v_lshl_add_u32 v250, v250, 4, v249
    v_lshlrev_b32 v250, 9, v250
    v_add_u32 v250, s72, v250
    v_mov_b32 v249, 0
    v_and_b32 v7, 15, v0
    s_mul_i32 s72, s74, 320
    s_add_u32 s72, s72, 160896
    v_lshl_add_u32 v7, v7, 2, s72
    v_lshrrev_b32 v8, 4, v0
    s_mul_i32 s72, s75, 384
    s_add_u32 s72, s72, 162944
    v_lshl_add_u32 v8, v8, 4, s72
    s_lshr_b32 s72, s58, 4
    s_mul_i32 s73, s74, 5
    s_add_u32 s72, s72, s73
    s_mul_i32 s72, s72, 74
    s_lshl1_add_u32 s73, s59, s75
    s_add_u32 s72, s72, s73
    s_lshl_b32 s79, s72, 10
    s_add_u32 s80, s79, 75776
    s_add_u32 s81, s80, 75776
    s_add_u32 s82, s81, 75776
    s_add_u32 s83, s82, 75776
    s_lshl4_add_u32 s71, s62, s59
    s_lshl_b32 s71, s71, 9
    s_add_u32 s71, s71, 131072
    v_lshlrev_b32 v9, 4, v0
    s_waitcnt vmcnt(0)
    v_lshlrev_b32 v188, 16, v168
    v_and_b32 v189, 0xffff0000, v168
    v_lshlrev_b32 v190, 16, v169
    v_and_b32 v191, 0xffff0000, v169
    v_lshlrev_b32 v192, 16, v170
    v_and_b32 v193, 0xffff0000, v170
    v_lshlrev_b32 v194, 16, v171
    v_and_b32 v195, 0xffff0000, v171
    v_lshlrev_b32 v196, 16, v172
    v_and_b32 v197, 0xffff0000, v172
    v_pk_add_f32 v[188:189], v[188:189], v[196:197]
    v_lshlrev_b32 v196, 16, v173
    v_and_b32 v197, 0xffff0000, v173
    v_pk_add_f32 v[190:191], v[190:191], v[196:197]
    v_lshlrev_b32 v196, 16, v174
    v_and_b32 v197, 0xffff0000, v174
    v_pk_add_f32 v[192:193], v[192:193], v[196:197]
    v_lshlrev_b32 v196, 16, v175
    v_and_b32 v197, 0xffff0000, v175
    v_pk_add_f32 v[194:195], v[194:195], v[196:197]
    v_lshlrev_b32 v196, 16, v176
    v_and_b32 v197, 0xffff0000, v176
    v_pk_add_f32 v[188:189], v[188:189], v[196:197]
    v_lshlrev_b32 v196, 16, v177
    v_and_b32 v197, 0xffff0000, v177
    v_pk_add_f32 v[190:191], v[190:191], v[196:197]
    v_lshlrev_b32 v196, 16, v178
    v_and_b32 v197, 0xffff0000, v178
    v_pk_add_f32 v[192:193], v[192:193], v[196:197]
    v_lshlrev_b32 v196, 16, v179
    v_and_b32 v197, 0xffff0000, v179
    v_pk_add_f32 v[194:195], v[194:195], v[196:197]
    v_lshlrev_b32 v196, 16, v180
    v_and_b32 v197, 0xffff0000, v180
    v_pk_add_f32 v[188:189], v[188:189], v[196:197]
    v_lshlrev_b32 v196, 16, v181
    v_and_b32 v197, 0xffff0000, v181
    v_pk_add_f32 v[190:191], v[190:191], v[196:197]
    v_lshlrev_b32 v196, 16, v182
    v_and_b32 v197, 0xffff0000, v182
    v_pk_add_f32 v[192:193], v[192:193], v[196:197]
    v_lshlrev_b32 v196, 16, v183
    v_and_b32 v197, 0xffff0000, v183
    v_pk_add_f32 v[194:195], v[194:195], v[196:197]
    v_lshlrev_b32 v196, 16, v184
    v_and_b32 v197, 0xffff0000, v184
    v_pk_add_f32 v[188:189], v[188:189], v[196:197]
    v_lshlrev_b32 v196, 16, v185
    v_and_b32 v197, 0xffff0000, v185
    v_pk_add_f32 v[190:191], v[190:191], v[196:197]
    v_lshlrev_b32 v196, 16, v186
    v_and_b32 v197, 0xffff0000, v186
    v_pk_add_f32 v[192:193], v[192:193], v[196:197]
    v_lshlrev_b32 v196, 16, v187
    v_and_b32 v197, 0xffff0000, v187
    v_pk_add_f32 v[194:195], v[194:195], v[196:197]
    v_permlane32_swap_b32 v188, v192
    v_permlane32_swap_b32 v189, v193
    v_permlane32_swap_b32 v190, v194
    v_permlane32_swap_b32 v191, v195
    v_add_f32 v188, v188, v192
    v_add_f32 v189, v189, v193
    v_add_f32 v190, v190, v194
    v_add_f32 v191, v191, v195
    s_nop 0
    v_permlane16_swap_b32 v188, v190
    v_permlane16_swap_b32 v189, v191
    v_add_f32 v188, v188, v190
    v_add_f32 v189, v189, v191
    s_nop 0
    v_add_f32_dpp v188, v188, v188 row_ror:8 row_mask:0xf bank_mask:0xf
    v_add_f32_dpp v189, v189, v189 row_ror:8 row_mask:0xf bank_mask:0xf
    v_lshrrev_b32 v199, 4, v0
    v_lshlrev_b32 v199, 3, v199
    v_lshl_add_u32 v199, v198, 5, v199
    s_lshl_b32 s73, s56, 8
    s_add_u32 s73, s73, 159744
    v_add_u32 v199, s73, v199
    ds_write_b64 v199, v[188:189]
    s_branch L_pg_H
.p2align 12
L_pg_H:
    s_waitcnt lgkmcnt(0)
    s_barrier
    ds_read_b128 v[156:159], v1 offset:0
    ds_read_b128 v[160:163], v1 offset:2048
    ds_read_b128 v[164:167], v1 offset:4096
    ds_read_b128 v[168:171], v1 offset:6144
    ds_read_b128 v[172:175], v1 offset:8192
    ds_read_b64_tr_b16 v[132:133], v3 offset:0
    ds_read_b64_tr_b16 v[134:135], v3 offset:512
    ds_read_b64_tr_b16 v[136:137], v4 offset:0
    ds_read_b64_tr_b16 v[138:139], v4 offset:512
    ds_read_b64_tr_b16 v[140:141], v5 offset:0
    ds_read_b64_tr_b16 v[142:143], v5 offset:512
    ds_read_b64_tr_b16 v[144:145], v6 offset:0
    ds_read_b64_tr_b16 v[146:147], v6 offset:512
    ds_read_b64_tr_b16 v[148:149], v3 offset:8192
    ds_read_b64_tr_b16 v[150:151], v3 offset:8704
    ds_read_b64_tr_b16 v[152:153], v4 offset:8192
    ds_read_b64_tr_b16 v[154:155], v4 offset:8704
    s_waitcnt lgkmcnt(0)
.p2align 6
L_main_H:
    s_waitcnt lgkmcnt(4)
    v_mfma_f32_16x16x32_bf16 v[12:15], v[132:135], v[156:159], v[12:15]
    ds_read_b128 v[176:179], v2 offset:0
    v_mfma_f32_16x16x32_bf16 v[36:39], v[132:135], v[160:163], v[36:39]
    ds_read_b128 v[180:183], v2 offset:2048
    v_mfma_f32_16x16x32_bf16 v[60:63], v[132:135], v[164:167], v[60:63]
    ds_read_b128 v[184:187], v2 offset:4096
    v_mfma_f32_16x16x32_bf16 v[84:87], v[132:135], v[168:171], v[84:87]
    ds_read_b128 v[188:191], v2 offset:6144
    v_mfma_f32_16x16x32_bf16 v[108:111], v[132:135], v[172:175], v[108:111]
    ds_read_b64_tr_b16 v[132:133], v3 offset:4096
    v_mfma_f32_16x16x32_bf16 v[16:19], v[136:139], v[156:159], v[16:19]
    ds_read_b64_tr_b16 v[134:135], v3 offset:4608
    v_mfma_f32_16x16x32_bf16 v[40:43], v[136:139], v[160:163], v[40:43]
    ds_read_b128 v[192:195], v2 offset:8192
    v_mfma_f32_16x16x32_bf16 v[64:67], v[136:139], v[164:167], v[64:67]
    s_add_u32 s77, s77, 1
    v_mfma_f32_16x16x32_bf16 v[88:91], v[136:139], v[168:171], v[88:91]
    s_cmp_eq_u32 s77, 3
    s_cselect_b32 s77, 0, s77
    v_mfma_f32_16x16x32_bf16 v[112:115], v[136:139], v[172:175], v[112:115]
    ds_read_b64_tr_b16 v[136:137], v4 offset:4096
    v_mfma_f32_16x16x32_bf16 v[20:23], v[140:143], v[156:159], v[20:23]
    ds_read_b64_tr_b16 v[138:139], v4 offset:4608
    v_mfma_f32_16x16x32_bf16 v[44:47], v[140:143], v[160:163], v[44:47]
    s_mov_b32 s78, 45056
    s_cselect_b32 s78, -90112, s78
    v_mfma_f32_16x16x32_bf16 v[68:71], v[140:143], v[164:167], v[68:71]
    v_mfma_f32_16x16x32_bf16 v[92:95], v[140:143], v[168:171], v[92:95]
    v_mfma_f32_16x16x32_bf16 v[116:119], v[140:143], v[172:175], v[116:119]
    ds_read_b64_tr_b16 v[140:141], v5 offset:4096
    v_mfma_f32_16x16x32_bf16 v[24:27], v[144:147], v[156:159], v[24:27]
    ds_read_b64_tr_b16 v[142:143], v5 offset:4608
    v_mfma_f32_16x16x32_bf16 v[48:51], v[144:147], v[160:163], v[48:51]
    v_mfma_f32_16x16x32_bf16 v[72:75], v[144:147], v[164:167], v[72:75]
    v_mfma_f32_16x16x32_bf16 v[96:99], v[144:147], v[168:171], v[96:99]
    v_mfma_f32_16x16x32_bf16 v[120:123], v[144:147], v[172:175], v[120:123]
    ds_read_b64_tr_b16 v[144:145], v6 offset:4096
    s_waitcnt lgkmcnt(3)
    v_mfma_f32_16x16x32_bf16 v[28:31], v[148:151], v[156:159], v[28:31]
    ds_read_b64_tr_b16 v[146:147], v6 offset:4608
    v_mfma_f32_16x16x32_bf16 v[52:55], v[148:151], v[160:163], v[52:55]
    v_mfma_f32_16x16x32_bf16 v[76:79], v[148:151], v[164:167], v[76:79]
    v_mfma_f32_16x16x32_bf16 v[100:103], v[148:151], v[168:171], v[100:103]
    v_mfma_f32_16x16x32_bf16 v[124:127], v[148:151], v[172:175], v[124:127]
    ds_read_b64_tr_b16 v[148:149], v3 offset:12288
    v_mfma_f32_16x16x32_bf16 v[32:35], v[152:155], v[156:159], v[32:35]
    ds_read_b64_tr_b16 v[150:151], v3 offset:12800
    v_mfma_f32_16x16x32_bf16 v[56:59], v[152:155], v[160:163], v[56:59]
    v_mfma_f32_16x16x32_bf16 v[80:83], v[152:155], v[164:167], v[80:83]
    v_mfma_f32_16x16x32_bf16 v[104:107], v[152:155], v[168:171], v[104:107]
    v_mfma_f32_16x16x32_bf16 v[128:131], v[152:155], v[172:175], v[128:131]
    ds_read_b64_tr_b16 v[152:153], v4 offset:12288
    v_mfma_f32_16x16x32_bf16 v[12:15], v[132:135], v[176:179], v[12:15]
    ds_read_b64_tr_b16 v[154:155], v4 offset:12800
    v_mfma_f32_16x16x32_bf16 v[36:39], v[132:135], v[180:183], v[36:39]
    v_add_u32 v1, s78, v1
    v_mfma_f32_16x16x32_bf16 v[60:63], v[132:135], v[184:187], v[60:63]
    v_add_u32 v2, s78, v2
    v_mfma_f32_16x16x32_bf16 v[84:87], v[132:135], v[188:191], v[84:87]
    v_add_u32 v3, s78, v3
    v_mfma_f32_16x16x32_bf16 v[108:111], v[132:135], v[192:195], v[108:111]
    v_add_u32 v4, s78, v4
    v_mfma_f32_16x16x32_bf16 v[16:19], v[136:139], v[176:179], v[16:19]
    v_add_u32 v5, s78, v5
    v_mfma_f32_16x16x32_bf16 v[40:43], v[136:139], v[180:183], v[40:43]
    v_add_u32 v6, s78, v6
    v_mfma_f32_16x16x32_bf16 v[64:67], v[136:139], v[184:187], v[64:67]
    s_waitcnt lgkmcnt(0)
    s_barrier
    v_mfma_f32_16x16x32_bf16 v[88:91], v[136:139], v[188:191], v[88:91]
    ds_read_b64_tr_b16 v[132:133], v3 offset:0
    v_mfma_f32_16x16x32_bf16 v[112:115], v[136:139], v[192:195], v[112:115]
    ds_read_b64_tr_b16 v[134:135], v3 offset:512
    v_mfma_f32_16x16x32_bf16 v[20:23], v[140:143], v[176:179], v[20:23]
    ds_read_b128 v[156:159], v1 offset:0
    v_mfma_f32_16x16x32_bf16 v[44:47], v[140:143], v[180:183], v[44:47]
    ds_read_b128 v[160:163], v1 offset:2048
    v_mfma_f32_16x16x32_bf16 v[68:71], v[140:143], v[184:187], v[68:71]
    ds_read_b128 v[164:167], v1 offset:4096
    v_mfma_f32_16x16x32_bf16 v[92:95], v[140:143], v[188:191], v[92:95]
    ds_read_b128 v[168:171], v1 offset:6144
    v_mfma_f32_16x16x32_bf16 v[116:119], v[140:143], v[192:195], v[116:119]
    ds_read_b128 v[172:175], v1 offset:8192
    v_mfma_f32_16x16x32_bf16 v[24:27], v[144:147], v[176:179], v[24:27]
    ds_read_b64_tr_b16 v[136:137], v4 offset:0
    v_mfma_f32_16x16x32_bf16 v[48:51], v[144:147], v[180:183], v[48:51]
    ds_read_b64_tr_b16 v[138:139], v4 offset:512
    v_mfma_f32_16x16x32_bf16 v[72:75], v[144:147], v[184:187], v[72:75]
    ds_read_b64_tr_b16 v[140:141], v5 offset:0
    v_mfma_f32_16x16x32_bf16 v[96:99], v[144:147], v[188:191], v[96:99]
    ds_read_b64_tr_b16 v[142:143], v5 offset:512
    v_mfma_f32_16x16x32_bf16 v[120:123], v[144:147], v[192:195], v[120:123]
    ds_read_b64_tr_b16 v[144:145], v6 offset:0
    v_mfma_f32_16x16x32_bf16 v[28:31], v[148:151], v[176:179], v[28:31]
    ds_read_b64_tr_b16 v[146:147], v6 offset:512
    v_mfma_f32_16x16x32_bf16 v[52:55], v[148:151], v[180:183], v[52:55]
    s_sub_u32 s76, s76, 1
    v_mfma_f32_16x16x32_bf16 v[76:79], v[148:151], v[184:187], v[76:79]
    v_mfma_f32_16x16x32_bf16 v[100:103], v[148:151], v[188:191], v[100:103]
    v_mfma_f32_16x16x32_bf16 v[124:127], v[148:151], v[192:195], v[124:127]
    ds_read_b64_tr_b16 v[148:149], v3 offset:8192
    v_mfma_f32_16x16x32_bf16 v[32:35], v[152:155], v[176:179], v[32:35]
    ds_read_b64_tr_b16 v[150:151], v3 offset:8704
    v_mfma_f32_16x16x32_bf16 v[56:59], v[152:155], v[180:183], v[56:59]
    v_mfma_f32_16x16x32_bf16 v[80:83], v[152:155], v[184:187], v[80:83]
    v_mfma_f32_16x16x32_bf16 v[104:107], v[152:155], v[188:191], v[104:107]
    v_mfma_f32_16x16x32_bf16 v[128:131], v[152:155], v[192:195], v[128:131]
    ds_read_b64_tr_b16 v[152:153], v4 offset:8192
    ds_read_b64_tr_b16 v[154:155], v4 offset:8704
    s_cmp_lg_u32 s76, 0
    s_cbranch_scc1 L_main_H
    s_waitcnt lgkmcnt(4)
    v_mfma_f32_16x16x32_bf16 v[12:15], v[132:135], v[156:159], v[12:15]
    ds_read_b128 v[176:179], v2 offset:0
    v_mfma_f32_16x16x32_bf16 v[36:39], v[132:135], v[160:163], v[36:39]
    ds_read_b128 v[180:183], v2 offset:2048
    v_mfma_f32_16x16x32_bf16 v[60:63], v[132:135], v[164:167], v[60:63]
    ds_read_b128 v[184:187], v2 offset:4096
    v_mfma_f32_16x16x32_bf16 v[84:87], v[132:135], v[168:171], v[84:87]
    ds_read_b128 v[188:191], v2 offset:6144
    v_mfma_f32_16x16x32_bf16 v[108:111], v[132:135], v[172:175], v[108:111]
    ds_read_b64_tr_b16 v[132:133], v3 offset:4096
    v_mfma_f32_16x16x32_bf16 v[16:19], v[136:139], v[156:159], v[16:19]
    ds_read_b64_tr_b16 v[134:135], v3 offset:4608
    v_mfma_f32_16x16x32_bf16 v[40:43], v[136:139], v[160:163], v[40:43]
    ds_read_b128 v[192:195], v2 offset:8192
    v_mfma_f32_16x16x32_bf16 v[64:67], v[136:139], v[164:167], v[64:67]
    ds_read_b32 v196, v7 offset:0
    v_mfma_f32_16x16x32_bf16 v[88:91], v[136:139], v[168:171], v[88:91]
    ds_read_b32 v197, v7 offset:1024
    v_mfma_f32_16x16x32_bf16 v[112:115], v[136:139], v[172:175], v[112:115]
    ds_read_b64_tr_b16 v[136:137], v4 offset:4096
    v_mfma_f32_16x16x32_bf16 v[20:23], v[140:143], v[156:159], v[20:23]
    ds_read_b64_tr_b16 v[138:139], v4 offset:4608
    v_mfma_f32_16x16x32_bf16 v[44:47], v[140:143], v[160:163], v[44:47]
    ds_read_b32 v198, v7 offset:64
    v_mfma_f32_16x16x32_bf16 v[68:71], v[140:143], v[164:167], v[68:71]
    ds_read_b32 v199, v7 offset:1088
    v_mfma_f32_16x16x32_bf16 v[92:95], v[140:143], v[168:171], v[92:95]
    ds_read_b32 v200, v7 offset:128
    v_mfma_f32_16x16x32_bf16 v[116:119], v[140:143], v[172:175], v[116:119]
    ds_read_b64_tr_b16 v[140:141], v5 offset:4096
    v_mfma_f32_16x16x32_bf16 v[24:27], v[144:147], v[156:159], v[24:27]
    ds_read_b64_tr_b16 v[142:143], v5 offset:4608
    v_mfma_f32_16x16x32_bf16 v[48:51], v[144:147], v[160:163], v[48:51]
    ds_read_b32 v201, v7 offset:1152
    v_mfma_f32_16x16x32_bf16 v[72:75], v[144:147], v[164:167], v[72:75]
    ds_read_b32 v202, v7 offset:192
    v_mfma_f32_16x16x32_bf16 v[96:99], v[144:147], v[168:171], v[96:99]
    ds_read_b32 v203, v7 offset:1216
    v_mfma_f32_16x16x32_bf16 v[120:123], v[144:147], v[172:175], v[120:123]
    ds_read_b64_tr_b16 v[144:145], v6 offset:4096
    s_waitcnt lgkmcnt(8)
    v_mfma_f32_16x16x32_bf16 v[28:31], v[148:151], v[156:159], v[28:31]
    ds_read_b64_tr_b16 v[146:147], v6 offset:4608
    v_mfma_f32_16x16x32_bf16 v[52:55], v[148:151], v[160:163], v[52:55]
    ds_read_b32 v204, v7 offset:256
    v_mfma_f32_16x16x32_bf16 v[76:79], v[148:151], v[164:167], v[76:79]
    ds_read_b32 v205, v7 offset:1280
    v_mfma_f32_16x16x32_bf16 v[100:103], v[148:151], v[168:171], v[100:103]
    ds_read_b128 v[208:211], v8 offset:0
    v_mfma_f32_16x16x32_bf16 v[124:127], v[148:151], v[172:175], v[124:127]
    ds_read_b64_tr_b16 v[148:149], v3 offset:12288
    v_mfma_f32_16x16x32_bf16 v[32:35], v[152:155], v[156:159], v[32:35]
    ds_read_b64_tr_b16 v[150:151], v3 offset:12800
    v_mfma_f32_16x16x32_bf16 v[56:59], v[152:155], v[160:163], v[56:59]
    ds_read_b128 v[212:215], v8 offset:64
    v_mfma_f32_16x16x32_bf16 v[80:83], v[152:155], v[164:167], v[80:83]
    ds_read_b128 v[216:219], v8 offset:128
    v_mfma_f32_16x16x32_bf16 v[104:107], v[152:155], v[168:171], v[104:107]
    ds_read_b128 v[220:223], v8 offset:192
    v_mfma_f32_16x16x32_bf16 v[128:131], v[152:155], v[172:175], v[128:131]
    ds_read_b64_tr_b16 v[152:153], v4 offset:12288
    v_mfma_f32_16x16x32_bf16 v[12:15], v[132:135], v[176:179], v[12:15]
    ds_read_b64_tr_b16 v[154:155], v4 offset:12800
    v_mfma_f32_16x16x32_bf16 v[36:39], v[132:135], v[180:183], v[36:39]
    ds_read_b128 v[224:227], v8 offset:256
    v_mfma_f32_16x16x32_bf16 v[60:63], v[132:135], v[184:187], v[60:63]
    ds_read_b128 v[228:231], v8 offset:320
    v_mfma_f32_16x16x32_bf16 v[84:87], v[132:135], v[188:191], v[84:87]
    v_mfma_f32_16x16x32_bf16 v[108:111], v[132:135], v[192:195], v[108:111]
    v_mfma_f32_16x16x32_bf16 v[16:19], v[136:139], v[176:179], v[16:19]
    v_mfma_f32_16x16x32_bf16 v[40:43], v[136:139], v[180:183], v[40:43]
    v_mfma_f32_16x16x32_bf16 v[64:67], v[136:139], v[184:187], v[64:67]
    s_waitcnt lgkmcnt(0)
    ds_add_u32 v253, v252 offset:0
    v_mfma_f32_16x16x32_bf16 v[88:91], v[136:139], v[188:191], v[88:91]
    v_mul_f32 v197, 0xbfb8aa3b, v197
    v_mfma_f32_16x16x32_bf16 v[112:115], v[136:139], v[192:195], v[112:115]
    v_mul_f32 v199, 0xbfb8aa3b, v199
    v_mfma_f32_16x16x32_bf16 v[20:23], v[140:143], v[176:179], v[20:23]
    v_mul_f32 v201, 0xbfb8aa3b, v201
    v_mfma_f32_16x16x32_bf16 v[44:47], v[140:143], v[180:183], v[44:47]
    v_mul_f32 v203, 0xbfb8aa3b, v203
    v_mfma_f32_16x16x32_bf16 v[68:71], v[140:143], v[184:187], v[68:71]
    v_mul_f32 v205, 0xbfb8aa3b, v205
    v_mfma_f32_16x16x32_bf16 v[92:95], v[140:143], v[188:191], v[92:95]
    v_mfma_f32_16x16x32_bf16 v[116:119], v[140:143], v[192:195], v[116:119]
    v_mfma_f32_16x16x32_bf16 v[24:27], v[144:147], v[176:179], v[24:27]
    v_mfma_f32_16x16x32_bf16 v[48:51], v[144:147], v[180:183], v[48:51]
    v_mfma_f32_16x16x32_bf16 v[72:75], v[144:147], v[184:187], v[72:75]
    v_mfma_f32_16x16x32_bf16 v[96:99], v[144:147], v[188:191], v[96:99]
    v_mfma_f32_16x16x32_bf16 v[120:123], v[144:147], v[192:195], v[120:123]
    v_mfma_f32_16x16x32_bf16 v[28:31], v[148:151], v[176:179], v[28:31]
    v_mfma_f32_16x16x32_bf16 v[52:55], v[148:151], v[180:183], v[52:55]
    v_mfma_f32_16x16x32_bf16 v[76:79], v[148:151], v[184:187], v[76:79]
    v_mfma_f32_16x16x32_bf16 v[100:103], v[148:151], v[188:191], v[100:103]
    v_mfma_f32_16x16x32_bf16 v[124:127], v[148:151], v[192:195], v[124:127]
    v_mfma_f32_16x16x32_bf16 v[32:35], v[152:155], v[176:179], v[32:35]
    v_mfma_f32_16x16x32_bf16 v[56:59], v[152:155], v[180:183], v[56:59]
    v_mfma_f32_16x16x32_bf16 v[80:83], v[152:155], v[184:187], v[80:83]
    v_mfma_f32_16x16x32_bf16 v[104:107], v[152:155], v[188:191], v[104:107]
    v_mfma_f32_16x16x32_bf16 v[128:131], v[152:155], v[192:195], v[128:131]
    s_waitcnt lgkmcnt(0)
    v_pk_fma_f32 v[12:13], v[208:209], v[196:197], v[12:13] op_sel_hi:[1,0,1]
    v_pk_fma_f32 v[14:15], v[210:211], v[196:197], v[14:15] op_sel_hi:[1,0,1]
    v_pk_fma_f32 v[16:17], v[212:213], v[196:197], v[16:17] op_sel_hi:[1,0,1]
    v_pk_fma_f32 v[18:19], v[214:215], v[196:197], v[18:19] op_sel_hi:[1,0,1]
    v_pk_mul_f32 v[12:13], v[12:13], v[196:197] op_sel:[0,1] op_sel_hi:[1,1]
    v_pk_mul_f32 v[14:15], v[14:15], v[196:197] op_sel:[0,1] op_sel_hi:[1,1]
    v_pk_mul_f32 v[16:17], v[16:17], v[196:197] op_sel:[0,1] op_sel_hi:[1,1]
    v_pk_mul_f32 v[18:19], v[18:19], v[196:197] op_sel:[0,1] op_sel_hi:[1,1]
    v_exp_f32 v132, v12
    v_exp_f32 v133, v13
    v_exp_f32 v134, v14
    v_exp_f32 v135, v15
    v_exp_f32 v136, v16
    v_exp_f32 v137, v17
    v_exp_f32 v138, v18
    v_exp_f32 v139, v19
    v_pk_add_f32 v[132:133], v[132:133], 1.0 op_sel_hi:[1,0]
    v_pk_add_f32 v[134:135], v[134:135], 1.0 op_sel_hi:[1,0]
    v_pk_add_f32 v[136:137], v[136:137], 1.0 op_sel_hi:[1,0]
    v_pk_add_f32 v[138:139], v[138:139], 1.0 op_sel_hi:[1,0]
    v_rcp_f32 v132, v132
    v_rcp_f32 v133, v133
    v_rcp_f32 v134, v134
    v_rcp_f32 v135, v135
    v_rcp_f32 v136, v136
    v_rcp_f32 v137, v137
    v_rcp_f32 v138, v138
    v_rcp_f32 v139, v139
    v_pk_mul_f32 v[132:133], v[132:133], v[12:13]
    v_pk_mul_f32 v[134:135], v[134:135], v[14:15]
    v_pk_mul_f32 v[136:137], v[136:137], v[16:17]
    v_pk_mul_f32 v[138:139], v[138:139], v[18:19]
    v_cvt_pk_bf16_f32 v140, v132, v133
    v_cvt_pk_bf16_f32 v141, v134, v135
    v_cvt_pk_bf16_f32 v142, v136, v137
    v_cvt_pk_bf16_f32 v143, v138, v139
    buffer_store_dwordx4 v[140:143], v9, s[32:35], s79 offen sc1
    v_pk_fma_f32 v[36:37], v[208:209], v[198:199], v[36:37] op_sel_hi:[1,0,1]
    v_pk_fma_f32 v[38:39], v[210:211], v[198:199], v[38:39] op_sel_hi:[1,0,1]
    v_pk_fma_f32 v[40:41], v[212:213], v[198:199], v[40:41] op_sel_hi:[1,0,1]
    v_pk_fma_f32 v[42:43], v[214:215], v[198:199], v[42:43] op_sel_hi:[1,0,1]
    v_pk_mul_f32 v[36:37], v[36:37], v[198:199] op_sel:[0,1] op_sel_hi:[1,1]
    v_pk_mul_f32 v[38:39], v[38:39], v[198:199] op_sel:[0,1] op_sel_hi:[1,1]
    v_pk_mul_f32 v[40:41], v[40:41], v[198:199] op_sel:[0,1] op_sel_hi:[1,1]
    v_pk_mul_f32 v[42:43], v[42:43], v[198:199] op_sel:[0,1] op_sel_hi:[1,1]
    v_exp_f32 v132, v36
    v_exp_f32 v133, v37
    v_exp_f32 v134, v38
    v_exp_f32 v135, v39
    v_exp_f32 v136, v40
    v_exp_f32 v137, v41
    v_exp_f32 v138, v42
    v_exp_f32 v139, v43
    v_pk_add_f32 v[132:133], v[132:133], 1.0 op_sel_hi:[1,0]
    v_pk_add_f32 v[134:135], v[134:135], 1.0 op_sel_hi:[1,0]
    v_pk_add_f32 v[136:137], v[136:137], 1.0 op_sel_hi:[1,0]
    v_pk_add_f32 v[138:139], v[138:139], 1.0 op_sel_hi:[1,0]
    v_rcp_f32 v132, v132
    v_rcp_f32 v133, v133
    v_rcp_f32 v134, v134
    v_rcp_f32 v135, v135
    v_rcp_f32 v136, v136
    v_rcp_f32 v137, v137
    v_rcp_f32 v138, v138
    v_rcp_f32 v139, v139
    v_pk_mul_f32 v[132:133], v[132:133], v[36:37]
    v_pk_mul_f32 v[134:135], v[134:135], v[38:39]
    v_pk_mul_f32 v[136:137], v[136:137], v[40:41]
    v_pk_mul_f32 v[138:139], v[138:139], v[42:43]
    v_cvt_pk_bf16_f32 v144, v132, v133
    v_cvt_pk_bf16_f32 v145, v134, v135
    v_cvt_pk_bf16_f32 v146, v136, v137
    v_cvt_pk_bf16_f32 v147, v138, v139
    buffer_store_dwordx4 v[144:147], v9, s[32:35], s80 offen sc1
    v_pk_fma_f32 v[60:61], v[208:209], v[200:201], v[60:61] op_sel_hi:[1,0,1]
    v_pk_fma_f32 v[62:63], v[210:211], v[200:201], v[62:63] op_sel_hi:[1,0,1]
    v_pk_fma_f32 v[64:65], v[212:213], v[200:201], v[64:65] op_sel_hi:[1,0,1]
    v_pk_fma_f32 v[66:67], v[214:215], v[200:201], v[66:67] op_sel_hi:[1,0,1]
    v_pk_mul_f32 v[60:61], v[60:61], v[200:201] op_sel:[0,1] op_sel_hi:[1,1]
    v_pk_mul_f32 v[62:63], v[62:63], v[200:201] op_sel:[0,1] op_sel_hi:[1,1]
    v_pk_mul_f32 v[64:65], v[64:65], v[200:201] op_sel:[0,1] op_sel_hi:[1,1]
    v_pk_mul_f32 v[66:67], v[66:67], v[200:201] op_sel:[0,1] op_sel_hi:[1,1]
    v_exp_f32 v132, v60
    v_exp_f32 v133, v61
    v_exp_f32 v134, v62
    v_exp_f32 v135, v63
    v_exp_f32 v136, v64
    v_exp_f32 v137, v65
    v_exp_f32 v138, v66
    v_exp_f32 v139, v67
    v_pk_add_f32 v[132:133], v[132:133], 1.0 op_sel_hi:[1,0]
    v_pk_add_f32 v[134:135], v[134:135], 1.0 op_sel_hi:[1,0]
    v_pk_add_f32 v[136:137], v[136:137], 1.0 op_sel_hi:[1,0]
    v_pk_add_f32 v[138:139], v[138:139], 1.0 op_sel_hi:[1,0]
    v_rcp_f32 v132, v132
    v_rcp_f32 v133, v133
    v_rcp_f32 v134, v134
    v_rcp_f32 v135, v135
    v_rcp_f32 v136, v136
    v_rcp_f32 v137, v137
    v_rcp_f32 v138, v138
    v_rcp_f32 v139, v139
    v_pk_mul_f32 v[132:133], v[132:133], v[60:61]
    v_pk_mul_f32 v[134:135], v[134:135], v[62:63]
    v_pk_mul_f32 v[136:137], v[136:137], v[64:65]
    v_pk_mul_f32 v[138:139], v[138:139], v[66:67]
    v_cvt_pk_bf16_f32 v140, v132, v133
    v_cvt_pk_bf16_f32 v141, v134, v135
    v_cvt_pk_bf16_f32 v142, v136, v137
    v_cvt_pk_bf16_f32 v143, v138, v139
    buffer_store_dwordx4 v[140:143], v9, s[32:35], s81 offen sc1
    v_pk_fma_f32 v[84:85], v[208:209], v[202:203], v[84:85] op_sel_hi:[1,0,1]
    v_pk_fma_f32 v[86:87], v[210:211], v[202:203], v[86:87] op_sel_hi:[1,0,1]
    v_pk_fma_f32 v[88:89], v[212:213], v[202:203], v[88:89] op_sel_hi:[1,0,1]
    v_pk_fma_f32 v[90:91], v[214:215], v[202:203], v[90:91] op_sel_hi:[1,0,1]
    v_pk_mul_f32 v[84:85], v[84:85], v[202:203] op_sel:[0,1] op_sel_hi:[1,1]
    v_pk_mul_f32 v[86:87], v[86:87], v[202:203] op_sel:[0,1] op_sel_hi:[1,1]
    v_pk_mul_f32 v[88:89], v[88:89], v[202:203] op_sel:[0,1] op_sel_hi:[1,1]
    v_pk_mul_f32 v[90:91], v[90:91], v[202:203] op_sel:[0,1] op_sel_hi:[1,1]
    v_exp_f32 v132, v84
    v_exp_f32 v133, v85
    v_exp_f32 v134, v86
    v_exp_f32 v135, v87
    v_exp_f32 v136, v88
    v_exp_f32 v137, v89
    v_exp_f32 v138, v90
    v_exp_f32 v139, v91
    v_pk_add_f32 v[132:133], v[132:133], 1.0 op_sel_hi:[1,0]
    v_pk_add_f32 v[134:135], v[134:135], 1.0 op_sel_hi:[1,0]
    v_pk_add_f32 v[136:137], v[136:137], 1.0 op_sel_hi:[1,0]
    v_pk_add_f32 v[138:139], v[138:139], 1.0 op_sel_hi:[1,0]
    v_rcp_f32 v132, v132
    v_rcp_f32 v133, v133
    v_rcp_f32 v134, v134
    v_rcp_f32 v135, v135
    v_rcp_f32 v136, v136
    v_rcp_f32 v137, v137
    v_rcp_f32 v138, v138
    v_rcp_f32 v139, v139
    v_pk_mul_f32 v[132:133], v[132:133], v[84:85]
    v_pk_mul_f32 v[134:135], v[134:135], v[86:87]
    v_pk_mul_f32 v[136:137], v[136:137], v[88:89]
    v_pk_mul_f32 v[138:139], v[138:139], v[90:91]
    v_cvt_pk_bf16_f32 v144, v132, v133
    v_cvt_pk_bf16_f32 v145, v134, v135
    v_cvt_pk_bf16_f32 v146, v136, v137
    v_cvt_pk_bf16_f32 v147, v138, v139
    buffer_store_dwordx4 v[144:147], v9, s[32:35], s82 offen sc1
    v_pk_fma_f32 v[108:109], v[208:209], v[204:205], v[108:109] op_sel_hi:[1,0,1]
    v_pk_fma_f32 v[110:111], v[210:211], v[204:205], v[110:111] op_sel_hi:[1,0,1]
    v_pk_fma_f32 v[112:113], v[212:213], v[204:205], v[112:113] op_sel_hi:[1,0,1]
    v_pk_fma_f32 v[114:115], v[214:215], v[204:205], v[114:115] op_sel_hi:[1,0,1]
    v_pk_mul_f32 v[108:109], v[108:109], v[204:205] op_sel:[0,1] op_sel_hi:[1,1]
    v_pk_mul_f32 v[110:111], v[110:111], v[204:205] op_sel:[0,1] op_sel_hi:[1,1]
    v_pk_mul_f32 v[112:113], v[112:113], v[204:205] op_sel:[0,1] op_sel_hi:[1,1]
    v_pk_mul_f32 v[114:115], v[114:115], v[204:205] op_sel:[0,1] op_sel_hi:[1,1]
    v_exp_f32 v132, v108
    v_exp_f32 v133, v109
    v_exp_f32 v134, v110
    v_exp_f32 v135, v111
    v_exp_f32 v136, v112
    v_exp_f32 v137, v113
    v_exp_f32 v138, v114
    v_exp_f32 v139, v115
    v_pk_add_f32 v[132:133], v[132:133], 1.0 op_sel_hi:[1,0]
    v_pk_add_f32 v[134:135], v[134:135], 1.0 op_sel_hi:[1,0]
    v_pk_add_f32 v[136:137], v[136:137], 1.0 op_sel_hi:[1,0]
    v_pk_add_f32 v[138:139], v[138:139], 1.0 op_sel_hi:[1,0]
    v_rcp_f32 v132, v132
    v_rcp_f32 v133, v133
    v_rcp_f32 v134, v134
    v_rcp_f32 v135, v135
    v_rcp_f32 v136, v136
    v_rcp_f32 v137, v137
    v_rcp_f32 v138, v138
    v_rcp_f32 v139, v139
    v_pk_mul_f32 v[132:133], v[132:133], v[108:109]
    v_pk_mul_f32 v[134:135], v[134:135], v[110:111]
    v_pk_mul_f32 v[136:137], v[136:137], v[112:113]
    v_pk_mul_f32 v[138:139], v[138:139], v[114:115]
    v_cvt_pk_bf16_f32 v140, v132, v133
    v_cvt_pk_bf16_f32 v141, v134, v135
    v_cvt_pk_bf16_f32 v142, v136, v137
    v_cvt_pk_bf16_f32 v143, v138, v139
    buffer_store_dwordx4 v[140:143], v9, s[32:35], s83 offen sc1
    v_add_u32 v9, 18432, v9
    v_pk_fma_f32 v[20:21], v[216:217], v[196:197], v[20:21] op_sel_hi:[1,0,1]
    v_pk_fma_f32 v[22:23], v[218:219], v[196:197], v[22:23] op_sel_hi:[1,0,1]
    v_pk_fma_f32 v[24:25], v[220:221], v[196:197], v[24:25] op_sel_hi:[1,0,1]
    v_pk_fma_f32 v[26:27], v[222:223], v[196:197], v[26:27] op_sel_hi:[1,0,1]
    v_pk_mul_f32 v[20:21], v[20:21], v[196:197] op_sel:[0,1] op_sel_hi:[1,1]
    v_pk_mul_f32 v[22:23], v[22:23], v[196:197] op_sel:[0,1] op_sel_hi:[1,1]
    v_pk_mul_f32 v[24:25], v[24:25], v[196:197] op_sel:[0,1] op_sel_hi:[1,1]
    v_pk_mul_f32 v[26:27], v[26:27], v[196:197] op_sel:[0,1] op_sel_hi:[1,1]
    v_exp_f32 v132, v20
    v_exp_f32 v133, v21
    v_exp_f32 v134, v22
    v_exp_f32 v135, v23
    v_exp_f32 v136, v24
    v_exp_f32 v137, v25
    v_exp_f32 v138, v26
    v_exp_f32 v139, v27
    v_pk_add_f32 v[132:133], v[132:133], 1.0 op_sel_hi:[1,0]
    v_pk_add_f32 v[134:135], v[134:135], 1.0 op_sel_hi:[1,0]
    v_pk_add_f32 v[136:137], v[136:137], 1.0 op_sel_hi:[1,0]
    v_pk_add_f32 v[138:139], v[138:139], 1.0 op_sel_hi:[1,0]
    v_rcp_f32 v132, v132
    v_rcp_f32 v133, v133
    v_rcp_f32 v134, v134
    v_rcp_f32 v135, v135
    v_rcp_f32 v136, v136
    v_rcp_f32 v137, v137
    v_rcp_f32 v138, v138
    v_rcp_f32 v139, v139
    v_pk_mul_f32 v[132:133], v[132:133], v[20:21]
    v_pk_mul_f32 v[134:135], v[134:135], v[22:23]
    v_pk_mul_f32 v[136:137], v[136:137], v[24:25]
    v_pk_mul_f32 v[138:139], v[138:139], v[26:27]
    v_cvt_pk_bf16_f32 v144, v132, v133
    v_cvt_pk_bf16_f32 v145, v134, v135
    v_cvt_pk_bf16_f32 v146, v136, v137
    v_cvt_pk_bf16_f32 v147, v138, v139
    buffer_store_dwordx4 v[144:147], v9, s[32:35], s79 offen sc1
    v_pk_fma_f32 v[44:45], v[216:217], v[198:199], v[44:45] op_sel_hi:[1,0,1]
    v_pk_fma_f32 v[46:47], v[218:219], v[198:199], v[46:47] op_sel_hi:[1,0,1]
    v_pk_fma_f32 v[48:49], v[220:221], v[198:199], v[48:49] op_sel_hi:[1,0,1]
    v_pk_fma_f32 v[50:51], v[222:223], v[198:199], v[50:51] op_sel_hi:[1,0,1]
    v_pk_mul_f32 v[44:45], v[44:45], v[198:199] op_sel:[0,1] op_sel_hi:[1,1]
    v_pk_mul_f32 v[46:47], v[46:47], v[198:199] op_sel:[0,1] op_sel_hi:[1,1]
    v_pk_mul_f32 v[48:49], v[48:49], v[198:199] op_sel:[0,1] op_sel_hi:[1,1]
    v_pk_mul_f32 v[50:51], v[50:51], v[198:199] op_sel:[0,1] op_sel_hi:[1,1]
    v_exp_f32 v132, v44
    v_exp_f32 v133, v45
    v_exp_f32 v134, v46
    v_exp_f32 v135, v47
    v_exp_f32 v136, v48
    v_exp_f32 v137, v49
    v_exp_f32 v138, v50
    v_exp_f32 v139, v51
    v_pk_add_f32 v[132:133], v[132:133], 1.0 op_sel_hi:[1,0]
    v_pk_add_f32 v[134:135], v[134:135], 1.0 op_sel_hi:[1,0]
    v_pk_add_f32 v[136:137], v[136:137], 1.0 op_sel_hi:[1,0]
    v_pk_add_f32 v[138:139], v[138:139], 1.0 op_sel_hi:[1,0]
    v_rcp_f32 v132, v132
    v_rcp_f32 v133, v133
    v_rcp_f32 v134, v134
    v_rcp_f32 v135, v135
    v_rcp_f32 v136, v136
    v_rcp_f32 v137, v137
    v_rcp_f32 v138, v138
    v_rcp_f32 v139, v139
    v_pk_mul_f32 v[132:133], v[132:133], v[44:45]
    v_pk_mul_f32 v[134:135], v[134:135], v[46:47]
    v_pk_mul_f32 v[136:137], v[136:137], v[48:49]
    v_pk_mul_f32 v[138:139], v[138:139], v[50:51]
    v_cvt_pk_bf16_f32 v140, v132, v133
    v_cvt_pk_bf16_f32 v141, v134, v135
    v_cvt_pk_bf16_f32 v142, v136, v137
    v_cvt_pk_bf16_f32 v143, v138, v139
    buffer_store_dwordx4 v[140:143], v9, s[32:35], s80 offen sc1
    v_pk_fma_f32 v[68:69], v[216:217], v[200:201], v[68:69] op_sel_hi:[1,0,1]
    v_pk_fma_f32 v[70:71], v[218:219], v[200:201], v[70:71] op_sel_hi:[1,0,1]
    v_pk_fma_f32 v[72:73], v[220:221], v[200:201], v[72:73] op_sel_hi:[1,0,1]
    v_pk_fma_f32 v[74:75], v[222:223], v[200:201], v[74:75] op_sel_hi:[1,0,1]
    v_pk_mul_f32 v[68:69], v[68:69], v[200:201] op_sel:[0,1] op_sel_hi:[1,1]
    v_pk_mul_f32 v[70:71], v[70:71], v[200:201] op_sel:[0,1] op_sel_hi:[1,1]
    v_pk_mul_f32 v[72:73], v[72:73], v[200:201] op_sel:[0,1] op_sel_hi:[1,1]
    v_pk_mul_f32 v[74:75], v[74:75], v[200:201] op_sel:[0,1] op_sel_hi:[1,1]
    v_exp_f32 v132, v68
    v_exp_f32 v133, v69
    v_exp_f32 v134, v70
    v_exp_f32 v135, v71
    v_exp_f32 v136, v72
    v_exp_f32 v137, v73
    v_exp_f32 v138, v74
    v_exp_f32 v139, v75
    v_pk_add_f32 v[132:133], v[132:133], 1.0 op_sel_hi:[1,0]
    v_pk_add_f32 v[134:135], v[134:135], 1.0 op_sel_hi:[1,0]
    v_pk_add_f32 v[136:137], v[136:137], 1.0 op_sel_hi:[1,0]
    v_pk_add_f32 v[138:139], v[138:139], 1.0 op_sel_hi:[1,0]
    v_rcp_f32 v132, v132
    v_rcp_f32 v133, v133
    v_rcp_f32 v134, v134
    v_rcp_f32 v135, v135
    v_rcp_f32 v136, v136
    v_rcp_f32 v137, v137
    v_rcp_f32 v138, v138
    v_rcp_f32 v139, v139
    v_pk_mul_f32 v[132:133], v[132:133], v[68:69]
    v_pk_mul_f32 v[134:135], v[134:135], v[70:71]
    v_pk_mul_f32 v[136:137], v[136:137], v[72:73]
    v_pk_mul_f32 v[138:139], v[138:139], v[74:75]
    v_cvt_pk_bf16_f32 v144, v132, v133
    v_cvt_pk_bf16_f32 v145, v134, v135
    v_cvt_pk_bf16_f32 v146, v136, v137
    v_cvt_pk_bf16_f32 v147, v138, v139
    buffer_store_dwordx4 v[144:147], v9, s[32:35], s81 offen sc1
    v_pk_fma_f32 v[92:93], v[216:217], v[202:203], v[92:93] op_sel_hi:[1,0,1]
    v_pk_fma_f32 v[94:95], v[218:219], v[202:203], v[94:95] op_sel_hi:[1,0,1]
    v_pk_fma_f32 v[96:97], v[220:221], v[202:203], v[96:97] op_sel_hi:[1,0,1]
    v_pk_fma_f32 v[98:99], v[222:223], v[202:203], v[98:99] op_sel_hi:[1,0,1]
    v_pk_mul_f32 v[92:93], v[92:93], v[202:203] op_sel:[0,1] op_sel_hi:[1,1]
    v_pk_mul_f32 v[94:95], v[94:95], v[202:203] op_sel:[0,1] op_sel_hi:[1,1]
    v_pk_mul_f32 v[96:97], v[96:97], v[202:203] op_sel:[0,1] op_sel_hi:[1,1]
    v_pk_mul_f32 v[98:99], v[98:99], v[202:203] op_sel:[0,1] op_sel_hi:[1,1]
    v_exp_f32 v132, v92
    v_exp_f32 v133, v93
    v_exp_f32 v134, v94
    v_exp_f32 v135, v95
    v_exp_f32 v136, v96
    v_exp_f32 v137, v97
    v_exp_f32 v138, v98
    v_exp_f32 v139, v99
    s_waitcnt vmcnt(3)
    s_mov_b64 exec, 1
    ds_add_rtn_u32 v254, v253, v252 offset:20
    s_mov_b64 exec, -1
    v_pk_add_f32 v[132:133], v[132:133], 1.0 op_sel_hi:[1,0]
    v_pk_add_f32 v[134:135], v[134:135], 1.0 op_sel_hi:[1,0]
    v_pk_add_f32 v[136:137], v[136:137], 1.0 op_sel_hi:[1,0]
    v_pk_add_f32 v[138:139], v[138:139], 1.0 op_sel_hi:[1,0]
    v_rcp_f32 v132, v132
    v_rcp_f32 v133, v133
    v_rcp_f32 v134, v134
    v_rcp_f32 v135, v135
    v_rcp_f32 v136, v136
    v_rcp_f32 v137, v137
    v_rcp_f32 v138, v138
    v_rcp_f32 v139, v139
    s_waitcnt lgkmcnt(0)
    v_readfirstlane_b32 s85, v254
    s_nop 0
    s_cmp_eq_u32 s85, 3
    s_cselect_b32 s85, s71, 2130706432
    s_nop 1
    buffer_store_dword v252, v251, s[36:39], s85 offen offset:0 sc1
    v_pk_mul_f32 v[132:133], v[132:133], v[92:93]
    v_pk_mul_f32 v[134:135], v[134:135], v[94:95]
    v_pk_mul_f32 v[136:137], v[136:137], v[96:97]
    v_pk_mul_f32 v[138:139], v[138:139], v[98:99]
    v_cvt_pk_bf16_f32 v140, v132, v133
    v_cvt_pk_bf16_f32 v141, v134, v135
    v_cvt_pk_bf16_f32 v142, v136, v137
    v_cvt_pk_bf16_f32 v143, v138, v139
    buffer_store_dwordx4 v[140:143], v9, s[32:35], s82 offen sc1
    v_pk_fma_f32 v[116:117], v[216:217], v[204:205], v[116:117] op_sel_hi:[1,0,1]
    v_pk_fma_f32 v[118:119], v[218:219], v[204:205], v[118:119] op_sel_hi:[1,0,1]
    v_pk_fma_f32 v[120:121], v[220:221], v[204:205], v[120:121] op_sel_hi:[1,0,1]
    v_pk_fma_f32 v[122:123], v[222:223], v[204:205], v[122:123] op_sel_hi:[1,0,1]
    v_pk_mul_f32 v[116:117], v[116:117], v[204:205] op_sel:[0,1] op_sel_hi:[1,1]
    v_pk_mul_f32 v[118:119], v[118:119], v[204:205] op_sel:[0,1] op_sel_hi:[1,1]
    v_pk_mul_f32 v[120:121], v[120:121], v[204:205] op_sel:[0,1] op_sel_hi:[1,1]
    v_pk_mul_f32 v[122:123], v[122:123], v[204:205] op_sel:[0,1] op_sel_hi:[1,1]
    v_exp_f32 v132, v116
    v_exp_f32 v133, v117
    v_exp_f32 v134, v118
    v_exp_f32 v135, v119
    v_exp_f32 v136, v120
    v_exp_f32 v137, v121
    v_exp_f32 v138, v122
    v_exp_f32 v139, v123
    v_pk_add_f32 v[132:133], v[132:133], 1.0 op_sel_hi:[1,0]
    v_pk_add_f32 v[134:135], v[134:135], 1.0 op_sel_hi:[1,0]
L_pad_2:
    s_cbranch_execz L_tramp
    v_pk_add_f32 v[136:137], v[136:137], 1.0 op_sel_hi:[1,0]
    v_pk_add_f32 v[138:139], v[138:139], 1.0 op_sel_hi:[1,0]
    v_rcp_f32 v132, v132
    v_rcp_f32 v133, v133
    v_rcp_f32 v134, v134
    v_rcp_f32 v135, v135
    v_rcp_f32 v136, v136
    v_rcp_f32 v137, v137
    v_rcp_f32 v138, v138
    v_rcp_f32 v139, v139
    v_pk_mul_f32 v[132:133], v[132:133], v[116:117]
    v_pk_mul_f32 v[134:135], v[134:135], v[118:119]
    v_pk_mul_f32 v[136:137], v[136:137], v[120:121]
    v_pk_mul_f32 v[138:139], v[138:139], v[122:123]
    v_cvt_pk_bf16_f32 v144, v132, v133
    v_cvt_pk_bf16_f32 v145, v134, v135
    v_cvt_pk_bf16_f32 v146, v136, v137
    v_cvt_pk_bf16_f32 v147, v138, v139
    buffer_store_dwordx4 v[144:147], v9, s[32:35], s83 offen sc1
    v_add_u32 v9, 18432, v9
    v_pk_fma_f32 v[28:29], v[224:225], v[196:197], v[28:29] op_sel_hi:[1,0,1]
    v_pk_fma_f32 v[30:31], v[226:227], v[196:197], v[30:31] op_sel_hi:[1,0,1]
    v_pk_fma_f32 v[32:33], v[228:229], v[196:197], v[32:33] op_sel_hi:[1,0,1]
    v_pk_fma_f32 v[34:35], v[230:231], v[196:197], v[34:35] op_sel_hi:[1,0,1]
    v_pk_mul_f32 v[28:29], v[28:29], v[196:197] op_sel:[0,1] op_sel_hi:[1,1]
    v_pk_mul_f32 v[30:31], v[30:31], v[196:197] op_sel:[0,1] op_sel_hi:[1,1]
    v_pk_mul_f32 v[32:33], v[32:33], v[196:197] op_sel:[0,1] op_sel_hi:[1,1]
    v_pk_mul_f32 v[34:35], v[34:35], v[196:197] op_sel:[0,1] op_sel_hi:[1,1]
    v_exp_f32 v132, v28
    v_exp_f32 v133, v29
    v_exp_f32 v134, v30
    v_exp_f32 v135, v31
    v_exp_f32 v136, v32
    v_exp_f32 v137, v33
    v_exp_f32 v138, v34
    v_exp_f32 v139, v35
    v_pk_add_f32 v[132:133], v[132:133], 1.0 op_sel_hi:[1,0]
    v_pk_add_f32 v[134:135], v[134:135], 1.0 op_sel_hi:[1,0]
    v_pk_add_f32 v[136:137], v[136:137], 1.0 op_sel_hi:[1,0]
    v_pk_add_f32 v[138:139], v[138:139], 1.0 op_sel_hi:[1,0]
    v_rcp_f32 v132, v132
    v_rcp_f32 v133, v133
    v_rcp_f32 v134, v134
    v_rcp_f32 v135, v135
    v_rcp_f32 v136, v136
    v_rcp_f32 v137, v137
    v_rcp_f32 v138, v138
    v_rcp_f32 v139, v139
    v_pk_mul_f32 v[132:133], v[132:133], v[28:29]
    v_pk_mul_f32 v[134:135], v[134:135], v[30:31]
    v_pk_mul_f32 v[136:137], v[136:137], v[32:33]
    v_pk_mul_f32 v[138:139], v[138:139], v[34:35]
    v_cvt_pk_bf16_f32 v140, v132, v133
    v_cvt_pk_bf16_f32 v141, v134, v135
    v_cvt_pk_bf16_f32 v142, v136, v137
    v_cvt_pk_bf16_f32 v143, v138, v139
    buffer_store_dwordx4 v[140:143], v9, s[32:35], s79 offen sc1
    v_pk_fma_f32 v[52:53], v[224:225], v[198:199], v[52:53] op_sel_hi:[1,0,1]
    v_pk_fma_f32 v[54:55], v[226:227], v[198:199], v[54:55] op_sel_hi:[1,0,1]
    v_pk_fma_f32 v[56:57], v[228:229], v[198:199], v[56:57] op_sel_hi:[1,0,1]
    v_pk_fma_f32 v[58:59], v[230:231], v[198:199], v[58:59] op_sel_hi:[1,0,1]
    v_pk_mul_f32 v[52:53], v[52:53], v[198:199] op_sel:[0,1] op_sel_hi:[1,1]
    v_pk_mul_f32 v[54:55], v[54:55], v[198:199] op_sel:[0,1] op_sel_hi:[1,1]
    v_pk_mul_f32 v[56:57], v[56:57], v[198:199] op_sel:[0,1] op_sel_hi:[1,1]
    v_pk_mul_f32 v[58:59], v[58:59], v[198:199] op_sel:[0,1] op_sel_hi:[1,1]
    v_exp_f32 v132, v52
    v_exp_f32 v133, v53
    v_exp_f32 v134, v54
    v_exp_f32 v135, v55
    v_exp_f32 v136, v56
    v_exp_f32 v137, v57
    v_exp_f32 v138, v58
    v_exp_f32 v139, v59
    v_pk_add_f32 v[132:133], v[132:133], 1.0 op_sel_hi:[1,0]
    v_pk_add_f32 v[134:135], v[134:135], 1.0 op_sel_hi:[1,0]
    v_pk_add_f32 v[136:137], v[136:137], 1.0 op_sel_hi:[1,0]
    v_pk_add_f32 v[138:139], v[138:139], 1.0 op_sel_hi:[1,0]
    v_rcp_f32 v132, v132
    v_rcp_f32 v133, v133
    v_rcp_f32 v134, v134
    v_rcp_f32 v135, v135
    v_rcp_f32 v136, v136
    v_rcp_f32 v137, v137
    v_rcp_f32 v138, v138
    v_rcp_f32 v139, v139
    v_pk_mul_f32 v[132:133], v[132:133], v[52:53]
    v_pk_mul_f32 v[134:135], v[134:135], v[54:55]
    v_pk_mul_f32 v[136:137], v[136:137], v[56:57]
    v_pk_mul_f32 v[138:139], v[138:139], v[58:59]
    v_cvt_pk_bf16_f32 v144, v132, v133
    v_cvt_pk_bf16_f32 v145, v134, v135
    v_cvt_pk_bf16_f32 v146, v136, v137
    v_cvt_pk_bf16_f32 v147, v138, v139
    buffer_store_dwordx4 v[144:147], v9, s[32:35], s80 offen sc1
    v_pk_fma_f32 v[76:77], v[224:225], v[200:201], v[76:77] op_sel_hi:[1,0,1]
    v_pk_fma_f32 v[78:79], v[226:227], v[200:201], v[78:79] op_sel_hi:[1,0,1]
    v_pk_fma_f32 v[80:81], v[228:229], v[200:201], v[80:81] op_sel_hi:[1,0,1]
    v_pk_fma_f32 v[82:83], v[230:231], v[200:201], v[82:83] op_sel_hi:[1,0,1]
    v_pk_mul_f32 v[76:77], v[76:77], v[200:201] op_sel:[0,1] op_sel_hi:[1,1]
    v_pk_mul_f32 v[78:79], v[78:79], v[200:201] op_sel:[0,1] op_sel_hi:[1,1]
    v_pk_mul_f32 v[80:81], v[80:81], v[200:201] op_sel:[0,1] op_sel_hi:[1,1]
    v_pk_mul_f32 v[82:83], v[82:83], v[200:201] op_sel:[0,1] op_sel_hi:[1,1]
    v_exp_f32 v132, v76
    v_exp_f32 v133, v77
    v_exp_f32 v134, v78
    v_exp_f32 v135, v79
    v_exp_f32 v136, v80
    v_exp_f32 v137, v81
    v_exp_f32 v138, v82
    v_exp_f32 v139, v83
    v_pk_add_f32 v[132:133], v[132:133], 1.0 op_sel_hi:[1,0]
    v_pk_add_f32 v[134:135], v[134:135], 1.0 op_sel_hi:[1,0]
    v_pk_add_f32 v[136:137], v[136:137], 1.0 op_sel_hi:[1,0]
    v_pk_add_f32 v[138:139], v[138:139], 1.0 op_sel_hi:[1,0]
    v_rcp_f32 v132, v132
    v_rcp_f32 v133, v133
    v_rcp_f32 v134, v134
    v_rcp_f32 v135, v135
    v_rcp_f32 v136, v136
    v_rcp_f32 v137, v137
    v_rcp_f32 v138, v138
    v_rcp_f32 v139, v139
    v_pk_mul_f32 v[132:133], v[132:133], v[76:77]
    v_pk_mul_f32 v[134:135], v[134:135], v[78:79]
    v_pk_mul_f32 v[136:137], v[136:137], v[80:81]
    v_pk_mul_f32 v[138:139], v[138:139], v[82:83]
    v_cvt_pk_bf16_f32 v140, v132, v133
    v_cvt_pk_bf16_f32 v141, v134, v135
    v_cvt_pk_bf16_f32 v142, v136, v137
    v_cvt_pk_bf16_f32 v143, v138, v139
    buffer_store_dwordx4 v[140:143], v9, s[32:35], s81 offen sc1
    v_pk_fma_f32 v[100:101], v[224:225], v[202:203], v[100:101] op_sel_hi:[1,0,1]
    v_pk_fma_f32 v[102:103], v[226:227], v[202:203], v[102:103] op_sel_hi:[1,0,1]
    v_pk_fma_f32 v[104:105], v[228:229], v[202:203], v[104:105] op_sel_hi:[1,0,1]
    v_pk_fma_f32 v[106:107], v[230:231], v[202:203], v[106:107] op_sel_hi:[1,0,1]
    v_pk_mul_f32 v[100:101], v[100:101], v[202:203] op_sel:[0,1] op_sel_hi:[1,1]
    v_pk_mul_f32 v[102:103], v[102:103], v[202:203] op_sel:[0,1] op_sel_hi:[1,1]
    v_pk_mul_f32 v[104:105], v[104:105], v[202:203] op_sel:[0,1] op_sel_hi:[1,1]
    v_pk_mul_f32 v[106:107], v[106:107], v[202:203] op_sel:[0,1] op_sel_hi:[1,1]
    v_exp_f32 v132, v100
    v_exp_f32 v133, v101
    v_exp_f32 v134, v102
    v_exp_f32 v135, v103
    v_exp_f32 v136, v104
    v_exp_f32 v137, v105
    v_exp_f32 v138, v106
    v_exp_f32 v139, v107
    v_pk_add_f32 v[132:133], v[132:133], 1.0 op_sel_hi:[1,0]
    v_pk_add_f32 v[134:135], v[134:135], 1.0 op_sel_hi:[1,0]
    v_pk_add_f32 v[136:137], v[136:137], 1.0 op_sel_hi:[1,0]
    v_pk_add_f32 v[138:139], v[138:139], 1.0 op_sel_hi:[1,0]
    v_rcp_f32 v132, v132
    v_rcp_f32 v133, v133
    v_rcp_f32 v134, v134
    v_rcp_f32 v135, v135
    v_rcp_f32 v136, v136
    v_rcp_f32 v137, v137
    v_rcp_f32 v138, v138
    v_rcp_f32 v139, v139
    v_pk_mul_f32 v[132:133], v[132:133], v[100:101]
    v_pk_mul_f32 v[134:135], v[134:135], v[102:103]
    v_pk_mul_f32 v[136:137], v[136:137], v[104:105]
    v_pk_mul_f32 v[138:139], v[138:139], v[106:107]
    v_cvt_pk_bf16_f32 v144, v132, v133
    v_cvt_pk_bf16_f32 v145, v134, v135
    v_cvt_pk_bf16_f32 v146, v136, v137
    v_cvt_pk_bf16_f32 v147, v138, v139
    buffer_store_dwordx4 v[144:147], v9, s[32:35], s82 offen sc1
    v_pk_fma_f32 v[124:125], v[224:225], v[204:205], v[124:125] op_sel_hi:[1,0,1]
    v_pk_fma_f32 v[126:127], v[226:227], v[204:205], v[126:127] op_sel_hi:[1,0,1]
    v_pk_fma_f32 v[128:129], v[228:229], v[204:205], v[128:129] op_sel_hi:[1,0,1]
    v_pk_fma_f32 v[130:131], v[230:231], v[204:205], v[130:131] op_sel_hi:[1,0,1]
    v_pk_mul_f32 v[124:125], v[124:125], v[204:205] op_sel:[0,1] op_sel_hi:[1,1]
    v_pk_mul_f32 v[126:127], v[126:127], v[204:205] op_sel:[0,1] op_sel_hi:[1,1]
    v_pk_mul_f32 v[128:129], v[128:129], v[204:205] op_sel:[0,1] op_sel_hi:[1,1]
    v_pk_mul_f32 v[130:131], v[130:131], v[204:205] op_sel:[0,1] op_sel_hi:[1,1]
    v_exp_f32 v132, v124
    v_exp_f32 v133, v125
    v_exp_f32 v134, v126
    v_exp_f32 v135, v127
    v_exp_f32 v136, v128
    v_exp_f32 v137, v129
    v_exp_f32 v138, v130
    v_exp_f32 v139, v131
    v_pk_add_f32 v[132:133], v[132:133], 1.0 op_sel_hi:[1,0]
    v_pk_add_f32 v[134:135], v[134:135], 1.0 op_sel_hi:[1,0]
    v_pk_add_f32 v[136:137], v[136:137], 1.0 op_sel_hi:[1,0]
    v_pk_add_f32 v[138:139], v[138:139], 1.0 op_sel_hi:[1,0]
    v_rcp_f32 v132, v132
    v_rcp_f32 v133, v133
    v_rcp_f32 v134, v134
    v_rcp_f32 v135, v135
    v_rcp_f32 v136, v136
    v_rcp_f32 v137, v137
    v_rcp_f32 v138, v138
    v_rcp_f32 v139, v139
    v_pk_mul_f32 v[132:133], v[132:133], v[124:125]
    v_pk_mul_f32 v[134:135], v[134:135], v[126:127]
    v_pk_mul_f32 v[136:137], v[136:137], v[128:129]
    v_pk_mul_f32 v[138:139], v[138:139], v[130:131]
    v_cvt_pk_bf16_f32 v140, v132, v133
    v_cvt_pk_bf16_f32 v141, v134, v135
    v_cvt_pk_bf16_f32 v142, v136, v137
    v_cvt_pk_bf16_f32 v143, v138, v139
    buffer_store_dwordx4 v[140:143], v9, s[32:35], s83 offen sc1
    s_cmp_eq_u32 s63, 0
    s_cbranch_scc1 L_nop2
L_c2:
L_pad_0:
    s_cbranch_execz L_tramp
    v_mov_b32 v13, 1
    v_mov_b32 v15, s3
    s_lshr_b32 s74, s56, 1
    s_and_b32 s75, s56, 1
    s_lshl1_add_u32 s72, s60, s74
    s_mul_i32 s72, s72, 222
    s_add_u32 s72, s72, s75
    s_lshl_b32 s72, s72, 10
    v_lshl_add_u32 v17, v0, 4, s72
    v_add_u32 v18, 75776, v17
    v_add_u32 v19, 75776, v18
    s_mov_b32 s76, 0
    s_waitcnt vmcnt(63)
    v_cmp_ne_u32 vcc, s3, v249
    s_nop 1
    s_cmp_lg_u64 vcc, 0
    s_cbranch_scc1 slow_2
    s_mov_b64 exec, 1
    ds_add_u32 v253, v15 offset:16
    s_mov_b64 exec, -1
    ds_read_b32 v8, v253 offset:16
    s_waitcnt lgkmcnt(0)
    v_readfirstlane_b32 s72, v8
    s_nop 0
    s_cmp_ge_u32 s72, 5
    s_cbranch_scc1 go_1
    s_waitcnt vmcnt(0)
    s_mov_b64 exec, 1
    ds_add_rtn_u32 v254, v253, v252 offset:28
    s_mov_b64 exec, -1
    s_waitcnt lgkmcnt(0)
    v_readfirstlane_b32 s85, v254
    s_nop 0
    s_cmp_eq_u32 s85, 3
    s_cselect_b32 s85, s71, 2130706432
    s_nop 1
    buffer_store_dword v252, v251, s[36:39], s85 offen offset:256 sc1
back_3:
    v_mov_b32 v13, 0
    s_mov_b32 s71, 2130706432
    ds_read_b32 v8, v253 offset:16
    s_waitcnt lgkmcnt(0)
    v_readfirstlane_b32 s85, v8
    s_nop 0
    s_cmp_lt_u32 s85, 5
    s_cbranch_scc1 lws_9
lwd_10:
go_1:
    buffer_load_dwordx4 v[120:123], v17, s[32:35], s76 offen offset:0 sc1
    buffer_load_dwordx4 v[124:127], v18, s[32:35], s76 offen offset:0 sc1
    buffer_load_dwordx4 v[128:131], v19, s[32:35], s76 offen offset:0 sc1
    buffer_load_dwordx4 v[132:135], v17, s[32:35], s76 offen offset:2048 sc1
    buffer_load_dwordx4 v[136:139], v18, s[32:35], s76 offen offset:2048 sc1
    buffer_load_dwordx4 v[140:143], v19, s[32:35], s76 offen offset:2048 sc1
    s_add_u32 s76, s76, 4096
    buffer_load_dwordx4 v[144:147], v17, s[32:35], s76 offen offset:0 sc1
    buffer_load_dwordx4 v[148:151], v18, s[32:35], s76 offen offset:0 sc1
    buffer_load_dwordx4 v[152:155], v19, s[32:35], s76 offen offset:0 sc1
    buffer_load_dwordx4 v[156:159], v17, s[32:35], s76 offen offset:2048 sc1
    buffer_load_dwordx4 v[160:163], v18, s[32:35], s76 offen offset:2048 sc1
    buffer_load_dwordx4 v[164:167], v19, s[32:35], s76 offen offset:2048 sc1
    v_lshrrev_b32 v1, 2, v0
    v_bfe_u32 v2, v1, 1, 2
    s_lshl_b32 s72, s75, 1
    v_xor_b32 v2, s72, v2
    v_lshlrev_b32 v1, 7, v1
    v_lshl_add_u32 v1, v2, 5, v1
    v_and_b32 v2, 3, v0
    v_lshl_add_u32 v1, v2, 3, v1
    s_lshl_b32 s72, s75, 12
    v_add_u32 v20, s72, v1
    v_xor_b32 v21, 32, v20
    v_xor_b32 v22, 64, v20
    v_xor_b32 v23, 96, v20
    ds_read_b64_tr_b16 v[180:181], v20 offset:49152
    ds_read_b64_tr_b16 v[182:183], v20 offset:51200
    ds_read_b64_tr_b16 v[184:185], v21 offset:49152
    ds_read_b64_tr_b16 v[186:187], v21 offset:51200
    ds_read_b64_tr_b16 v[188:189], v22 offset:49152
    ds_read_b64_tr_b16 v[190:191], v22 offset:51200
    ds_read_b64_tr_b16 v[192:193], v23 offset:49152
    ds_read_b64_tr_b16 v[194:195], v23 offset:51200
    s_lshl1_add_u32 s72, s60, s74
    s_mul_i32 s72, s72, 61440
    s_lshl1_add_u32 s73, s61, s75
    s_lshl_b32 s73, s73, 6
    s_add_u32 s72, s72, s73
    v_and_b32 v1, 15, v0
    v_bfe_u32 v2, v0, 4, 1
    v_lshrrev_b32 v3, 5, v0
    v_lshl_add_u32 v2, v2, 1, v3
    v_lshrrev_b32 v14, 2, v0
    v_and_b32 v3, 3, v0
    v_mul_u32_u24 v4, 1280, v14
    v_lshl_add_u32 v4, v3, 4, v4
    v_add_u32 v4, s72, v4
    v_lshl_add_u32 v3, s75, 2, v3
    v_and_b32 v5, 7, v14
    v_xor_b32 v3, v3, v5
    v_lshlrev_b32 v14, 7, v14
    v_lshl_add_u32 v14, v3, 4, v14
    s_lshl_b32 s72, s75, 2
    v_add_u32 v2, s72, v2
    v_and_b32 v3, 7, v1
    v_xor_b32 v2, v2, v3
    v_lshlrev_b32 v7, 7, v1
    v_lshl_add_u32 v7, v2, 4, v7
    s_mul_i32 s72, s74, 6144
    s_add_u32 s72, s72, 147456
    v_add_u32 v7, s72, v7
    v_add_u32 v14, s72, v14
    v_lshrrev_b32 v2, 5, v0
    v_lshl_add_u32 v2, s75, 2, v2
    v_xor_b32 v2, v2, v3
    v_lshlrev_b32 v7, 7, v1
    v_lshl_add_u32 v7, v2, 4, v7
    v_bfe_u32 v2, v0, 4, 1
    v_lshl_add_u32 v7, v2, 3, v7
    v_add_u32 v7, s72, v7
    v_xor_b32 v16, 32, v7
    v_lshrrev_b32 v1, 3, v0
    v_and_b32 v2, 7, v0
    v_xor_b32 v3, v1, v2
    v_lshl_add_u32 v1, s75, 3, v1
    v_lshlrev_b32 v14, 7, v1
    v_lshl_add_u32 v14, v3, 4, v14
    v_add_u32 v14, s72, v14
    s_lshl1_add_u32 s72, s60, s74
    s_mul_i32 s72, s72, 61440
    s_lshl_b32 s73, s61, 7
    s_add_u32 s72, s72, s73
    v_mul_u32_u24 v4, 1280, v1
    v_lshl_add_u32 v4, v2, 4, v4
    v_add_u32 v4, s72, v4
    s_xor_b32 s73, s56, 1
    s_mul_i32 s72, s56, 6144
    s_add_u32 s72, s72, 57344
    v_lshl_add_u32 v5, v0, 4, s72
    s_mul_i32 s72, s73, 6144
    s_add_u32 s72, s72, 57344
    v_lshl_add_u32 v6, v0, 4, s72
    s_lshl2_add_u32 s72, s56, 163744
    v_mov_b32 v10, s72
    s_lshl2_add_u32 s72, s73, 163744
    v_mov_b32 v11, s72
    s_mov_b32 s80, 0
    s_mov_b32 s81, 20480
    s_mov_b32 s82, 40960
    v_mov_b32 v12, 0xbfb8aa3b
    s_waitcnt vmcnt(9)
    s_mov_b64 exec, 1
    ds_add_rtn_u32 v254, v253, v13 offset:28
    s_mov_b64 exec, -1
    s_waitcnt lgkmcnt(7)
    v_mfma_f32_16x16x32_bf16 v[24:27], v[180:183], v[120:123], 0
    ds_read_b64_tr_b16 v[196:197], v20 offset:57344
    v_mfma_f32_16x16x32_bf16 v[40:43], v[180:183], v[124:127], 0
    ds_read_b64_tr_b16 v[198:199], v20 offset:59392
    v_mfma_f32_16x16x32_bf16 v[56:59], v[180:183], v[128:131], 0
    ds_read_b64_tr_b16 v[200:201], v21 offset:57344
    s_waitcnt lgkmcnt(8)
    v_mfma_f32_16x16x32_bf16 v[28:31], v[184:187], v[120:123], 0
    ds_read_b64_tr_b16 v[202:203], v21 offset:59392
    v_mfma_f32_16x16x32_bf16 v[44:47], v[184:187], v[124:127], 0
    ds_read_b64_tr_b16 v[204:205], v22 offset:57344
    v_mfma_f32_16x16x32_bf16 v[60:63], v[184:187], v[128:131], 0
    ds_read_b64_tr_b16 v[206:207], v22 offset:59392
    s_waitcnt lgkmcnt(9)
    v_mfma_f32_16x16x32_bf16 v[32:35], v[188:191], v[120:123], 0
    ds_read_b64_tr_b16 v[208:209], v23 offset:57344
    v_mfma_f32_16x16x32_bf16 v[48:51], v[188:191], v[124:127], 0
    ds_read_b64_tr_b16 v[210:211], v23 offset:59392
    v_mfma_f32_16x16x32_bf16 v[64:67], v[188:191], v[128:131], 0
    s_add_u32 s76, s76, 4096
    s_waitcnt lgkmcnt(9)
    v_mfma_f32_16x16x32_bf16 v[36:39], v[192:195], v[120:123], 0
    buffer_load_dwordx4 v[168:171], v17, s[32:35], s76 offen offset:0 sc1
    v_mfma_f32_16x16x32_bf16 v[52:55], v[192:195], v[124:127], 0
    buffer_load_dwordx4 v[172:175], v18, s[32:35], s76 offen offset:0 sc1
    v_mfma_f32_16x16x32_bf16 v[68:71], v[192:195], v[128:131], 0
    buffer_load_dwordx4 v[176:179], v19, s[32:35], s76 offen offset:0 sc1
    s_waitcnt lgkmcnt(8)
    v_readfirstlane_b32 s85, v254
    s_nop 0
    s_cmp_eq_u32 s85, 3
    s_cselect_b32 s85, s71, 2130706432
    s_nop 1
    buffer_store_dword v252, v251, s[36:39], s85 offen offset:256 sc1
    v_add_u32 v250, 256, v250
    buffer_load_dword v249, v250, s[36:39], 0 offen sc1
    s_waitcnt vmcnt(11)
    s_waitcnt lgkmcnt(6)
    v_mfma_f32_16x16x32_bf16 v[24:27], v[196:199], v[132:135], v[24:27]
    v_add_u32 v20, 65536, v20
    v_add_u32 v21, 65536, v21
    v_add_u32 v22, 65536, v22
    v_add_u32 v23, 65536, v23
    v_mfma_f32_16x16x32_bf16 v[40:43], v[196:199], v[136:139], v[40:43]
    ds_read_b64_tr_b16 v[180:181], v20 offset:0
    v_mfma_f32_16x16x32_bf16 v[56:59], v[196:199], v[140:143], v[56:59]
    ds_read_b64_tr_b16 v[182:183], v20 offset:2048
    s_waitcnt lgkmcnt(6)
    v_mfma_f32_16x16x32_bf16 v[28:31], v[200:203], v[132:135], v[28:31]
    ds_read_b64_tr_b16 v[184:185], v21 offset:0
    v_mfma_f32_16x16x32_bf16 v[44:47], v[200:203], v[136:139], v[44:47]
    ds_read_b64_tr_b16 v[186:187], v21 offset:2048
    v_mfma_f32_16x16x32_bf16 v[60:63], v[200:203], v[140:143], v[60:63]
    ds_read_b64_tr_b16 v[188:189], v22 offset:0
    s_waitcnt lgkmcnt(7)
    v_mfma_f32_16x16x32_bf16 v[32:35], v[204:207], v[132:135], v[32:35]
    ds_read_b64_tr_b16 v[190:191], v22 offset:2048
    v_mfma_f32_16x16x32_bf16 v[48:51], v[204:207], v[136:139], v[48:51]
    ds_read_b64_tr_b16 v[192:193], v23 offset:0
    v_mfma_f32_16x16x32_bf16 v[64:67], v[204:207], v[140:143], v[64:67]
    ds_read_b64_tr_b16 v[194:195], v23 offset:2048
    s_waitcnt lgkmcnt(8)
    v_mfma_f32_16x16x32_bf16 v[36:39], v[208:211], v[132:135], v[36:39]
    buffer_load_dwordx4 v[120:123], v17, s[32:35], s76 offen offset:2048 sc1
    v_mfma_f32_16x16x32_bf16 v[52:55], v[208:211], v[136:139], v[52:55]
    buffer_load_dwordx4 v[124:127], v18, s[32:35], s76 offen offset:2048 sc1
    v_mfma_f32_16x16x32_bf16 v[68:71], v[208:211], v[140:143], v[68:71]
    buffer_load_dwordx4 v[128:131], v19, s[32:35], s76 offen offset:2048 sc1
    s_waitcnt vmcnt(11)
    s_waitcnt lgkmcnt(6)
    v_mfma_f32_16x16x32_bf16 v[24:27], v[180:183], v[144:147], v[24:27]
    ds_read_b64_tr_b16 v[196:197], v20 offset:8192
    v_mfma_f32_16x16x32_bf16 v[40:43], v[180:183], v[148:151], v[40:43]
    ds_read_b64_tr_b16 v[198:199], v20 offset:10240
    v_mfma_f32_16x16x32_bf16 v[56:59], v[180:183], v[152:155], v[56:59]
    ds_read_b64_tr_b16 v[200:201], v21 offset:8192
    s_waitcnt lgkmcnt(7)
    v_mfma_f32_16x16x32_bf16 v[28:31], v[184:187], v[144:147], v[28:31]
    ds_read_b64_tr_b16 v[202:203], v21 offset:10240
    v_mfma_f32_16x16x32_bf16 v[44:47], v[184:187], v[148:151], v[44:47]
    ds_read_b64_tr_b16 v[204:205], v22 offset:8192
    v_mfma_f32_16x16x32_bf16 v[60:63], v[184:187], v[152:155], v[60:63]
    ds_read_b64_tr_b16 v[206:207], v22 offset:10240
    s_waitcnt lgkmcnt(8)
    v_mfma_f32_16x16x32_bf16 v[32:35], v[188:191], v[144:147], v[32:35]
    ds_read_b64_tr_b16 v[208:209], v23 offset:8192
    v_mfma_f32_16x16x32_bf16 v[48:51], v[188:191], v[148:151], v[48:51]
    ds_read_b64_tr_b16 v[210:211], v23 offset:10240
    v_mfma_f32_16x16x32_bf16 v[64:67], v[188:191], v[152:155], v[64:67]
    s_add_u32 s76, s76, 4096
    s_waitcnt lgkmcnt(8)
    v_mfma_f32_16x16x32_bf16 v[36:39], v[192:195], v[144:147], v[36:39]
    buffer_load_dwordx4 v[132:135], v17, s[32:35], s76 offen offset:0 sc1
    v_mfma_f32_16x16x32_bf16 v[52:55], v[192:195], v[148:151], v[52:55]
    buffer_load_dwordx4 v[136:139], v18, s[32:35], s76 offen offset:0 sc1
    v_mfma_f32_16x16x32_bf16 v[68:71], v[192:195], v[152:155], v[68:71]
    buffer_load_dwordx4 v[140:143], v19, s[32:35], s76 offen offset:0 sc1
    s_waitcnt vmcnt(11)
    s_waitcnt lgkmcnt(6)
    v_mfma_f32_16x16x32_bf16 v[24:27], v[196:199], v[156:159], v[24:27]
    ds_read_b64_tr_b16 v[180:181], v20 offset:16384
    v_mfma_f32_16x16x32_bf16 v[40:43], v[196:199], v[160:163], v[40:43]
    ds_read_b64_tr_b16 v[182:183], v20 offset:18432
    v_mfma_f32_16x16x32_bf16 v[56:59], v[196:199], v[164:167], v[56:59]
    ds_read_b64_tr_b16 v[184:185], v21 offset:16384
    s_waitcnt lgkmcnt(7)
    v_mfma_f32_16x16x32_bf16 v[28:31], v[200:203], v[156:159], v[28:31]
    ds_read_b64_tr_b16 v[186:187], v21 offset:18432
    v_mfma_f32_16x16x32_bf16 v[44:47], v[200:203], v[160:163], v[44:47]
    ds_read_b64_tr_b16 v[188:189], v22 offset:16384
    v_mfma_f32_16x16x32_bf16 v[60:63], v[200:203], v[164:167], v[60:63]
    ds_read_b64_tr_b16 v[190:191], v22 offset:18432
    s_waitcnt lgkmcnt(8)
    v_mfma_f32_16x16x32_bf16 v[32:35], v[204:207], v[156:159], v[32:35]
    ds_read_b64_tr_b16 v[192:193], v23 offset:16384
    v_mfma_f32_16x16x32_bf16 v[48:51], v[204:207], v[160:163], v[48:51]
    ds_read_b64_tr_b16 v[194:195], v23 offset:18432
    v_mfma_f32_16x16x32_bf16 v[64:67], v[204:207], v[164:167], v[64:67]
    buffer_load_dwordx4 v[144:147], v17, s[32:35], s76 offen offset:2048 sc1
    s_waitcnt lgkmcnt(8)
    v_mfma_f32_16x16x32_bf16 v[36:39], v[208:211], v[156:159], v[36:39]
    buffer_load_dwordx4 v[148:151], v18, s[32:35], s76 offen offset:2048 sc1
    v_mfma_f32_16x16x32_bf16 v[52:55], v[208:211], v[160:163], v[52:55]
    buffer_load_dwordx4 v[152:155], v19, s[32:35], s76 offen offset:2048 sc1
    v_mfma_f32_16x16x32_bf16 v[68:71], v[208:211], v[164:167], v[68:71]
    s_waitcnt vmcnt(9)
    v_cmp_ne_u32 vcc, s3, v249
    s_nop 1
    s_cmp_lg_u64 vcc, 0
    s_cbranch_scc1 pslow_12
pdone_13:
    s_mov_b64 exec, 1
    ds_add_u32 v253, v15 offset:16
    s_mov_b64 exec, -1
    s_waitcnt lgkmcnt(7)
    v_mfma_f32_16x16x32_bf16 v[24:27], v[180:183], v[168:171], v[24:27]
    s_add_u32 s76, s76, 4096
    buffer_load_dwordx4 v[156:159], v17, s[32:35], s76 offen offset:0 sc1
    v_mfma_f32_16x16x32_bf16 v[40:43], v[180:183], v[172:175], v[40:43]
    buffer_load_dwordx4 v[160:163], v18, s[32:35], s76 offen offset:0 sc1
    buffer_load_dwordx4 v[164:167], v19, s[32:35], s76 offen offset:0 sc1
    v_mfma_f32_16x16x32_bf16 v[56:59], v[180:183], v[176:179], v[56:59]
    s_waitcnt lgkmcnt(0)
    s_barrier
    v_mfma_f32_16x16x32_bf16 v[28:31], v[184:187], v[168:171], v[28:31]
    ds_read_b64_tr_b16 v[196:197], v20 offset:24576
    v_mfma_f32_16x16x32_bf16 v[44:47], v[184:187], v[172:175], v[44:47]
    ds_read_b64_tr_b16 v[198:199], v20 offset:26624
    v_mfma_f32_16x16x32_bf16 v[60:63], v[184:187], v[176:179], v[60:63]
    ds_read_b64_tr_b16 v[200:201], v21 offset:24576
    v_mfma_f32_16x16x32_bf16 v[32:35], v[188:191], v[168:171], v[32:35]
    ds_read_b64_tr_b16 v[202:203], v21 offset:26624
    v_mfma_f32_16x16x32_bf16 v[48:51], v[188:191], v[172:175], v[48:51]
    ds_read_b64_tr_b16 v[204:205], v22 offset:24576
    v_mfma_f32_16x16x32_bf16 v[64:67], v[188:191], v[176:179], v[64:67]
    ds_read_b64_tr_b16 v[206:207], v22 offset:26624
    v_mfma_f32_16x16x32_bf16 v[36:39], v[192:195], v[168:171], v[36:39]
    ds_read_b64_tr_b16 v[208:209], v23 offset:24576
    v_mfma_f32_16x16x32_bf16 v[52:55], v[192:195], v[172:175], v[52:55]
    ds_read_b64_tr_b16 v[210:211], v23 offset:26624
    v_mfma_f32_16x16x32_bf16 v[68:71], v[192:195], v[176:179], v[68:71]
    ds_read_b32 v9, v253 offset:16
    s_waitcnt lgkmcnt(0)
    v_readfirstlane_b32 s85, v9
    s_nop 0
    s_cmp_lt_u32 s85, 6
    s_cbranch_scc1 lws_15
lwd_16:
    s_waitcnt vmcnt(9)
    v_mfma_f32_16x16x32_bf16 v[24:27], v[196:199], v[120:123], v[24:27]
    ds_read_b64_tr_b16 v[180:181], v20 offset:32768
    v_mfma_f32_16x16x32_bf16 v[40:43], v[196:199], v[124:127], v[40:43]
    ds_read_b64_tr_b16 v[182:183], v20 offset:34816
    v_mfma_f32_16x16x32_bf16 v[56:59], v[196:199], v[128:131], v[56:59]
    ds_read_b64_tr_b16 v[184:185], v21 offset:32768
    v_mfma_f32_16x16x32_bf16 v[28:31], v[200:203], v[120:123], v[28:31]
    ds_read_b64_tr_b16 v[186:187], v21 offset:34816
    v_mfma_f32_16x16x32_bf16 v[44:47], v[200:203], v[124:127], v[44:47]
    ds_read_b64_tr_b16 v[188:189], v22 offset:32768
    v_mfma_f32_16x16x32_bf16 v[60:63], v[200:203], v[128:131], v[60:63]
    ds_read_b64_tr_b16 v[190:191], v22 offset:34816
    v_mfma_f32_16x16x32_bf16 v[32:35], v[204:207], v[120:123], v[32:35]
    ds_read_b64_tr_b16 v[192:193], v23 offset:32768
    v_mfma_f32_16x16x32_bf16 v[48:51], v[204:207], v[124:127], v[48:51]
    ds_read_b64_tr_b16 v[194:195], v23 offset:34816
    v_mfma_f32_16x16x32_bf16 v[64:67], v[204:207], v[128:131], v[64:67]
    buffer_load_dwordx4 v[168:171], v17, s[32:35], s76 offen offset:2048 sc1
    v_mfma_f32_16x16x32_bf16 v[36:39], v[208:211], v[120:123], v[36:39]
    buffer_load_dwordx4 v[172:175], v18, s[32:35], s76 offen offset:2048 sc1
    v_mfma_f32_16x16x32_bf16 v[52:55], v[208:211], v[124:127], v[52:55]
    buffer_load_dwordx4 v[176:179], v19, s[32:35], s76 offen offset:2048 sc1
    v_mfma_f32_16x16x32_bf16 v[68:71], v[208:211], v[128:131], v[68:71]
    s_waitcnt vmcnt(9)
    s_waitcnt lgkmcnt(6)
    v_mfma_f32_16x16x32_bf16 v[24:27], v[180:183], v[132:135], v[24:27]
    ds_read_b64_tr_b16 v[196:197], v20 offset:40960
    v_mfma_f32_16x16x32_bf16 v[40:43], v[180:183], v[136:139], v[40:43]
    ds_read_b64_tr_b16 v[198:199], v20 offset:43008
    v_mfma_f32_16x16x32_bf16 v[56:59], v[180:183], v[140:143], v[56:59]
    ds_read_b64_tr_b16 v[200:201], v21 offset:40960
    s_waitcnt lgkmcnt(7)
    v_mfma_f32_16x16x32_bf16 v[28:31], v[184:187], v[132:135], v[28:31]
    ds_read_b64_tr_b16 v[202:203], v21 offset:43008
    v_mfma_f32_16x16x32_bf16 v[44:47], v[184:187], v[136:139], v[44:47]
    ds_read_b64_tr_b16 v[204:205], v22 offset:40960
    v_mfma_f32_16x16x32_bf16 v[60:63], v[184:187], v[140:143], v[60:63]
    ds_read_b64_tr_b16 v[206:207], v22 offset:43008
    s_waitcnt lgkmcnt(8)
    v_mfma_f32_16x16x32_bf16 v[32:35], v[188:191], v[132:135], v[32:35]
    ds_read_b64_tr_b16 v[208:209], v23 offset:40960
    v_mfma_f32_16x16x32_bf16 v[48:51], v[188:191], v[136:139], v[48:51]
    ds_read_b64_tr_b16 v[210:211], v23 offset:43008
    v_mfma_f32_16x16x32_bf16 v[64:67], v[188:191], v[140:143], v[64:67]
    s_add_u32 s76, s76, 4096
    s_waitcnt lgkmcnt(8)
    v_mfma_f32_16x16x32_bf16 v[36:39], v[192:195], v[132:135], v[36:39]
    buffer_load_dwordx4 v[120:123], v17, s[32:35], s76 offen offset:0 sc1
    v_mfma_f32_16x16x32_bf16 v[52:55], v[192:195], v[136:139], v[52:55]
    buffer_load_dwordx4 v[124:127], v18, s[32:35], s76 offen offset:0 sc1
    v_mfma_f32_16x16x32_bf16 v[68:71], v[192:195], v[140:143], v[68:71]
    buffer_load_dwordx4 v[128:131], v19, s[32:35], s76 offen offset:0 sc1
    s_waitcnt vmcnt(9)
    s_waitcnt lgkmcnt(6)
    v_mfma_f32_16x16x32_bf16 v[24:27], v[196:199], v[144:147], v[24:27]
    ds_read_b64_tr_b16 v[180:181], v20 offset:49152
    v_mfma_f32_16x16x32_bf16 v[40:43], v[196:199], v[148:151], v[40:43]
    ds_read_b64_tr_b16 v[182:183], v20 offset:51200
    v_mfma_f32_16x16x32_bf16 v[56:59], v[196:199], v[152:155], v[56:59]
    ds_read_b64_tr_b16 v[184:185], v21 offset:49152
    s_waitcnt lgkmcnt(7)
    v_mfma_f32_16x16x32_bf16 v[28:31], v[200:203], v[144:147], v[28:31]
    ds_read_b64_tr_b16 v[186:187], v21 offset:51200
    v_mfma_f32_16x16x32_bf16 v[44:47], v[200:203], v[148:151], v[44:47]
    ds_read_b64_tr_b16 v[188:189], v22 offset:49152
    v_mfma_f32_16x16x32_bf16 v[60:63], v[200:203], v[152:155], v[60:63]
    ds_read_b64_tr_b16 v[190:191], v22 offset:51200
    s_waitcnt lgkmcnt(8)
    v_mfma_f32_16x16x32_bf16 v[32:35], v[204:207], v[144:147], v[32:35]
    ds_read_b64_tr_b16 v[192:193], v23 offset:49152
    v_mfma_f32_16x16x32_bf16 v[48:51], v[204:207], v[148:151], v[48:51]
    ds_read_b64_tr_b16 v[194:195], v23 offset:51200
    v_mfma_f32_16x16x32_bf16 v[64:67], v[204:207], v[152:155], v[64:67]
    buffer_load_dwordx4 v[132:135], v17, s[32:35], s76 offen offset:2048 sc1
    s_waitcnt lgkmcnt(8)
    v_mfma_f32_16x16x32_bf16 v[36:39], v[208:211], v[144:147], v[36:39]
    buffer_load_dwordx4 v[136:139], v18, s[32:35], s76 offen offset:2048 sc1
    v_mfma_f32_16x16x32_bf16 v[52:55], v[208:211], v[148:151], v[52:55]
    buffer_load_dwordx4 v[140:143], v19, s[32:35], s76 offen offset:2048 sc1
    v_mfma_f32_16x16x32_bf16 v[68:71], v[208:211], v[152:155], v[68:71]
    s_waitcnt vmcnt(9)
    s_waitcnt lgkmcnt(6)
    v_mfma_f32_16x16x32_bf16 v[24:27], v[180:183], v[156:159], v[24:27]
    ds_read_b64_tr_b16 v[196:197], v20 offset:57344
    v_mfma_f32_16x16x32_bf16 v[40:43], v[180:183], v[160:163], v[40:43]
    ds_read_b64_tr_b16 v[198:199], v20 offset:59392
    v_mfma_f32_16x16x32_bf16 v[56:59], v[180:183], v[164:167], v[56:59]
    ds_read_b64_tr_b16 v[200:201], v21 offset:57344
    s_waitcnt lgkmcnt(7)
    v_mfma_f32_16x16x32_bf16 v[28:31], v[184:187], v[156:159], v[28:31]
    ds_read_b64_tr_b16 v[202:203], v21 offset:59392
    v_mfma_f32_16x16x32_bf16 v[44:47], v[184:187], v[160:163], v[44:47]
    ds_read_b64_tr_b16 v[204:205], v22 offset:57344
    v_mfma_f32_16x16x32_bf16 v[60:63], v[184:187], v[164:167], v[60:63]
    ds_read_b64_tr_b16 v[206:207], v22 offset:59392
    s_waitcnt lgkmcnt(8)
    v_mfma_f32_16x16x32_bf16 v[32:35], v[188:191], v[156:159], v[32:35]
    ds_read_b64_tr_b16 v[208:209], v23 offset:57344
    v_mfma_f32_16x16x32_bf16 v[48:51], v[188:191], v[160:163], v[48:51]
    ds_read_b64_tr_b16 v[210:211], v23 offset:59392
L_pad_3:
    s_cbranch_execz L_tramp
    v_mfma_f32_16x16x32_bf16 v[64:67], v[188:191], v[164:167], v[64:67]
    s_add_u32 s76, s76, 4096
    s_waitcnt lgkmcnt(8)
    v_mfma_f32_16x16x32_bf16 v[36:39], v[192:195], v[156:159], v[36:39]
    buffer_load_dwordx4 v[144:147], v17, s[32:35], s76 offen offset:0 sc1
    v_mfma_f32_16x16x32_bf16 v[52:55], v[192:195], v[160:163], v[52:55]
    buffer_load_dwordx4 v[148:151], v18, s[32:35], s76 offen offset:0 sc1
    v_mfma_f32_16x16x32_bf16 v[68:71], v[192:195], v[164:167], v[68:71]
    buffer_load_dwordx4 v[152:155], v19, s[32:35], s76 offen offset:0 sc1
    s_waitcnt vmcnt(9)
    s_waitcnt lgkmcnt(6)
    v_mfma_f32_16x16x32_bf16 v[24:27], v[196:199], v[168:171], v[24:27]
    v_add_u32 v20, 65536, v20
    v_add_u32 v21, 65536, v21
    v_add_u32 v22, 65536, v22
    v_add_u32 v23, 65536, v23
    v_mfma_f32_16x16x32_bf16 v[40:43], v[196:199], v[172:175], v[40:43]
    ds_read_b64_tr_b16 v[180:181], v20 offset:0
    v_mfma_f32_16x16x32_bf16 v[56:59], v[196:199], v[176:179], v[56:59]
    ds_read_b64_tr_b16 v[182:183], v20 offset:2048
    s_waitcnt lgkmcnt(6)
    v_mfma_f32_16x16x32_bf16 v[28:31], v[200:203], v[168:171], v[28:31]
    ds_read_b64_tr_b16 v[184:185], v21 offset:0
    v_mfma_f32_16x16x32_bf16 v[44:47], v[200:203], v[172:175], v[44:47]
    ds_read_b64_tr_b16 v[186:187], v21 offset:2048
    v_mfma_f32_16x16x32_bf16 v[60:63], v[200:203], v[176:179], v[60:63]
    ds_read_b64_tr_b16 v[188:189], v22 offset:0
    s_waitcnt lgkmcnt(7)
    v_mfma_f32_16x16x32_bf16 v[32:35], v[204:207], v[168:171], v[32:35]
    ds_read_b64_tr_b16 v[190:191], v22 offset:2048
    v_mfma_f32_16x16x32_bf16 v[48:51], v[204:207], v[172:175], v[48:51]
    ds_read_b64_tr_b16 v[192:193], v23 offset:0
    v_mfma_f32_16x16x32_bf16 v[64:67], v[204:207], v[176:179], v[64:67]
    ds_read_b64_tr_b16 v[194:195], v23 offset:2048
    s_waitcnt lgkmcnt(8)
    v_mfma_f32_16x16x32_bf16 v[36:39], v[208:211], v[168:171], v[36:39]
    buffer_load_dwordx4 v[156:159], v17, s[32:35], s76 offen offset:2048 sc1
    v_mfma_f32_16x16x32_bf16 v[52:55], v[208:211], v[172:175], v[52:55]
    buffer_load_dwordx4 v[160:163], v18, s[32:35], s76 offen offset:2048 sc1
    v_mfma_f32_16x16x32_bf16 v[68:71], v[208:211], v[176:179], v[68:71]
    buffer_load_dwordx4 v[164:167], v19, s[32:35], s76 offen offset:2048 sc1
    s_waitcnt vmcnt(9)
    s_waitcnt lgkmcnt(6)
    v_mfma_f32_16x16x32_bf16 v[24:27], v[180:183], v[120:123], v[24:27]
    ds_read_b64_tr_b16 v[196:197], v20 offset:8192
    v_mfma_f32_16x16x32_bf16 v[40:43], v[180:183], v[124:127], v[40:43]
    ds_read_b64_tr_b16 v[198:199], v20 offset:10240
    v_mfma_f32_16x16x32_bf16 v[56:59], v[180:183], v[128:131], v[56:59]
    ds_read_b64_tr_b16 v[200:201], v21 offset:8192
    s_waitcnt lgkmcnt(7)
    v_mfma_f32_16x16x32_bf16 v[28:31], v[184:187], v[120:123], v[28:31]
    ds_read_b64_tr_b16 v[202:203], v21 offset:10240
    v_mfma_f32_16x16x32_bf16 v[44:47], v[184:187], v[124:127], v[44:47]
    ds_read_b64_tr_b16 v[204:205], v22 offset:8192
    v_mfma_f32_16x16x32_bf16 v[60:63], v[184:187], v[128:131], v[60:63]
    ds_read_b64_tr_b16 v[206:207], v22 offset:10240
    s_waitcnt lgkmcnt(8)
    v_mfma_f32_16x16x32_bf16 v[32:35], v[188:191], v[120:123], v[32:35]
    ds_read_b64_tr_b16 v[208:209], v23 offset:8192
    v_mfma_f32_16x16x32_bf16 v[48:51], v[188:191], v[124:127], v[48:51]
    ds_read_b64_tr_b16 v[210:211], v23 offset:10240
    v_mfma_f32_16x16x32_bf16 v[64:67], v[188:191], v[128:131], v[64:67]
    s_add_u32 s76, s76, 4096
    s_waitcnt lgkmcnt(8)
    v_mfma_f32_16x16x32_bf16 v[36:39], v[192:195], v[120:123], v[36:39]
    buffer_load_dwordx4 v[168:171], v17, s[32:35], s76 offen offset:0 sc1
    v_mfma_f32_16x16x32_bf16 v[52:55], v[192:195], v[124:127], v[52:55]
    buffer_load_dwordx4 v[172:175], v18, s[32:35], s76 offen offset:0 sc1
    v_mfma_f32_16x16x32_bf16 v[68:71], v[192:195], v[128:131], v[68:71]
    buffer_load_dwordx4 v[176:179], v19, s[32:35], s76 offen offset:0 sc1
    s_waitcnt vmcnt(9)
    s_waitcnt lgkmcnt(6)
    v_mfma_f32_16x16x32_bf16 v[24:27], v[196:199], v[132:135], v[24:27]
    buffer_load_dwordx4 v[120:123], v17, s[32:35], s76 offen offset:2048 sc1
    buffer_load_dwordx4 v[124:127], v18, s[32:35], s76 offen offset:2048 sc1
    v_mfma_f32_16x16x32_bf16 v[40:43], v[196:199], v[136:139], v[40:43]
    buffer_load_dwordx4 v[128:131], v19, s[32:35], s76 offen offset:2048 sc1
    v_mfma_f32_16x16x32_bf16 v[56:59], v[196:199], v[140:143], v[56:59]
    s_waitcnt lgkmcnt(0)
    s_barrier
    v_mfma_f32_16x16x32_bf16 v[28:31], v[200:203], v[132:135], v[28:31]
    v_add_u32 v20, -131072, v20
    v_add_u32 v21, -131072, v21
    v_add_u32 v22, -131072, v22
    v_add_u32 v23, -131072, v23
    v_mfma_f32_16x16x32_bf16 v[44:47], v[200:203], v[136:139], v[44:47]
    ds_read_b64_tr_b16 v[180:181], v20 offset:0
    v_mfma_f32_16x16x32_bf16 v[60:63], v[200:203], v[140:143], v[60:63]
    ds_read_b64_tr_b16 v[182:183], v20 offset:2048
    v_mfma_f32_16x16x32_bf16 v[32:35], v[204:207], v[132:135], v[32:35]
    ds_read_b64_tr_b16 v[184:185], v21 offset:0
    v_mfma_f32_16x16x32_bf16 v[48:51], v[204:207], v[136:139], v[48:51]
    ds_read_b64_tr_b16 v[186:187], v21 offset:2048
    v_mfma_f32_16x16x32_bf16 v[64:67], v[204:207], v[140:143], v[64:67]
    ds_read_b64_tr_b16 v[188:189], v22 offset:0
    v_mfma_f32_16x16x32_bf16 v[36:39], v[208:211], v[132:135], v[36:39]
    ds_read_b64_tr_b16 v[190:191], v22 offset:2048
    v_mfma_f32_16x16x32_bf16 v[52:55], v[208:211], v[136:139], v[52:55]
    ds_read_b64_tr_b16 v[192:193], v23 offset:0
    v_mfma_f32_16x16x32_bf16 v[68:71], v[208:211], v[140:143], v[68:71]
    ds_read_b64_tr_b16 v[194:195], v23 offset:2048
    s_waitcnt vmcnt(9)
    s_waitcnt lgkmcnt(6)
    v_mfma_f32_16x16x32_bf16 v[24:27], v[180:183], v[144:147], v[24:27]
    ds_read_b64_tr_b16 v[196:197], v20 offset:8192
    v_mfma_f32_16x16x32_bf16 v[40:43], v[180:183], v[148:151], v[40:43]
    ds_read_b64_tr_b16 v[198:199], v20 offset:10240
    v_mfma_f32_16x16x32_bf16 v[56:59], v[180:183], v[152:155], v[56:59]
    ds_read_b64_tr_b16 v[200:201], v21 offset:8192
    s_waitcnt lgkmcnt(7)
    v_mfma_f32_16x16x32_bf16 v[28:31], v[184:187], v[144:147], v[28:31]
    ds_read_b64_tr_b16 v[202:203], v21 offset:10240
    v_mfma_f32_16x16x32_bf16 v[44:47], v[184:187], v[148:151], v[44:47]
    ds_read_b64_tr_b16 v[204:205], v22 offset:8192
    v_mfma_f32_16x16x32_bf16 v[60:63], v[184:187], v[152:155], v[60:63]
    ds_read_b64_tr_b16 v[206:207], v22 offset:10240
    s_waitcnt lgkmcnt(8)
    v_mfma_f32_16x16x32_bf16 v[32:35], v[188:191], v[144:147], v[32:35]
    ds_read_b64_tr_b16 v[208:209], v23 offset:8192
    v_mfma_f32_16x16x32_bf16 v[48:51], v[188:191], v[148:151], v[48:51]
    ds_read_b64_tr_b16 v[210:211], v23 offset:10240
    v_mfma_f32_16x16x32_bf16 v[64:67], v[188:191], v[152:155], v[64:67]
    s_add_u32 s76, s76, 4096
    s_waitcnt lgkmcnt(8)
    v_mfma_f32_16x16x32_bf16 v[36:39], v[192:195], v[144:147], v[36:39]
    buffer_load_dwordx4 v[132:135], v17, s[32:35], s76 offen offset:0 sc1
    v_mfma_f32_16x16x32_bf16 v[52:55], v[192:195], v[148:151], v[52:55]
    buffer_load_dwordx4 v[136:139], v18, s[32:35], s76 offen offset:0 sc1
    v_mfma_f32_16x16x32_bf16 v[68:71], v[192:195], v[152:155], v[68:71]
    buffer_load_dwordx4 v[140:143], v19, s[32:35], s76 offen offset:0 sc1
    s_waitcnt vmcnt(9)
    s_waitcnt lgkmcnt(6)
    v_mfma_f32_16x16x32_bf16 v[24:27], v[196:199], v[156:159], v[24:27]
    ds_read_b64_tr_b16 v[180:181], v20 offset:16384
    v_mfma_f32_16x16x32_bf16 v[40:43], v[196:199], v[160:163], v[40:43]
    ds_read_b64_tr_b16 v[182:183], v20 offset:18432
    v_mfma_f32_16x16x32_bf16 v[56:59], v[196:199], v[164:167], v[56:59]
    ds_read_b64_tr_b16 v[184:185], v21 offset:16384
    s_waitcnt lgkmcnt(7)
    v_mfma_f32_16x16x32_bf16 v[28:31], v[200:203], v[156:159], v[28:31]
    ds_read_b64_tr_b16 v[186:187], v21 offset:18432
    v_mfma_f32_16x16x32_bf16 v[44:47], v[200:203], v[160:163], v[44:47]
    ds_read_b64_tr_b16 v[188:189], v22 offset:16384
    v_mfma_f32_16x16x32_bf16 v[60:63], v[200:203], v[164:167], v[60:63]
    ds_read_b64_tr_b16 v[190:191], v22 offset:18432
    s_waitcnt lgkmcnt(8)
    v_mfma_f32_16x16x32_bf16 v[32:35], v[204:207], v[156:159], v[32:35]
    ds_read_b64_tr_b16 v[192:193], v23 offset:16384
    v_mfma_f32_16x16x32_bf16 v[48:51], v[204:207], v[160:163], v[48:51]
    ds_read_b64_tr_b16 v[194:195], v23 offset:18432
    v_mfma_f32_16x16x32_bf16 v[64:67], v[204:207], v[164:167], v[64:67]
    buffer_load_dwordx4 v[144:147], v17, s[32:35], s76 offen offset:2048 sc1
    s_waitcnt lgkmcnt(8)
    v_mfma_f32_16x16x32_bf16 v[36:39], v[208:211], v[156:159], v[36:39]
    buffer_load_dwordx4 v[148:151], v18, s[32:35], s76 offen offset:2048 sc1
    v_mfma_f32_16x16x32_bf16 v[52:55], v[208:211], v[160:163], v[52:55]
    buffer_load_dwordx4 v[152:155], v19, s[32:35], s76 offen offset:2048 sc1
    v_mfma_f32_16x16x32_bf16 v[68:71], v[208:211], v[164:167], v[68:71]
    s_waitcnt vmcnt(9)
    s_waitcnt lgkmcnt(6)
    v_mfma_f32_16x16x32_bf16 v[24:27], v[180:183], v[168:171], v[24:27]
    ds_read_b64_tr_b16 v[196:197], v20 offset:24576
    v_mfma_f32_16x16x32_bf16 v[40:43], v[180:183], v[172:175], v[40:43]
    ds_read_b64_tr_b16 v[198:199], v20 offset:26624
    v_mfma_f32_16x16x32_bf16 v[56:59], v[180:183], v[176:179], v[56:59]
    ds_read_b64_tr_b16 v[200:201], v21 offset:24576
    s_waitcnt lgkmcnt(7)
    v_mfma_f32_16x16x32_bf16 v[28:31], v[184:187], v[168:171], v[28:31]
    ds_read_b64_tr_b16 v[202:203], v21 offset:26624
    v_mfma_f32_16x16x32_bf16 v[44:47], v[184:187], v[172:175], v[44:47]
    ds_read_b64_tr_b16 v[204:205], v22 offset:24576
    v_mfma_f32_16x16x32_bf16 v[60:63], v[184:187], v[176:179], v[60:63]
    ds_read_b64_tr_b16 v[206:207], v22 offset:26624
    s_waitcnt lgkmcnt(8)
    v_mfma_f32_16x16x32_bf16 v[32:35], v[188:191], v[168:171], v[32:35]
    ds_read_b64_tr_b16 v[208:209], v23 offset:24576
    v_mfma_f32_16x16x32_bf16 v[48:51], v[188:191], v[172:175], v[48:51]
    ds_read_b64_tr_b16 v[210:211], v23 offset:26624
    v_mfma_f32_16x16x32_bf16 v[64:67], v[188:191], v[176:179], v[64:67]
    s_add_u32 s76, s76, 4096
    s_waitcnt lgkmcnt(8)
    v_mfma_f32_16x16x32_bf16 v[36:39], v[192:195], v[168:171], v[36:39]
    buffer_load_dwordx4 v[156:159], v17, s[32:35], s76 offen offset:0 sc1
    v_mfma_f32_16x16x32_bf16 v[52:55], v[192:195], v[172:175], v[52:55]
    buffer_load_dwordx4 v[160:163], v18, s[32:35], s76 offen offset:0 sc1
    v_mfma_f32_16x16x32_bf16 v[68:71], v[192:195], v[176:179], v[68:71]
    buffer_load_dwordx4 v[164:167], v19, s[32:35], s76 offen offset:0 sc1
    s_waitcnt vmcnt(9)
    s_waitcnt lgkmcnt(6)
    v_mfma_f32_16x16x32_bf16 v[24:27], v[196:199], v[120:123], v[24:27]
    ds_read_b64_tr_b16 v[180:181], v20 offset:32768
    v_mfma_f32_16x16x32_bf16 v[40:43], v[196:199], v[124:127], v[40:43]
    ds_read_b64_tr_b16 v[182:183], v20 offset:34816
    v_mfma_f32_16x16x32_bf16 v[56:59], v[196:199], v[128:131], v[56:59]
    ds_read_b64_tr_b16 v[184:185], v21 offset:32768
    s_waitcnt lgkmcnt(7)
    v_mfma_f32_16x16x32_bf16 v[28:31], v[200:203], v[120:123], v[28:31]
    ds_read_b64_tr_b16 v[186:187], v21 offset:34816
    v_mfma_f32_16x16x32_bf16 v[44:47], v[200:203], v[124:127], v[44:47]
    ds_read_b64_tr_b16 v[188:189], v22 offset:32768
    v_mfma_f32_16x16x32_bf16 v[60:63], v[200:203], v[128:131], v[60:63]
    ds_read_b64_tr_b16 v[190:191], v22 offset:34816
    s_waitcnt lgkmcnt(8)
    v_mfma_f32_16x16x32_bf16 v[32:35], v[204:207], v[120:123], v[32:35]
    ds_read_b64_tr_b16 v[192:193], v23 offset:32768
    v_mfma_f32_16x16x32_bf16 v[48:51], v[204:207], v[124:127], v[48:51]
    ds_read_b64_tr_b16 v[194:195], v23 offset:34816
    v_mfma_f32_16x16x32_bf16 v[64:67], v[204:207], v[128:131], v[64:67]
    buffer_load_dwordx4 v[168:171], v17, s[32:35], s76 offen offset:2048 sc1
    s_waitcnt lgkmcnt(8)
    v_mfma_f32_16x16x32_bf16 v[36:39], v[208:211], v[120:123], v[36:39]
    buffer_load_dwordx4 v[172:175], v18, s[32:35], s76 offen offset:2048 sc1
    v_mfma_f32_16x16x32_bf16 v[52:55], v[208:211], v[124:127], v[52:55]
    buffer_load_dwordx4 v[176:179], v19, s[32:35], s76 offen offset:2048 sc1
    v_mfma_f32_16x16x32_bf16 v[68:71], v[208:211], v[128:131], v[68:71]
    s_waitcnt vmcnt(9)
    s_waitcnt lgkmcnt(6)
    v_mfma_f32_16x16x32_bf16 v[24:27], v[180:183], v[132:135], v[24:27]
    ds_read_b64_tr_b16 v[196:197], v20 offset:40960
    v_mfma_f32_16x16x32_bf16 v[40:43], v[180:183], v[136:139], v[40:43]
    ds_read_b64_tr_b16 v[198:199], v20 offset:43008
    v_mfma_f32_16x16x32_bf16 v[56:59], v[180:183], v[140:143], v[56:59]
    ds_read_b64_tr_b16 v[200:201], v21 offset:40960
    s_waitcnt lgkmcnt(7)
    v_mfma_f32_16x16x32_bf16 v[28:31], v[184:187], v[132:135], v[28:31]
    ds_read_b64_tr_b16 v[202:203], v21 offset:43008
    v_mfma_f32_16x16x32_bf16 v[44:47], v[184:187], v[136:139], v[44:47]
    ds_read_b64_tr_b16 v[204:205], v22 offset:40960
    v_mfma_f32_16x16x32_bf16 v[60:63], v[184:187], v[140:143], v[60:63]
    ds_read_b64_tr_b16 v[206:207], v22 offset:43008
    s_waitcnt lgkmcnt(8)
    v_mfma_f32_16x16x32_bf16 v[32:35], v[188:191], v[132:135], v[32:35]
    ds_read_b64_tr_b16 v[208:209], v23 offset:40960
    v_mfma_f32_16x16x32_bf16 v[48:51], v[188:191], v[136:139], v[48:51]
    ds_read_b64_tr_b16 v[210:211], v23 offset:43008
    v_mfma_f32_16x16x32_bf16 v[64:67], v[188:191], v[140:143], v[64:67]
    s_add_u32 s76, s76, 4096
    s_waitcnt lgkmcnt(8)
    v_mfma_f32_16x16x32_bf16 v[36:39], v[192:195], v[132:135], v[36:39]
    buffer_load_dwordx4 v[120:123], v17, s[32:35], s76 offen offset:0 sc1
    v_mfma_f32_16x16x32_bf16 v[52:55], v[192:195], v[136:139], v[52:55]
    buffer_load_dwordx4 v[124:127], v18, s[32:35], s76 offen offset:0 sc1
    v_mfma_f32_16x16x32_bf16 v[68:71], v[192:195], v[140:143], v[68:71]
    buffer_load_dwordx4 v[128:131], v19, s[32:35], s76 offen offset:0 sc1
    s_waitcnt vmcnt(9)
    s_waitcnt lgkmcnt(6)
    v_mfma_f32_16x16x32_bf16 v[24:27], v[196:199], v[144:147], v[24:27]
    ds_read_b64_tr_b16 v[180:181], v20 offset:49152
    v_mfma_f32_16x16x32_bf16 v[40:43], v[196:199], v[148:151], v[40:43]
    ds_read_b64_tr_b16 v[182:183], v20 offset:51200
    v_mfma_f32_16x16x32_bf16 v[56:59], v[196:199], v[152:155], v[56:59]
    ds_read_b64_tr_b16 v[184:185], v21 offset:49152
    s_waitcnt lgkmcnt(7)
    v_mfma_f32_16x16x32_bf16 v[28:31], v[200:203], v[144:147], v[28:31]
    ds_read_b64_tr_b16 v[186:187], v21 offset:51200
    v_mfma_f32_16x16x32_bf16 v[44:47], v[200:203], v[148:151], v[44:47]
    ds_read_b64_tr_b16 v[188:189], v22 offset:49152
    v_mfma_f32_16x16x32_bf16 v[60:63], v[200:203], v[152:155], v[60:63]
    ds_read_b64_tr_b16 v[190:191], v22 offset:51200
    s_waitcnt lgkmcnt(8)
    v_mfma_f32_16x16x32_bf16 v[32:35], v[204:207], v[144:147], v[32:35]
    ds_read_b64_tr_b16 v[192:193], v23 offset:49152
    v_mfma_f32_16x16x32_bf16 v[48:51], v[204:207], v[148:151], v[48:51]
    ds_read_b64_tr_b16 v[194:195], v23 offset:51200
    v_mfma_f32_16x16x32_bf16 v[64:67], v[204:207], v[152:155], v[64:67]
    buffer_load_dwordx4 v[132:135], v17, s[32:35], s76 offen offset:2048 sc1
    s_waitcnt lgkmcnt(8)
    v_mfma_f32_16x16x32_bf16 v[36:39], v[208:211], v[144:147], v[36:39]
    buffer_load_dwordx4 v[136:139], v18, s[32:35], s76 offen offset:2048 sc1
    v_mfma_f32_16x16x32_bf16 v[52:55], v[208:211], v[148:151], v[52:55]
    buffer_load_dwordx4 v[140:143], v19, s[32:35], s76 offen offset:2048 sc1
    v_mfma_f32_16x16x32_bf16 v[68:71], v[208:211], v[152:155], v[68:71]
    s_waitcnt vmcnt(9)
    s_waitcnt lgkmcnt(6)
    v_mfma_f32_16x16x32_bf16 v[24:27], v[180:183], v[156:159], v[24:27]
    s_add_u32 s76, s76, 4096
    buffer_load_dwordx4 v[144:147], v17, s[32:35], s76 offen offset:0 sc1
    v_mfma_f32_16x16x32_bf16 v[40:43], v[180:183], v[160:163], v[40:43]
    buffer_load_dwordx4 v[148:151], v18, s[32:35], s76 offen offset:0 sc1
    v_mfma_f32_16x16x32_bf16 v[56:59], v[180:183], v[164:167], v[56:59]
    buffer_load_dwordx4 v[152:155], v19, s[32:35], s76 offen offset:0 sc1
    s_waitcnt lgkmcnt(4)
    v_mfma_f32_16x16x32_bf16 v[28:31], v[184:187], v[156:159], v[28:31]
    s_waitcnt lgkmcnt(0)
    s_barrier
    v_mfma_f32_16x16x32_bf16 v[44:47], v[184:187], v[160:163], v[44:47]
    ds_read_b64_tr_b16 v[196:197], v20 offset:57344
    v_mfma_f32_16x16x32_bf16 v[60:63], v[184:187], v[164:167], v[60:63]
    ds_read_b64_tr_b16 v[198:199], v20 offset:59392
    v_mfma_f32_16x16x32_bf16 v[32:35], v[188:191], v[156:159], v[32:35]
    ds_read_b64_tr_b16 v[200:201], v21 offset:57344
    v_mfma_f32_16x16x32_bf16 v[48:51], v[188:191], v[160:163], v[48:51]
    ds_read_b64_tr_b16 v[202:203], v21 offset:59392
    v_mfma_f32_16x16x32_bf16 v[64:67], v[188:191], v[164:167], v[64:67]
    ds_read_b64_tr_b16 v[204:205], v22 offset:57344
    v_mfma_f32_16x16x32_bf16 v[36:39], v[192:195], v[156:159], v[36:39]
    ds_read_b64_tr_b16 v[206:207], v22 offset:59392
    v_mfma_f32_16x16x32_bf16 v[52:55], v[192:195], v[160:163], v[52:55]
    ds_read_b64_tr_b16 v[208:209], v23 offset:57344
    v_mfma_f32_16x16x32_bf16 v[68:71], v[192:195], v[164:167], v[68:71]
    ds_read_b64_tr_b16 v[210:211], v23 offset:59392
    s_waitcnt vmcnt(9)
    s_waitcnt lgkmcnt(6)
    v_mfma_f32_16x16x32_bf16 v[24:27], v[196:199], v[168:171], v[24:27]
    v_add_u32 v20, 65536, v20
    v_add_u32 v21, 65536, v21
    v_add_u32 v22, 65536, v22
    v_add_u32 v23, 65536, v23
    v_mfma_f32_16x16x32_bf16 v[40:43], v[196:199], v[172:175], v[40:43]
    ds_read_b64_tr_b16 v[180:181], v20 offset:0
    v_mfma_f32_16x16x32_bf16 v[56:59], v[196:199], v[176:179], v[56:59]
    ds_read_b64_tr_b16 v[182:183], v20 offset:2048
    s_waitcnt lgkmcnt(6)
    v_mfma_f32_16x16x32_bf16 v[28:31], v[200:203], v[168:171], v[28:31]
    ds_read_b64_tr_b16 v[184:185], v21 offset:0
    v_mfma_f32_16x16x32_bf16 v[44:47], v[200:203], v[172:175], v[44:47]
    ds_read_b64_tr_b16 v[186:187], v21 offset:2048
    v_mfma_f32_16x16x32_bf16 v[60:63], v[200:203], v[176:179], v[60:63]
    ds_read_b64_tr_b16 v[188:189], v22 offset:0
    s_waitcnt lgkmcnt(7)
    v_mfma_f32_16x16x32_bf16 v[32:35], v[204:207], v[168:171], v[32:35]
    ds_read_b64_tr_b16 v[190:191], v22 offset:2048
    v_mfma_f32_16x16x32_bf16 v[48:51], v[204:207], v[172:175], v[48:51]
    ds_read_b64_tr_b16 v[192:193], v23 offset:0
    v_mfma_f32_16x16x32_bf16 v[64:67], v[204:207], v[176:179], v[64:67]
    ds_read_b64_tr_b16 v[194:195], v23 offset:2048
    s_waitcnt lgkmcnt(8)
    v_mfma_f32_16x16x32_bf16 v[36:39], v[208:211], v[168:171], v[36:39]
    buffer_load_dwordx4 v[156:159], v17, s[32:35], s76 offen offset:2048 sc1
    v_mfma_f32_16x16x32_bf16 v[52:55], v[208:211], v[172:175], v[52:55]
    buffer_load_dwordx4 v[160:163], v18, s[32:35], s76 offen offset:2048 sc1
    v_mfma_f32_16x16x32_bf16 v[68:71], v[208:211], v[176:179], v[68:71]
    buffer_load_dwordx4 v[164:167], v19, s[32:35], s76 offen offset:2048 sc1
    s_waitcnt vmcnt(9)
    s_waitcnt lgkmcnt(6)
    v_mfma_f32_16x16x32_bf16 v[24:27], v[180:183], v[120:123], v[24:27]
    ds_read_b64_tr_b16 v[196:197], v20 offset:8192
    v_mfma_f32_16x16x32_bf16 v[40:43], v[180:183], v[124:127], v[40:43]
    ds_read_b64_tr_b16 v[198:199], v20 offset:10240
    v_mfma_f32_16x16x32_bf16 v[56:59], v[180:183], v[128:131], v[56:59]
    ds_read_b64_tr_b16 v[200:201], v21 offset:8192
    s_waitcnt lgkmcnt(7)
    v_mfma_f32_16x16x32_bf16 v[28:31], v[184:187], v[120:123], v[28:31]
    ds_read_b64_tr_b16 v[202:203], v21 offset:10240
    v_mfma_f32_16x16x32_bf16 v[44:47], v[184:187], v[124:127], v[44:47]
    ds_read_b64_tr_b16 v[204:205], v22 offset:8192
    v_mfma_f32_16x16x32_bf16 v[60:63], v[184:187], v[128:131], v[60:63]
    ds_read_b64_tr_b16 v[206:207], v22 offset:10240
    s_waitcnt lgkmcnt(8)
    v_mfma_f32_16x16x32_bf16 v[32:35], v[188:191], v[120:123], v[32:35]
    ds_read_b64_tr_b16 v[208:209], v23 offset:8192
    v_mfma_f32_16x16x32_bf16 v[48:51], v[188:191], v[124:127], v[48:51]
    ds_read_b64_tr_b16 v[210:211], v23 offset:10240
    v_mfma_f32_16x16x32_bf16 v[64:67], v[188:191], v[128:131], v[64:67]
    s_add_u32 s76, s76, 4096
    s_waitcnt lgkmcnt(8)
    v_mfma_f32_16x16x32_bf16 v[36:39], v[192:195], v[120:123], v[36:39]
    buffer_load_dwordx4 v[168:171], v17, s[32:35], s76 offen offset:0 sc1
    v_mfma_f32_16x16x32_bf16 v[52:55], v[192:195], v[124:127], v[52:55]
    buffer_load_dwordx4 v[172:175], v18, s[32:35], s76 offen offset:0 sc1
    v_mfma_f32_16x16x32_bf16 v[68:71], v[192:195], v[128:131], v[68:71]
    buffer_load_dwordx4 v[176:179], v19, s[32:35], s76 offen offset:0 sc1
    s_waitcnt vmcnt(9)
    s_waitcnt lgkmcnt(6)
    v_mfma_f32_16x16x32_bf16 v[24:27], v[196:199], v[132:135], v[24:27]
    ds_read_b64_tr_b16 v[180:181], v20 offset:16384
    v_mfma_f32_16x16x32_bf16 v[40:43], v[196:199], v[136:139], v[40:43]
    ds_read_b64_tr_b16 v[182:183], v20 offset:18432
    v_mfma_f32_16x16x32_bf16 v[56:59], v[196:199], v[140:143], v[56:59]
    ds_read_b64_tr_b16 v[184:185], v21 offset:16384
    s_waitcnt lgkmcnt(7)
    v_mfma_f32_16x16x32_bf16 v[28:31], v[200:203], v[132:135], v[28:31]
    ds_read_b64_tr_b16 v[186:187], v21 offset:18432
    v_mfma_f32_16x16x32_bf16 v[44:47], v[200:203], v[136:139], v[44:47]
    ds_read_b64_tr_b16 v[188:189], v22 offset:16384
    v_mfma_f32_16x16x32_bf16 v[60:63], v[200:203], v[140:143], v[60:63]
    ds_read_b64_tr_b16 v[190:191], v22 offset:18432
    s_waitcnt lgkmcnt(8)
    v_mfma_f32_16x16x32_bf16 v[32:35], v[204:207], v[132:135], v[32:35]
    ds_read_b64_tr_b16 v[192:193], v23 offset:16384
    v_mfma_f32_16x16x32_bf16 v[48:51], v[204:207], v[136:139], v[48:51]
    ds_read_b64_tr_b16 v[194:195], v23 offset:18432
    v_mfma_f32_16x16x32_bf16 v[64:67], v[204:207], v[140:143], v[64:67]
    buffer_load_dwordx4 v[120:123], v17, s[32:35], s76 offen offset:2048 sc1
    s_waitcnt lgkmcnt(8)
    v_mfma_f32_16x16x32_bf16 v[36:39], v[208:211], v[132:135], v[36:39]
    buffer_load_dwordx4 v[124:127], v18, s[32:35], s76 offen offset:2048 sc1
    v_mfma_f32_16x16x32_bf16 v[52:55], v[208:211], v[136:139], v[52:55]
    buffer_load_dwordx4 v[128:131], v19, s[32:35], s76 offen offset:2048 sc1
    v_mfma_f32_16x16x32_bf16 v[68:71], v[208:211], v[140:143], v[68:71]
    s_mov_b64 exec, 1
    ds_add_u32 v253, v252 offset:64
    s_mov_b64 exec, -1
    s_waitcnt vmcnt(9)
    s_waitcnt lgkmcnt(7)
    v_mfma_f32_16x16x32_bf16 v[24:27], v[180:183], v[144:147], v[24:27]
    ds_read_b64_tr_b16 v[196:197], v20 offset:24576
    ds_read_b64_tr_b16 v[198:199], v20 offset:26624
    v_mfma_f32_16x16x32_bf16 v[40:43], v[180:183], v[148:151], v[40:43]
    ds_read_b64_tr_b16 v[200:201], v21 offset:24576
    v_mfma_f32_16x16x32_bf16 v[56:59], v[180:183], v[152:155], v[56:59]
    ds_read_b64_tr_b16 v[202:203], v21 offset:26624
    s_waitcnt lgkmcnt(9)
    v_mfma_f32_16x16x32_bf16 v[28:31], v[184:187], v[144:147], v[28:31]
    ds_read_b32 v8, v253 offset:12
    v_mfma_f32_16x16x32_bf16 v[44:47], v[184:187], v[148:151], v[44:47]
    ds_read_b64_tr_b16 v[204:205], v22 offset:24576
    v_mfma_f32_16x16x32_bf16 v[60:63], v[184:187], v[152:155], v[60:63]
    ds_read_b64_tr_b16 v[206:207], v22 offset:26624
    s_waitcnt lgkmcnt(10)
    v_mfma_f32_16x16x32_bf16 v[32:35], v[188:191], v[144:147], v[32:35]
    ds_read_b64_tr_b16 v[208:209], v23 offset:24576
    v_mfma_f32_16x16x32_bf16 v[48:51], v[188:191], v[148:151], v[48:51]
    ds_read_b64_tr_b16 v[210:211], v23 offset:26624
    v_mfma_f32_16x16x32_bf16 v[64:67], v[188:191], v[152:155], v[64:67]
    s_add_u32 s76, s76, 4096
    s_waitcnt lgkmcnt(10)
    v_mfma_f32_16x16x32_bf16 v[36:39], v[192:195], v[144:147], v[36:39]
    buffer_load_dwordx4 v[132:135], v17, s[32:35], s76 offen offset:0 sc1
    v_mfma_f32_16x16x32_bf16 v[52:55], v[192:195], v[148:151], v[52:55]
    buffer_load_dwordx4 v[136:139], v18, s[32:35], s76 offen offset:0 sc1
    v_mfma_f32_16x16x32_bf16 v[68:71], v[192:195], v[152:155], v[68:71]
    buffer_load_dwordx4 v[140:143], v19, s[32:35], s76 offen offset:0 sc1
    s_waitcnt lgkmcnt(4)
    v_readfirstlane_b32 s72, v8
    s_nop 0
    s_cmp_lt_u32 s72, 1
    s_cbranch_scc1 L_oslow
    s_waitcnt vmcnt(9)
    v_mfma_f32_16x16x32_bf16 v[24:27], v[196:199], v[156:159], v[24:27]
    ds_read_b64_tr_b16 v[180:181], v20 offset:32768
    v_mfma_f32_16x16x32_bf16 v[40:43], v[196:199], v[160:163], v[40:43]
    ds_read_b64_tr_b16 v[182:183], v20 offset:34816
    v_mfma_f32_16x16x32_bf16 v[56:59], v[196:199], v[164:167], v[56:59]
    ds_read_b64_tr_b16 v[184:185], v21 offset:32768
    v_mfma_f32_16x16x32_bf16 v[28:31], v[200:203], v[156:159], v[28:31]
    ds_read_b64_tr_b16 v[186:187], v21 offset:34816
    v_mfma_f32_16x16x32_bf16 v[44:47], v[200:203], v[160:163], v[44:47]
    ds_read_b64_tr_b16 v[188:189], v22 offset:32768
    v_mfma_f32_16x16x32_bf16 v[60:63], v[200:203], v[164:167], v[60:63]
    ds_read_b64_tr_b16 v[190:191], v22 offset:34816
    s_waitcnt lgkmcnt(8)
    v_mfma_f32_16x16x32_bf16 v[32:35], v[204:207], v[156:159], v[32:35]
    ds_read_b64_tr_b16 v[192:193], v23 offset:32768
    v_mfma_f32_16x16x32_bf16 v[48:51], v[204:207], v[160:163], v[48:51]
    ds_read_b64_tr_b16 v[194:195], v23 offset:34816
    v_mfma_f32_16x16x32_bf16 v[64:67], v[204:207], v[164:167], v[64:67]
    buffer_load_dwordx4 v[144:147], v17, s[32:35], s76 offen offset:2048 sc1
    s_waitcnt lgkmcnt(8)
    v_mfma_f32_16x16x32_bf16 v[36:39], v[208:211], v[156:159], v[36:39]
    buffer_load_dwordx4 v[148:151], v18, s[32:35], s76 offen offset:2048 sc1
    v_mfma_f32_16x16x32_bf16 v[52:55], v[208:211], v[160:163], v[52:55]
    buffer_load_dwordx4 v[152:155], v19, s[32:35], s76 offen offset:2048 sc1
    v_mfma_f32_16x16x32_bf16 v[68:71], v[208:211], v[164:167], v[68:71]
    s_waitcnt vmcnt(9)
    s_waitcnt lgkmcnt(6)
    v_mfma_f32_16x16x32_bf16 v[24:27], v[180:183], v[168:171], v[24:27]
    ds_read_b64_tr_b16 v[196:197], v20 offset:40960
    ds_read_b64_tr_b16 v[198:199], v20 offset:43008
    v_mfma_f32_16x16x32_bf16 v[40:43], v[180:183], v[172:175], v[40:43]
    ds_read_b64_tr_b16 v[200:201], v21 offset:40960
    ds_read_b64_tr_b16 v[202:203], v21 offset:43008
    v_mfma_f32_16x16x32_bf16 v[56:59], v[180:183], v[176:179], v[56:59]
    ds_read_b32 v8, v253 offset:12
    s_waitcnt lgkmcnt(9)
    v_mfma_f32_16x16x32_bf16 v[28:31], v[184:187], v[168:171], v[28:31]
    ds_read_b32 v9, v253 offset:64
    v_mfma_f32_16x16x32_bf16 v[44:47], v[184:187], v[172:175], v[44:47]
    ds_read_b64_tr_b16 v[204:205], v22 offset:40960
    v_mfma_f32_16x16x32_bf16 v[60:63], v[184:187], v[176:179], v[60:63]
    ds_read_b64_tr_b16 v[206:207], v22 offset:43008
    s_waitcnt lgkmcnt(10)
    v_mfma_f32_16x16x32_bf16 v[32:35], v[188:191], v[168:171], v[32:35]
    ds_read_b64_tr_b16 v[208:209], v23 offset:40960
    v_mfma_f32_16x16x32_bf16 v[48:51], v[188:191], v[172:175], v[48:51]
    ds_read_b64_tr_b16 v[210:211], v23 offset:43008
    v_mfma_f32_16x16x32_bf16 v[64:67], v[188:191], v[176:179], v[64:67]
    s_add_u32 s76, s76, 4096
    s_waitcnt lgkmcnt(10)
    v_mfma_f32_16x16x32_bf16 v[36:39], v[192:195], v[168:171], v[36:39]
    buffer_load_dwordx4 v[156:159], v17, s[32:35], s76 offen offset:0 sc1
    v_mfma_f32_16x16x32_bf16 v[52:55], v[192:195], v[172:175], v[52:55]
    buffer_load_dwordx4 v[160:163], v18, s[32:35], s76 offen offset:0 sc1
    v_mfma_f32_16x16x32_bf16 v[68:71], v[192:195], v[176:179], v[68:71]
    buffer_load_dwordx4 v[164:167], v19, s[32:35], s76 offen offset:0 sc1
    s_waitcnt lgkmcnt(5)
    v_readfirstlane_b32 s85, v8
    s_nop 0
    s_cmp_lt_u32 s85, 2
    s_cbranch_scc1 lws_27
lwd_28:
    s_waitcnt lgkmcnt(4)
    v_readfirstlane_b32 s85, v9
    s_nop 0
    s_cmp_lt_u32 s85, 4
    s_cbranch_scc1 lws_30
lwd_31:
    s_waitcnt vmcnt(9)
    v_mfma_f32_16x16x32_bf16 v[24:27], v[196:199], v[120:123], v[24:27]
    ds_read_b64_tr_b16 v[188:189], v22 offset:49152
    v_mfma_f32_16x16x32_bf16 v[40:43], v[196:199], v[124:127], v[40:43]
    ds_read_b64_tr_b16 v[190:191], v22 offset:51200
    v_mfma_f32_16x16x32_bf16 v[56:59], v[196:199], v[128:131], v[56:59]
    ds_read_b64_tr_b16 v[192:193], v23 offset:49152
    v_mfma_f32_16x16x32_bf16 v[28:31], v[200:203], v[120:123], v[28:31]
    ds_read_b64_tr_b16 v[194:195], v23 offset:51200
    v_mfma_f32_16x16x32_bf16 v[44:47], v[200:203], v[124:127], v[44:47]
    ds_read_b64_tr_b16 v[180:181], v20 offset:49152
    v_mfma_f32_16x16x32_bf16 v[60:63], v[200:203], v[128:131], v[60:63]
    ds_read_b64_tr_b16 v[182:183], v20 offset:51200
    s_waitcnt lgkmcnt(8)
    v_mfma_f32_16x16x32_bf16 v[32:35], v[204:207], v[120:123], v[32:35]
    ds_read_b64_tr_b16 v[184:185], v21 offset:49152
    v_mfma_f32_16x16x32_bf16 v[48:51], v[204:207], v[124:127], v[48:51]
    ds_read_b64_tr_b16 v[186:187], v21 offset:51200
    v_mfma_f32_16x16x32_bf16 v[64:67], v[204:207], v[128:131], v[64:67]
    buffer_load_dwordx4 v[168:171], v17, s[32:35], s76 offen offset:2048 sc1
    s_waitcnt lgkmcnt(8)
    v_mfma_f32_16x16x32_bf16 v[36:39], v[208:211], v[120:123], v[36:39]
    buffer_load_dwordx4 v[172:175], v18, s[32:35], s76 offen offset:2048 sc1
    v_mfma_f32_16x16x32_bf16 v[52:55], v[208:211], v[124:127], v[52:55]
    buffer_load_dwordx4 v[176:179], v19, s[32:35], s76 offen offset:2048 sc1
    v_mfma_f32_16x16x32_bf16 v[68:71], v[208:211], v[128:131], v[68:71]
    s_waitcnt vmcnt(9)
    s_waitcnt lgkmcnt(6)
    v_mfma_f32_16x16x32_bf16 v[32:35], v[188:191], v[132:135], v[32:35]
    ds_read_b64_tr_b16 v[196:197], v20 offset:57344
    ds_read_b64_tr_b16 v[198:199], v20 offset:59392
    v_mfma_f32_16x16x32_bf16 v[48:51], v[188:191], v[136:139], v[48:51]
    ds_read_b64_tr_b16 v[200:201], v21 offset:57344
    v_mfma_f32_16x16x32_bf16 v[64:67], v[188:191], v[140:143], v[64:67]
    ds_read_b64_tr_b16 v[202:203], v21 offset:59392
    s_waitcnt lgkmcnt(8)
    v_mfma_f32_16x16x32_bf16 v[36:39], v[192:195], v[132:135], v[36:39]
    ds_read_b32 v8, v253 offset:12
    v_mfma_f32_16x16x32_bf16 v[52:55], v[192:195], v[136:139], v[52:55]
    ds_read_b64_tr_b16 v[204:205], v22 offset:57344
    v_mfma_f32_16x16x32_bf16 v[68:71], v[192:195], v[140:143], v[68:71]
    ds_read_b64_tr_b16 v[206:207], v22 offset:59392
    s_waitcnt lgkmcnt(9)
    v_mfma_f32_16x16x32_bf16 v[24:27], v[180:183], v[132:135], v[24:27]
    ds_read_b64_tr_b16 v[208:209], v23 offset:57344
    ds_write_b128 v5, v[32:35] offset:0
    v_mfma_f32_16x16x32_bf16 v[40:43], v[180:183], v[136:139], v[40:43]
    ds_read_b64_tr_b16 v[210:211], v23 offset:59392
    ds_write_b128 v5, v[48:51] offset:2048
    v_mfma_f32_16x16x32_bf16 v[56:59], v[180:183], v[140:143], v[56:59]
    s_add_u32 s76, s76, 4096
    ds_write_b128 v5, v[64:67] offset:4096
    s_waitcnt lgkmcnt(12)
    v_mfma_f32_16x16x32_bf16 v[28:31], v[184:187], v[132:135], v[28:31]
    buffer_load_dwordx4 v[120:123], v17, s[32:35], s76 offen offset:0 sc1
    ds_write_b128 v5, v[36:39] offset:1024
    v_mfma_f32_16x16x32_bf16 v[44:47], v[184:187], v[136:139], v[44:47]
    buffer_load_dwordx4 v[124:127], v18, s[32:35], s76 offen offset:0 sc1
    ds_write_b128 v5, v[52:55] offset:3072
    v_mfma_f32_16x16x32_bf16 v[60:63], v[184:187], v[140:143], v[60:63]
    buffer_load_dwordx4 v[128:131], v19, s[32:35], s76 offen offset:0 sc1
    ds_write_b128 v5, v[68:71] offset:5120
L_join:
    s_waitcnt lgkmcnt(10)
    v_readfirstlane_b32 s85, v8
    s_nop 0
    s_cmp_lt_u32 s85, 3
    s_cbranch_scc1 lws_33
lwd_34:
    s_waitcnt lgkmcnt(0)
    ds_write_b32 v10, v252 offset:32
    s_waitcnt vmcnt(9)
    v_mfma_f32_16x16x32_bf16 v[72:75], v[196:199], v[144:147], 0
L_pad_4:
    s_cbranch_execz L_tramp
    v_add_u32 v20, 65536, v20
    v_add_u32 v21, 65536, v21
    v_add_u32 v22, 65536, v22
    v_add_u32 v23, 65536, v23
    ds_read_b64_tr_b16 v[180:181], v20 offset:0
    v_mfma_f32_16x16x32_bf16 v[88:91], v[196:199], v[148:151], 0
    ds_read_b64_tr_b16 v[182:183], v20 offset:2048
    v_mfma_f32_16x16x32_bf16 v[104:107], v[196:199], v[152:155], 0
    ds_read_b64_tr_b16 v[184:185], v21 offset:0
    v_mfma_f32_16x16x32_bf16 v[76:79], v[200:203], v[144:147], 0
    ds_read_b32 v9, v11 offset:32
    v_mfma_f32_16x16x32_bf16 v[92:95], v[200:203], v[148:151], 0
    ds_read_b64_tr_b16 v[186:187], v21 offset:2048
    v_mfma_f32_16x16x32_bf16 v[108:111], v[200:203], v[152:155], 0
    ds_read_b64_tr_b16 v[188:189], v22 offset:0
    v_mfma_f32_16x16x32_bf16 v[80:83], v[204:207], v[144:147], 0
    ds_read_b64_tr_b16 v[190:191], v22 offset:2048
    v_mfma_f32_16x16x32_bf16 v[96:99], v[204:207], v[148:151], 0
    ds_read_b64_tr_b16 v[192:193], v23 offset:0
    v_mfma_f32_16x16x32_bf16 v[112:115], v[204:207], v[152:155], 0
    ds_read_b64_tr_b16 v[194:195], v23 offset:2048
    v_mfma_f32_16x16x32_bf16 v[84:87], v[208:211], v[144:147], 0
    buffer_load_dwordx4 v[132:135], v17, s[32:35], s76 offen offset:2048 sc1
    v_mfma_f32_16x16x32_bf16 v[100:103], v[208:211], v[148:151], 0
    buffer_load_dwordx4 v[136:139], v18, s[32:35], s76 offen offset:2048 sc1
    v_mfma_f32_16x16x32_bf16 v[116:119], v[208:211], v[152:155], 0
    buffer_load_dwordx4 v[140:143], v19, s[32:35], s76 offen offset:2048 sc1
    s_waitcnt lgkmcnt(5)
    v_readfirstlane_b32 s85, v9
    s_nop 0
    s_cmp_lt_u32 s85, 1
    s_cbranch_scc1 lws_36
lwd_37:
    s_waitcnt vmcnt(9)
    v_mfma_f32_16x16x32_bf16 v[72:75], v[180:183], v[156:159], v[72:75]
    ds_read_b128 v[32:35], v6 offset:0
    ds_read_b128 v[36:39], v6 offset:1024
    v_mfma_f32_16x16x32_bf16 v[88:91], v[180:183], v[160:163], v[88:91]
    ds_read_b128 v[48:51], v6 offset:2048
    ds_read_b128 v[52:55], v6 offset:3072
    v_mfma_f32_16x16x32_bf16 v[104:107], v[180:183], v[164:167], v[104:107]
    ds_read_b128 v[64:67], v6 offset:4096
    ds_read_b128 v[68:71], v6 offset:5120
    s_waitcnt lgkmcnt(10)
    v_mfma_f32_16x16x32_bf16 v[76:79], v[184:187], v[156:159], v[76:79]
    ds_read_b64_tr_b16 v[196:197], v20 offset:8192
    ds_read_b64_tr_b16 v[198:199], v20 offset:10240
    v_mfma_f32_16x16x32_bf16 v[92:95], v[184:187], v[160:163], v[92:95]
    ds_read_b64_tr_b16 v[200:201], v21 offset:8192
    ds_read_b64_tr_b16 v[202:203], v21 offset:10240
    v_mfma_f32_16x16x32_bf16 v[108:111], v[184:187], v[164:167], v[108:111]
    ds_read_b32 v8, v253 offset:12
    ds_read_b32 v9, v253 offset:72
    s_waitcnt lgkmcnt(14)
    v_mfma_f32_16x16x32_bf16 v[80:83], v[188:191], v[156:159], v[80:83]
    ds_read_b64_tr_b16 v[204:205], v22 offset:8192
    ds_read_b64_tr_b16 v[206:207], v22 offset:10240
    v_mfma_f32_16x16x32_bf16 v[96:99], v[188:191], v[160:163], v[96:99]
    ds_read_b64_tr_b16 v[208:209], v23 offset:8192
    ds_read_b64_tr_b16 v[210:211], v23 offset:10240
    v_mfma_f32_16x16x32_bf16 v[112:115], v[188:191], v[164:167], v[112:115]
    s_add_u32 s76, s76, 4096
    s_waitcnt lgkmcnt(14)
    v_mfma_f32_16x16x32_bf16 v[84:87], v[192:195], v[156:159], v[84:87]
    buffer_load_dwordx4 v[144:147], v17, s[32:35], s76 offen offset:0 sc1
    v_mfma_f32_16x16x32_bf16 v[100:103], v[192:195], v[160:163], v[100:103]
    buffer_load_dwordx4 v[148:151], v18, s[32:35], s76 offen offset:0 sc1
    v_mfma_f32_16x16x32_bf16 v[116:119], v[192:195], v[164:167], v[116:119]
    buffer_load_dwordx4 v[152:155], v19, s[32:35], s76 offen offset:0 sc1
    s_waitcnt lgkmcnt(5)
    v_readfirstlane_b32 s85, v8
    s_nop 0
    s_cmp_lt_u32 s85, 4
    s_cbranch_scc1 lws_39
lwd_40:
    s_waitcnt lgkmcnt(4)
    v_readfirstlane_b32 s85, v9
    s_nop 0
    s_cmp_lt_u32 s85, 4
    s_cbranch_scc1 lws_42
lwd_43:
    s_waitcnt vmcnt(9)
    v_mfma_f32_16x16x32_bf16 v[72:75], v[196:199], v[168:171], v[72:75]
    ds_read_b64 v[212:213], v7 offset:0
    ds_read_b64 v[214:215], v16 offset:0
    v_add_f32 v24, v24, v32
    v_add_f32 v25, v25, v33
    v_mfma_f32_16x16x32_bf16 v[88:91], v[196:199], v[172:175], v[88:91]
    ds_read_b64 v[216:217], v7 offset:2048
    ds_read_b64 v[218:219], v16 offset:2048
    v_add_f32 v26, v26, v34
    v_add_f32 v27, v27, v35
    v_mfma_f32_16x16x32_bf16 v[104:107], v[196:199], v[176:179], v[104:107]
    ds_read_b64 v[220:221], v7 offset:4096
    ds_read_b64 v[222:223], v16 offset:4096
    v_add_f32 v28, v28, v36
    v_add_f32 v29, v29, v37
    v_mfma_f32_16x16x32_bf16 v[76:79], v[200:203], v[168:171], v[76:79]
    v_add_u32 v20, -131072, v20
    v_add_u32 v21, -131072, v21
    v_add_u32 v22, -131072, v22
    v_add_u32 v23, -131072, v23
    ds_read_b64_tr_b16 v[180:181], v20 offset:0
    v_add_f32 v30, v30, v38
    v_add_f32 v31, v31, v39
    v_mfma_f32_16x16x32_bf16 v[92:95], v[200:203], v[172:175], v[92:95]
    ds_read_b64_tr_b16 v[182:183], v20 offset:2048
    ds_read_b64_tr_b16 v[184:185], v21 offset:0
    v_exp_f32 v224, v24
    v_mfma_f32_16x16x32_bf16 v[108:111], v[200:203], v[176:179], v[108:111]
    ds_read_b64_tr_b16 v[186:187], v21 offset:2048
    ds_read_b64_tr_b16 v[188:189], v22 offset:0
    v_exp_f32 v225, v25
    s_waitcnt lgkmcnt(13)
    v_mfma_f32_16x16x32_bf16 v[80:83], v[204:207], v[168:171], v[80:83]
    ds_read_b64_tr_b16 v[190:191], v22 offset:2048
    v_exp_f32 v226, v26
    v_mfma_f32_16x16x32_bf16 v[96:99], v[204:207], v[172:175], v[96:99]
    ds_read_b64_tr_b16 v[192:193], v23 offset:0
    v_exp_f32 v227, v27
    v_mfma_f32_16x16x32_bf16 v[112:115], v[204:207], v[176:179], v[112:115]
    ds_read_b64_tr_b16 v[194:195], v23 offset:2048
    v_exp_f32 v228, v28
    s_waitcnt lgkmcnt(14)
    v_mfma_f32_16x16x32_bf16 v[84:87], v[208:211], v[168:171], v[84:87]
    buffer_load_dwordx4 v[156:159], v17, s[32:35], s76 offen offset:2048 sc1
    v_exp_f32 v229, v29
    v_mfma_f32_16x16x32_bf16 v[100:103], v[208:211], v[172:175], v[100:103]
    buffer_load_dwordx4 v[160:163], v18, s[32:35], s76 offen offset:2048 sc1
    v_exp_f32 v230, v30
    v_mfma_f32_16x16x32_bf16 v[116:119], v[208:211], v[176:179], v[116:119]
    buffer_load_dwordx4 v[164:167], v19, s[32:35], s76 offen offset:2048 sc1
    v_exp_f32 v231, v31
    v_fma_f32 v224, v224, v12, v12
    v_fma_f32 v225, v225, v12, v12
    s_waitcnt lgkmcnt(8)
    s_waitcnt vmcnt(9)
    s_waitcnt lgkmcnt(6)
    v_mfma_f32_16x16x32_bf16 v[72:75], v[180:183], v[120:123], v[72:75]
    ds_read_b64_tr_b16 v[196:197], v20 offset:8192
    ds_read_b64_tr_b16 v[198:199], v20 offset:10240
    v_fma_f32 v226, v226, v12, v12
    v_fma_f32 v227, v227, v12, v12
    v_mfma_f32_16x16x32_bf16 v[88:91], v[180:183], v[124:127], v[88:91]
    ds_read_b64_tr_b16 v[200:201], v21 offset:8192
    v_fma_f32 v228, v228, v12, v12
    v_fma_f32 v229, v229, v12, v12
    v_mfma_f32_16x16x32_bf16 v[104:107], v[180:183], v[128:131], v[104:107]
    ds_read_b64_tr_b16 v[202:203], v21 offset:10240
    v_fma_f32 v230, v230, v12, v12
    v_fma_f32 v231, v231, v12, v12
    s_waitcnt lgkmcnt(8)
    v_mfma_f32_16x16x32_bf16 v[76:79], v[184:187], v[120:123], v[76:79]
    ds_read_b32 v8, v253 offset:12
    v_rcp_f32 v224, v224
    v_mfma_f32_16x16x32_bf16 v[92:95], v[184:187], v[124:127], v[92:95]
    ds_read_b64_tr_b16 v[204:205], v22 offset:8192
    v_rcp_f32 v225, v225
    v_mfma_f32_16x16x32_bf16 v[108:111], v[184:187], v[128:131], v[108:111]
    ds_read_b64_tr_b16 v[206:207], v22 offset:10240
    v_rcp_f32 v226, v226
    s_waitcnt lgkmcnt(9)
    v_mfma_f32_16x16x32_bf16 v[80:83], v[188:191], v[120:123], v[80:83]
    ds_read_b64_tr_b16 v[208:209], v23 offset:8192
    v_rcp_f32 v227, v227
    v_mfma_f32_16x16x32_bf16 v[96:99], v[188:191], v[124:127], v[96:99]
    ds_read_b64_tr_b16 v[210:211], v23 offset:10240
    v_rcp_f32 v228, v228
    v_mfma_f32_16x16x32_bf16 v[112:115], v[188:191], v[128:131], v[112:115]
    s_add_u32 s76, s76, 4096
    v_rcp_f32 v229, v229
    s_waitcnt lgkmcnt(9)
    v_mfma_f32_16x16x32_bf16 v[84:87], v[192:195], v[120:123], v[84:87]
    buffer_load_dwordx4 v[168:171], v17, s[32:35], s76 offen offset:0 sc1
    v_rcp_f32 v230, v230
    v_mfma_f32_16x16x32_bf16 v[100:103], v[192:195], v[124:127], v[100:103]
    buffer_load_dwordx4 v[172:175], v18, s[32:35], s76 offen offset:0 sc1
    v_rcp_f32 v231, v231
    v_mul_f32 v24, v24, v224
    v_mfma_f32_16x16x32_bf16 v[116:119], v[192:195], v[128:131], v[116:119]
    buffer_load_dwordx4 v[176:179], v19, s[32:35], s76 offen offset:0 sc1
    v_mul_f32 v25, v25, v225
    v_mul_f32 v26, v26, v226
    v_mul_f32 v27, v27, v227
    s_waitcnt lgkmcnt(4)
    v_readfirstlane_b32 s85, v8
    s_nop 0
    s_cmp_lt_u32 s85, 5
    s_cbranch_scc1 lws_45
lwd_46:
    s_waitcnt vmcnt(9)
    v_mfma_f32_16x16x32_bf16 v[72:75], v[196:199], v[132:135], v[72:75]
    ds_read_b64_tr_b16 v[180:181], v20 offset:16384
    v_mul_f32 v28, v28, v228
    v_mul_f32 v29, v29, v229
    v_mfma_f32_16x16x32_bf16 v[88:91], v[196:199], v[136:139], v[88:91]
    ds_read_b64_tr_b16 v[182:183], v20 offset:18432
    v_mul_f32 v30, v30, v230
    v_mul_f32 v31, v31, v231
    v_mfma_f32_16x16x32_bf16 v[104:107], v[196:199], v[140:143], v[104:107]
    ds_read_b64_tr_b16 v[184:185], v21 offset:16384
    v_add_f32 v40, v40, v48
    v_add_f32 v41, v41, v49
    v_mfma_f32_16x16x32_bf16 v[76:79], v[200:203], v[132:135], v[76:79]
    ds_read_b64_tr_b16 v[186:187], v21 offset:18432
    v_add_f32 v42, v42, v50
    v_add_f32 v43, v43, v51
    v_mfma_f32_16x16x32_bf16 v[92:95], v[200:203], v[136:139], v[92:95]
    ds_read_b64_tr_b16 v[188:189], v22 offset:16384
    v_add_f32 v44, v44, v52
    v_add_f32 v45, v45, v53
    v_mfma_f32_16x16x32_bf16 v[108:111], v[200:203], v[140:143], v[108:111]
    ds_read_b64_tr_b16 v[190:191], v22 offset:18432
    v_add_f32 v46, v46, v54
    v_add_f32 v47, v47, v55
    s_waitcnt lgkmcnt(8)
    v_mfma_f32_16x16x32_bf16 v[80:83], v[204:207], v[132:135], v[80:83]
    ds_read_b64_tr_b16 v[192:193], v23 offset:16384
    v_exp_f32 v224, v40
    v_mfma_f32_16x16x32_bf16 v[96:99], v[204:207], v[136:139], v[96:99]
    ds_read_b64_tr_b16 v[194:195], v23 offset:18432
    v_exp_f32 v225, v41
    v_mfma_f32_16x16x32_bf16 v[112:115], v[204:207], v[140:143], v[112:115]
    buffer_load_dwordx4 v[120:123], v17, s[32:35], s76 offen offset:2048 sc1
    v_exp_f32 v226, v42
    s_waitcnt lgkmcnt(8)
    v_mfma_f32_16x16x32_bf16 v[84:87], v[208:211], v[132:135], v[84:87]
    buffer_load_dwordx4 v[124:127], v18, s[32:35], s76 offen offset:2048 sc1
    v_exp_f32 v227, v43
    v_mfma_f32_16x16x32_bf16 v[100:103], v[208:211], v[136:139], v[100:103]
    buffer_load_dwordx4 v[128:131], v19, s[32:35], s76 offen offset:2048 sc1
    v_exp_f32 v228, v44
    v_mfma_f32_16x16x32_bf16 v[116:119], v[208:211], v[140:143], v[116:119]
    v_exp_f32 v229, v45
    s_waitcnt vmcnt(9)
    s_waitcnt lgkmcnt(6)
    v_mfma_f32_16x16x32_bf16 v[72:75], v[180:183], v[144:147], v[72:75]
    ds_read_b64_tr_b16 v[196:197], v20 offset:24576
    v_exp_f32 v230, v46
    v_mfma_f32_16x16x32_bf16 v[88:91], v[180:183], v[148:151], v[88:91]
    ds_read_b64_tr_b16 v[198:199], v20 offset:26624
    v_exp_f32 v231, v47
    v_mfma_f32_16x16x32_bf16 v[104:107], v[180:183], v[152:155], v[104:107]
    ds_read_b64_tr_b16 v[200:201], v21 offset:24576
    v_fma_f32 v224, v224, v12, v12
    v_fma_f32 v225, v225, v12, v12
    v_fma_f32 v226, v226, v12, v12
    s_waitcnt lgkmcnt(7)
    v_mfma_f32_16x16x32_bf16 v[76:79], v[184:187], v[144:147], v[76:79]
    ds_read_b64_tr_b16 v[202:203], v21 offset:26624
    v_fma_f32 v227, v227, v12, v12
    v_fma_f32 v228, v228, v12, v12
    v_mfma_f32_16x16x32_bf16 v[92:95], v[184:187], v[148:151], v[92:95]
    ds_read_b64_tr_b16 v[204:205], v22 offset:24576
    v_fma_f32 v229, v229, v12, v12
    v_fma_f32 v230, v230, v12, v12
    v_mfma_f32_16x16x32_bf16 v[108:111], v[184:187], v[152:155], v[108:111]
    ds_read_b64_tr_b16 v[206:207], v22 offset:26624
    v_fma_f32 v231, v231, v12, v12
    v_rcp_f32 v224, v224
    s_waitcnt lgkmcnt(8)
    v_mfma_f32_16x16x32_bf16 v[80:83], v[188:191], v[144:147], v[80:83]
    ds_read_b64_tr_b16 v[208:209], v23 offset:24576
    v_rcp_f32 v225, v225
    v_mfma_f32_16x16x32_bf16 v[96:99], v[188:191], v[148:151], v[96:99]
    ds_read_b64_tr_b16 v[210:211], v23 offset:26624
    v_rcp_f32 v226, v226
    v_mfma_f32_16x16x32_bf16 v[112:115], v[188:191], v[152:155], v[112:115]
    s_add_u32 s76, s76, 4096
    v_rcp_f32 v227, v227
    s_waitcnt lgkmcnt(8)
    v_mfma_f32_16x16x32_bf16 v[84:87], v[192:195], v[144:147], v[84:87]
    buffer_load_dwordx4 v[132:135], v17, s[32:35], s76 offen offset:0 sc1
    v_rcp_f32 v228, v228
    v_mfma_f32_16x16x32_bf16 v[100:103], v[192:195], v[148:151], v[100:103]
    buffer_load_dwordx4 v[136:139], v18, s[32:35], s76 offen offset:0 sc1
    v_rcp_f32 v229, v229
    v_mfma_f32_16x16x32_bf16 v[116:119], v[192:195], v[152:155], v[116:119]
    buffer_load_dwordx4 v[140:143], v19, s[32:35], s76 offen offset:0 sc1
    v_rcp_f32 v230, v230
    v_rcp_f32 v231, v231
    s_waitcnt vmcnt(9)
    s_waitcnt lgkmcnt(6)
    v_mfma_f32_16x16x32_bf16 v[72:75], v[196:199], v[156:159], v[72:75]
    ds_read_b64_tr_b16 v[180:181], v20 offset:32768
    v_mul_f32 v40, v40, v224
    v_mfma_f32_16x16x32_bf16 v[88:91], v[196:199], v[160:163], v[88:91]
    ds_read_b64_tr_b16 v[182:183], v20 offset:34816
    v_mul_f32 v41, v41, v225
    v_mul_f32 v42, v42, v226
    v_mfma_f32_16x16x32_bf16 v[104:107], v[196:199], v[164:167], v[104:107]
    ds_read_b64_tr_b16 v[184:185], v21 offset:32768
    v_mul_f32 v43, v43, v227
    v_mul_f32 v44, v44, v228
    s_waitcnt lgkmcnt(7)
    v_mfma_f32_16x16x32_bf16 v[76:79], v[200:203], v[156:159], v[76:79]
    ds_read_b64_tr_b16 v[186:187], v21 offset:34816
    v_mul_f32 v45, v45, v229
    v_mfma_f32_16x16x32_bf16 v[92:95], v[200:203], v[160:163], v[92:95]
    ds_read_b64_tr_b16 v[188:189], v22 offset:32768
    v_mul_f32 v46, v46, v230
    v_mul_f32 v47, v47, v231
    v_mfma_f32_16x16x32_bf16 v[108:111], v[200:203], v[164:167], v[108:111]
    ds_read_b64_tr_b16 v[190:191], v22 offset:34816
    v_add_f32 v56, v56, v64
    v_add_f32 v57, v57, v65
    s_waitcnt lgkmcnt(8)
    v_mfma_f32_16x16x32_bf16 v[80:83], v[204:207], v[156:159], v[80:83]
    ds_read_b64_tr_b16 v[192:193], v23 offset:32768
    v_add_f32 v58, v58, v66
    v_mfma_f32_16x16x32_bf16 v[96:99], v[204:207], v[160:163], v[96:99]
    ds_read_b64_tr_b16 v[194:195], v23 offset:34816
    v_add_f32 v59, v59, v67
    v_add_f32 v60, v60, v68
    v_mfma_f32_16x16x32_bf16 v[112:115], v[204:207], v[164:167], v[112:115]
    v_add_f32 v61, v61, v69
    v_add_f32 v62, v62, v70
    s_waitcnt lgkmcnt(8)
    v_mfma_f32_16x16x32_bf16 v[84:87], v[208:211], v[156:159], v[84:87]
    v_add_f32 v63, v63, v71
    v_mfma_f32_16x16x32_bf16 v[100:103], v[208:211], v[160:163], v[100:103]
    v_exp_f32 v224, v56
    v_mfma_f32_16x16x32_bf16 v[116:119], v[208:211], v[164:167], v[116:119]
    v_exp_f32 v225, v57
    s_waitcnt vmcnt(6)
    s_waitcnt lgkmcnt(6)
    v_mfma_f32_16x16x32_bf16 v[72:75], v[180:183], v[168:171], v[72:75]
    ds_read_b64_tr_b16 v[204:205], v22 offset:40960
    v_exp_f32 v226, v58
    v_mfma_f32_16x16x32_bf16 v[88:91], v[180:183], v[172:175], v[88:91]
    ds_read_b64_tr_b16 v[206:207], v22 offset:43008
    v_exp_f32 v227, v59
    v_mfma_f32_16x16x32_bf16 v[104:107], v[180:183], v[176:179], v[104:107]
    ds_read_b64_tr_b16 v[208:209], v23 offset:40960
    v_exp_f32 v228, v60
    s_waitcnt lgkmcnt(7)
    v_mfma_f32_16x16x32_bf16 v[76:79], v[184:187], v[168:171], v[76:79]
    ds_read_b64_tr_b16 v[210:211], v23 offset:43008
    v_exp_f32 v229, v61
    v_mfma_f32_16x16x32_bf16 v[92:95], v[184:187], v[172:175], v[92:95]
    ds_read_b64_tr_b16 v[196:197], v20 offset:40960
    v_exp_f32 v230, v62
    v_mfma_f32_16x16x32_bf16 v[108:111], v[184:187], v[176:179], v[108:111]
    ds_read_b64_tr_b16 v[198:199], v20 offset:43008
    v_exp_f32 v231, v63
    v_fma_f32 v224, v224, v12, v12
    v_fma_f32 v225, v225, v12, v12
    s_waitcnt lgkmcnt(8)
    v_mfma_f32_16x16x32_bf16 v[80:83], v[188:191], v[168:171], v[80:83]
    ds_read_b64_tr_b16 v[200:201], v21 offset:40960
    v_fma_f32 v226, v226, v12, v12
    v_fma_f32 v227, v227, v12, v12
    v_mfma_f32_16x16x32_bf16 v[96:99], v[188:191], v[172:175], v[96:99]
    ds_read_b64_tr_b16 v[202:203], v21 offset:43008
    v_fma_f32 v228, v228, v12, v12
    v_fma_f32 v229, v229, v12, v12
    v_mfma_f32_16x16x32_bf16 v[112:115], v[188:191], v[176:179], v[112:115]
    v_fma_f32 v230, v230, v12, v12
    v_fma_f32 v231, v231, v12, v12
    s_waitcnt lgkmcnt(8)
    v_mfma_f32_16x16x32_bf16 v[84:87], v[192:195], v[168:171], v[84:87]
    v_rcp_f32 v224, v224
    v_mfma_f32_16x16x32_bf16 v[100:103], v[192:195], v[172:175], v[100:103]
    v_rcp_f32 v225, v225
    v_mfma_f32_16x16x32_bf16 v[116:119], v[192:195], v[176:179], v[116:119]
    v_rcp_f32 v226, v226
    v_rcp_f32 v227, v227
    s_waitcnt vmcnt(3)
    s_waitcnt lgkmcnt(6)
    v_mfma_f32_16x16x32_bf16 v[80:83], v[204:207], v[120:123], v[80:83]
    ds_read_b64_tr_b16 v[188:189], v22 offset:49152
    v_mfma_f32_16x16x32_bf16 v[96:99], v[204:207], v[124:127], v[96:99]
    ds_read_b64_tr_b16 v[190:191], v22 offset:51200
    v_rcp_f32 v228, v228
    v_mfma_f32_16x16x32_bf16 v[112:115], v[204:207], v[128:131], v[112:115]
    ds_read_b64_tr_b16 v[192:193], v23 offset:49152
    v_rcp_f32 v229, v229
    s_waitcnt lgkmcnt(7)
    v_mfma_f32_16x16x32_bf16 v[84:87], v[208:211], v[120:123], v[84:87]
    ds_read_b64_tr_b16 v[194:195], v23 offset:51200
    v_rcp_f32 v230, v230
    v_mfma_f32_16x16x32_bf16 v[100:103], v[208:211], v[124:127], v[100:103]
    ds_read_b64_tr_b16 v[180:181], v20 offset:49152
    v_rcp_f32 v231, v231
    v_mul_f32 v56, v56, v224
    v_mfma_f32_16x16x32_bf16 v[116:119], v[208:211], v[128:131], v[116:119]
    ds_read_b64_tr_b16 v[182:183], v20 offset:51200
    v_mul_f32 v57, v57, v225
    v_mul_f32 v58, v58, v226
    s_waitcnt vmcnt(0)
    s_waitcnt lgkmcnt(4)
    v_mfma_f32_16x16x32_bf16 v[80:83], v[188:191], v[132:135], v[80:83]
    ds_read_b64_tr_b16 v[184:185], v21 offset:49152
    v_mul_f32 v59, v59, v227
    v_mfma_f32_16x16x32_bf16 v[96:99], v[188:191], v[136:139], v[96:99]
    ds_read_b64_tr_b16 v[186:187], v21 offset:51200
    v_mul_f32 v60, v60, v228
    v_mul_f32 v61, v61, v229
    v_mfma_f32_16x16x32_bf16 v[112:115], v[188:191], v[140:143], v[112:115]
    v_mul_f32 v62, v62, v230
    v_mul_f32 v63, v63, v231
    s_waitcnt lgkmcnt(4)
    v_mfma_f32_16x16x32_bf16 v[84:87], v[192:195], v[132:135], v[84:87]
    v_lshlrev_b32 v32, 16, v212
    v_and_b32 v33, 0xffff0000, v212
    v_mfma_f32_16x16x32_bf16 v[100:103], v[192:195], v[136:139], v[100:103]
    v_lshlrev_b32 v34, 16, v213
    v_and_b32 v35, 0xffff0000, v213
    v_mfma_f32_16x16x32_bf16 v[116:119], v[192:195], v[140:143], v[116:119]
    v_lshlrev_b32 v36, 16, v214
    v_and_b32 v37, 0xffff0000, v214
    v_mfma_f32_16x16x32_bf16 v[72:75], v[196:199], v[120:123], v[72:75]
    ds_write_b128 v6, v[80:83] offset:0
    v_lshlrev_b32 v38, 16, v215
    v_mfma_f32_16x16x32_bf16 v[88:91], v[196:199], v[124:127], v[88:91]
    ds_write_b128 v6, v[96:99] offset:2048
    v_and_b32 v39, 0xffff0000, v215
    v_lshlrev_b32 v48, 16, v216
    v_mfma_f32_16x16x32_bf16 v[104:107], v[196:199], v[128:131], v[104:107]
    ds_write_b128 v6, v[112:115] offset:4096
    v_and_b32 v49, 0xffff0000, v216
    v_mfma_f32_16x16x32_bf16 v[76:79], v[200:203], v[120:123], v[76:79]
    ds_write_b128 v6, v[84:87] offset:1024
    v_lshlrev_b32 v50, 16, v217
    v_and_b32 v51, 0xffff0000, v217
    v_mfma_f32_16x16x32_bf16 v[92:95], v[200:203], v[124:127], v[92:95]
    ds_write_b128 v6, v[100:103] offset:3072
    v_lshlrev_b32 v52, 16, v218
    v_mfma_f32_16x16x32_bf16 v[108:111], v[200:203], v[128:131], v[108:111]
    ds_write_b128 v6, v[116:119] offset:5120
    v_and_b32 v53, 0xffff0000, v218
    v_lshlrev_b32 v54, 16, v219
    s_waitcnt lgkmcnt(8)
    v_mfma_f32_16x16x32_bf16 v[72:75], v[180:183], v[132:135], v[72:75]
    v_and_b32 v55, 0xffff0000, v219
    v_mfma_f32_16x16x32_bf16 v[88:91], v[180:183], v[136:139], v[88:91]
    v_lshlrev_b32 v64, 16, v220
    v_and_b32 v65, 0xffff0000, v220
    v_mfma_f32_16x16x32_bf16 v[104:107], v[180:183], v[140:143], v[104:107]
    v_lshlrev_b32 v66, 16, v221
    s_waitcnt lgkmcnt(6)
    v_mfma_f32_16x16x32_bf16 v[76:79], v[184:187], v[132:135], v[76:79]
    v_and_b32 v67, 0xffff0000, v221
    v_lshlrev_b32 v68, 16, v222
    v_mfma_f32_16x16x32_bf16 v[92:95], v[184:187], v[136:139], v[92:95]
    s_waitcnt lgkmcnt(0)
    s_barrier
    ds_read_b128 v[80:83], v5 offset:0
    ds_read_b128 v[84:87], v5 offset:1024
    v_and_b32 v69, 0xffff0000, v222
    v_mfma_f32_16x16x32_bf16 v[108:111], v[184:187], v[140:143], v[108:111]
    ds_read_b128 v[96:99], v5 offset:2048
    ds_read_b128 v[100:103], v5 offset:3072
    ds_read_b128 v[112:115], v5 offset:4096
    ds_read_b128 v[116:119], v5 offset:5120
    v_lshlrev_b32 v70, 16, v223
    v_and_b32 v71, 0xffff0000, v223
    v_pk_fma_f32 v[32:33], v[24:25], v[72:73], v[32:33]
    v_pk_fma_f32 v[34:35], v[26:27], v[74:75], v[34:35]
    v_pk_fma_f32 v[36:37], v[28:29], v[76:77], v[36:37]
    v_pk_fma_f32 v[38:39], v[30:31], v[78:79], v[38:39]
    v_pk_fma_f32 v[48:49], v[40:41], v[88:89], v[48:49]
    v_pk_fma_f32 v[50:51], v[42:43], v[90:91], v[50:51]
    v_pk_fma_f32 v[52:53], v[44:45], v[92:93], v[52:53]
    v_pk_fma_f32 v[54:55], v[46:47], v[94:95], v[54:55]
    v_pk_fma_f32 v[64:65], v[56:57], v[104:105], v[64:65]
    v_pk_fma_f32 v[66:67], v[58:59], v[106:107], v[66:67]
    v_pk_fma_f32 v[68:69], v[60:61], v[108:109], v[68:69]
    v_pk_fma_f32 v[70:71], v[62:63], v[110:111], v[70:71]
    s_waitcnt lgkmcnt(4)
    v_pk_fma_f32 v[32:33], v[24:25], v[80:81], v[32:33]
    v_pk_fma_f32 v[34:35], v[26:27], v[82:83], v[34:35]
    v_pk_fma_f32 v[36:37], v[28:29], v[84:85], v[36:37]
    v_pk_fma_f32 v[38:39], v[30:31], v[86:87], v[38:39]
    v_cvt_pk_bf16_f32 v212, v32, v33
    v_cvt_pk_bf16_f32 v213, v34, v35
    v_cvt_pk_bf16_f32 v214, v36, v37
    v_cvt_pk_bf16_f32 v215, v38, v39
    ds_write_b64 v7, v[212:213] offset:0
    ds_write_b64 v16, v[214:215] offset:0
    s_waitcnt lgkmcnt(4)
    v_pk_fma_f32 v[48:49], v[40:41], v[96:97], v[48:49]
    v_pk_fma_f32 v[50:51], v[42:43], v[98:99], v[50:51]
    v_pk_fma_f32 v[52:53], v[44:45], v[100:101], v[52:53]
    v_pk_fma_f32 v[54:55], v[46:47], v[102:103], v[54:55]
    v_cvt_pk_bf16_f32 v216, v48, v49
    v_cvt_pk_bf16_f32 v217, v50, v51
    v_cvt_pk_bf16_f32 v218, v52, v53
    v_cvt_pk_bf16_f32 v219, v54, v55
    ds_write_b64 v7, v[216:217] offset:2048
    ds_write_b64 v16, v[218:219] offset:2048
    s_waitcnt lgkmcnt(4)
    v_pk_fma_f32 v[64:65], v[56:57], v[112:113], v[64:65]
    v_pk_fma_f32 v[66:67], v[58:59], v[114:115], v[66:67]
    v_pk_fma_f32 v[68:69], v[60:61], v[116:117], v[68:69]
    v_pk_fma_f32 v[70:71], v[62:63], v[118:119], v[70:71]
    v_cvt_pk_bf16_f32 v220, v64, v65
    v_cvt_pk_bf16_f32 v221, v66, v67
    v_cvt_pk_bf16_f32 v222, v68, v69
    v_cvt_pk_bf16_f32 v223, v70, v71
    ds_write_b64 v7, v[220:221] offset:4096
    ds_write_b64 v16, v[222:223] offset:4096
    s_waitcnt lgkmcnt(0)
    s_barrier
    ds_read_b128 v[72:75], v14 offset:0
    ds_read_b128 v[88:91], v14 offset:2048
    ds_read_b128 v[104:107], v14 offset:4096
    s_waitcnt lgkmcnt(2)
    buffer_store_dwordx4 v[72:75], v4, s[52:55], s80 offen sc0 sc1 nt
    s_waitcnt lgkmcnt(1)
    buffer_store_dwordx4 v[88:91], v4, s[52:55], s81 offen sc0 sc1 nt
    s_waitcnt lgkmcnt(0)
    buffer_store_dwordx4 v[104:107], v4, s[52:55], s82 offen sc0 sc1 nt
    s_endpgm
L_nop2:
    s_waitcnt vmcnt(0)
    s_mov_b64 exec, 1
    ds_add_rtn_u32 v254, v253, v252 offset:28
    s_mov_b64 exec, -1
    s_waitcnt lgkmcnt(0)
    v_readfirstlane_b32 s85, v254
    s_nop 0
    s_cmp_eq_u32 s85, 3
    s_cselect_b32 s85, s71, 2130706432
    s_nop 1
    buffer_store_dword v252, v251, s[36:39], s85 offen offset:256 sc1
    s_branch L_fin
pslow_6:
    s_mov_b32 s85, 200000
poll_5:
    s_sleep 2
    buffer_load_dword v249, v250, s[36:39], 0 offen sc1
    s_waitcnt vmcnt(0)
    v_cmp_ne_u32 vcc, 1, v249
    s_nop 1
    s_cmp_eq_u64 vcc, 0
    s_cbranch_scc1 pdone_7
    s_sub_u32 s85, s85, 1
    s_cmp_lg_u32 s85, 0
    s_cbranch_scc1 poll_5
    s_branch pdone_7
slow_2:
L_pad_1:
    s_cbranch_execz L_tramp
    buffer_load_dword v249, v250, s[36:39], 0 offen sc1
    s_waitcnt vmcnt(1)
    s_mov_b64 exec, 1
    ds_add_rtn_u32 v254, v253, v252 offset:28
    s_mov_b64 exec, -1
    s_waitcnt lgkmcnt(0)
    v_readfirstlane_b32 s85, v254
    s_nop 0
    s_cmp_eq_u32 s85, 3
    s_cselect_b32 s85, s71, 2130706432
    s_nop 1
    buffer_store_dword v252, v251, s[36:39], s85 offen offset:256 sc1
    s_waitcnt vmcnt(1)
    v_cmp_ne_u32 vcc, 1, v249
    s_nop 1
    s_cmp_lg_u64 vcc, 0
    s_cbranch_scc1 pslow_6
pdone_7:
got_4:
    s_mov_b64 exec, 1
    ds_add_u32 v253, v15 offset:16
    s_mov_b64 exec, -1
    s_branch back_3
lws_9:
    s_mov_b32 s84, 1600000
lw_8:
    s_sleep 1
    ds_read_b32 v8, v253 offset:16
    s_waitcnt lgkmcnt(0)
    v_readfirstlane_b32 s85, v8
    s_nop 0
    s_cmp_ge_u32 s85, 5
    s_cbranch_scc1 lwd_10
    s_sub_u32 s84, s84, 1
    s_cmp_lg_u32 s84, 0
    s_cbranch_scc1 lw_8
    s_branch lwd_10
pslow_12:
    s_mov_b32 s85, 200000
poll_11:
    s_sleep 2
    buffer_load_dword v249, v250, s[36:39], 0 offen sc1
    s_waitcnt vmcnt(0)
    v_cmp_ne_u32 vcc, s3, v249
    s_nop 1
    s_cmp_eq_u64 vcc, 0
    s_cbranch_scc1 pdone_13
    s_sub_u32 s85, s85, 1
    s_cmp_lg_u32 s85, 0
    s_cbranch_scc1 poll_11
    s_branch pdone_13
lws_15:
    s_mov_b32 s84, 1600000
lw_14:
    ds_read_b32 v9, v253 offset:16
    s_waitcnt lgkmcnt(0)
    v_readfirstlane_b32 s85, v9
    s_nop 0
    s_cmp_ge_u32 s85, 6
    s_cbranch_scc1 lwd_16
    s_sub_u32 s84, s84, 1
    s_cmp_lg_u32 s84, 0
    s_cbranch_scc1 lw_14
    s_branch lwd_16
lws_18:
    s_mov_b32 s84, 1600000
lw_17:
    ds_read_b32 v9, v253 offset:64
    s_waitcnt lgkmcnt(0)
    v_readfirstlane_b32 s85, v9
    s_nop 0
    s_cmp_ge_u32 s85, 4
    s_cbranch_scc1 lwd_19
    s_sub_u32 s84, s84, 1
    s_cmp_lg_u32 s84, 0
    s_cbranch_scc1 lw_17
    s_branch lwd_19
lws_21:
    s_mov_b32 s84, 1600000
lw_20:
    ds_read_b32 v8, v253 offset:12
    s_waitcnt lgkmcnt(0)
    v_readfirstlane_b32 s85, v8
    s_nop 0
    s_cmp_ge_u32 s85, 1
    s_cbranch_scc1 lwd_22
    s_sub_u32 s84, s84, 1
    s_cmp_lg_u32 s84, 0
    s_cbranch_scc1 lw_20
    s_branch lwd_22
lws_24:
    s_mov_b32 s84, 1600000
lw_23:
    ds_read_b32 v8, v253 offset:12
    s_waitcnt lgkmcnt(0)
    v_readfirstlane_b32 s85, v8
    s_nop 0
    s_cmp_ge_u32 s85, 2
    s_cbranch_scc1 lwd_25
    s_sub_u32 s84, s84, 1
    s_cmp_lg_u32 s84, 0
    s_cbranch_scc1 lw_23
    s_branch lwd_25
L_oslow:
    s_waitcnt vmcnt(9)
    v_mfma_f32_16x16x32_bf16 v[24:27], v[196:199], v[156:159], v[24:27]
    ds_read_b64_tr_b16 v[180:181], v20 offset:32768
    v_mfma_f32_16x16x32_bf16 v[40:43], v[196:199], v[160:163], v[40:43]
    ds_read_b64_tr_b16 v[182:183], v20 offset:34816
    v_mfma_f32_16x16x32_bf16 v[56:59], v[196:199], v[164:167], v[56:59]
    ds_read_b64_tr_b16 v[184:185], v21 offset:32768
    v_mfma_f32_16x16x32_bf16 v[28:31], v[200:203], v[156:159], v[28:31]
    ds_read_b64_tr_b16 v[186:187], v21 offset:34816
    v_mfma_f32_16x16x32_bf16 v[44:47], v[200:203], v[160:163], v[44:47]
    ds_read_b64_tr_b16 v[188:189], v22 offset:32768
    v_mfma_f32_16x16x32_bf16 v[60:63], v[200:203], v[164:167], v[60:63]
    ds_read_b64_tr_b16 v[190:191], v22 offset:34816
    s_waitcnt lgkmcnt(8)
    v_mfma_f32_16x16x32_bf16 v[32:35], v[204:207], v[156:159], v[32:35]
    ds_read_b64_tr_b16 v[192:193], v23 offset:32768
    v_mfma_f32_16x16x32_bf16 v[48:51], v[204:207], v[160:163], v[48:51]
    ds_read_b64_tr_b16 v[194:195], v23 offset:34816
    v_mfma_f32_16x16x32_bf16 v[64:67], v[204:207], v[164:167], v[64:67]
    s_waitcnt lgkmcnt(8)
    v_mfma_f32_16x16x32_bf16 v[36:39], v[208:211], v[156:159], v[36:39]
    v_mfma_f32_16x16x32_bf16 v[52:55], v[208:211], v[160:163], v[52:55]
    v_mfma_f32_16x16x32_bf16 v[68:71], v[208:211], v[164:167], v[68:71]
    s_waitcnt vmcnt(6)
    s_waitcnt lgkmcnt(6)
    v_mfma_f32_16x16x32_bf16 v[24:27], v[180:183], v[168:171], v[24:27]
    ds_read_b64_tr_b16 v[196:197], v20 offset:40960
    v_mfma_f32_16x16x32_bf16 v[40:43], v[180:183], v[172:175], v[40:43]
    ds_read_b64_tr_b16 v[198:199], v20 offset:43008
    v_mfma_f32_16x16x32_bf16 v[56:59], v[180:183], v[176:179], v[56:59]
    ds_read_b64_tr_b16 v[200:201], v21 offset:40960
    s_waitcnt lgkmcnt(7)
    v_mfma_f32_16x16x32_bf16 v[28:31], v[184:187], v[168:171], v[28:31]
    ds_read_b64_tr_b16 v[202:203], v21 offset:43008
    v_mfma_f32_16x16x32_bf16 v[44:47], v[184:187], v[172:175], v[44:47]
    ds_read_b32 v8, v253 offset:12
    v_mfma_f32_16x16x32_bf16 v[60:63], v[184:187], v[176:179], v[60:63]
    ds_read_b32 v9, v253 offset:64
    s_waitcnt lgkmcnt(8)
    v_mfma_f32_16x16x32_bf16 v[32:35], v[188:191], v[168:171], v[32:35]
    ds_read_b64_tr_b16 v[204:205], v22 offset:40960
    v_mfma_f32_16x16x32_bf16 v[48:51], v[188:191], v[172:175], v[48:51]
    ds_read_b64_tr_b16 v[206:207], v22 offset:43008
    v_mfma_f32_16x16x32_bf16 v[64:67], v[188:191], v[176:179], v[64:67]
    ds_read_b64_tr_b16 v[208:209], v23 offset:40960
    s_waitcnt lgkmcnt(9)
    v_mfma_f32_16x16x32_bf16 v[36:39], v[192:195], v[168:171], v[36:39]
    ds_read_b64_tr_b16 v[210:211], v23 offset:43008
    v_mfma_f32_16x16x32_bf16 v[52:55], v[192:195], v[172:175], v[52:55]
    v_mfma_f32_16x16x32_bf16 v[68:71], v[192:195], v[176:179], v[68:71]
    s_waitcnt lgkmcnt(4)
    v_readfirstlane_b32 s85, v9
    s_nop 0
    s_cmp_lt_u32 s85, 4
    s_cbranch_scc1 lws_18
lwd_19:
    s_waitcnt vmcnt(3)
    v_mfma_f32_16x16x32_bf16 v[24:27], v[196:199], v[120:123], v[24:27]
    ds_read_b64_tr_b16 v[188:189], v22 offset:49152
    v_mfma_f32_16x16x32_bf16 v[40:43], v[196:199], v[124:127], v[40:43]
    ds_read_b64_tr_b16 v[190:191], v22 offset:51200
    v_mfma_f32_16x16x32_bf16 v[56:59], v[196:199], v[128:131], v[56:59]
    ds_read_b64_tr_b16 v[192:193], v23 offset:49152
    v_mfma_f32_16x16x32_bf16 v[28:31], v[200:203], v[120:123], v[28:31]
    ds_read_b64_tr_b16 v[194:195], v23 offset:51200
    v_mfma_f32_16x16x32_bf16 v[44:47], v[200:203], v[124:127], v[44:47]
    ds_read_b64_tr_b16 v[180:181], v20 offset:49152
    v_mfma_f32_16x16x32_bf16 v[60:63], v[200:203], v[128:131], v[60:63]
    ds_read_b64_tr_b16 v[182:183], v20 offset:51200
    s_waitcnt lgkmcnt(8)
    v_mfma_f32_16x16x32_bf16 v[32:35], v[204:207], v[120:123], v[32:35]
    ds_read_b64_tr_b16 v[184:185], v21 offset:49152
    v_mfma_f32_16x16x32_bf16 v[48:51], v[204:207], v[124:127], v[48:51]
    ds_read_b64_tr_b16 v[186:187], v21 offset:51200
    v_mfma_f32_16x16x32_bf16 v[64:67], v[204:207], v[128:131], v[64:67]
    s_waitcnt lgkmcnt(8)
    v_mfma_f32_16x16x32_bf16 v[36:39], v[208:211], v[120:123], v[36:39]
    v_mfma_f32_16x16x32_bf16 v[52:55], v[208:211], v[124:127], v[52:55]
    v_mfma_f32_16x16x32_bf16 v[68:71], v[208:211], v[128:131], v[68:71]
    s_waitcnt vmcnt(0)
    s_waitcnt lgkmcnt(6)
    v_mfma_f32_16x16x32_bf16 v[32:35], v[188:191], v[132:135], v[32:35]
    ds_read_b64_tr_b16 v[196:197], v20 offset:57344
    v_mfma_f32_16x16x32_bf16 v[48:51], v[188:191], v[136:139], v[48:51]
    ds_read_b64_tr_b16 v[198:199], v20 offset:59392
    v_mfma_f32_16x16x32_bf16 v[64:67], v[188:191], v[140:143], v[64:67]
    ds_read_b64_tr_b16 v[200:201], v21 offset:57344
    s_waitcnt lgkmcnt(7)
    v_mfma_f32_16x16x32_bf16 v[36:39], v[192:195], v[132:135], v[36:39]
    ds_read_b64_tr_b16 v[202:203], v21 offset:59392
    v_mfma_f32_16x16x32_bf16 v[52:55], v[192:195], v[136:139], v[52:55]
    ds_read_b32 v8, v253 offset:12
    v_mfma_f32_16x16x32_bf16 v[68:71], v[192:195], v[140:143], v[68:71]
    ds_read_b64_tr_b16 v[204:205], v22 offset:57344
    s_waitcnt lgkmcnt(8)
    v_mfma_f32_16x16x32_bf16 v[24:27], v[180:183], v[132:135], v[24:27]
    ds_read_b64_tr_b16 v[206:207], v22 offset:59392
    ds_write_b128 v5, v[32:35] offset:0
    v_mfma_f32_16x16x32_bf16 v[40:43], v[180:183], v[136:139], v[40:43]
    ds_read_b64_tr_b16 v[208:209], v23 offset:57344
    ds_write_b128 v5, v[48:51] offset:2048
    v_mfma_f32_16x16x32_bf16 v[56:59], v[180:183], v[140:143], v[56:59]
    ds_read_b64_tr_b16 v[210:211], v23 offset:59392
    ds_write_b128 v5, v[64:67] offset:4096
    s_waitcnt lgkmcnt(12)
    v_mfma_f32_16x16x32_bf16 v[28:31], v[184:187], v[132:135], v[28:31]
    ds_write_b128 v5, v[36:39] offset:1024
    v_mfma_f32_16x16x32_bf16 v[44:47], v[184:187], v[136:139], v[44:47]
    ds_write_b128 v5, v[52:55] offset:3072
    v_mfma_f32_16x16x32_bf16 v[60:63], v[184:187], v[140:143], v[60:63]
    ds_write_b128 v5, v[68:71] offset:5120
    ds_read_b32 v8, v253 offset:12
    s_waitcnt lgkmcnt(0)
    v_readfirstlane_b32 s85, v8
    s_nop 0
    s_cmp_lt_u32 s85, 1
    s_cbranch_scc1 lws_21
lwd_22:
    buffer_load_dwordx4 v[144:147], v17, s[32:35], s76 offen offset:2048 sc1
    buffer_load_dwordx4 v[148:151], v18, s[32:35], s76 offen offset:2048 sc1
    buffer_load_dwordx4 v[152:155], v19, s[32:35], s76 offen offset:2048 sc1
    s_add_u32 s76, s76, 4096
    buffer_load_dwordx4 v[156:159], v17, s[32:35], s76 offen offset:0 sc1
    buffer_load_dwordx4 v[160:163], v18, s[32:35], s76 offen offset:0 sc1
    buffer_load_dwordx4 v[164:167], v19, s[32:35], s76 offen offset:0 sc1
    ds_read_b32 v8, v253 offset:12
    s_waitcnt lgkmcnt(0)
    v_readfirstlane_b32 s85, v8
    s_nop 0
    s_cmp_lt_u32 s85, 2
    s_cbranch_scc1 lws_24
lwd_25:
    buffer_load_dwordx4 v[168:171], v17, s[32:35], s76 offen offset:2048 sc1
    buffer_load_dwordx4 v[172:175], v18, s[32:35], s76 offen offset:2048 sc1
    buffer_load_dwordx4 v[176:179], v19, s[32:35], s76 offen offset:2048 sc1
    s_add_u32 s76, s76, 4096
    buffer_load_dwordx4 v[120:123], v17, s[32:35], s76 offen offset:0 sc1
    buffer_load_dwordx4 v[124:127], v18, s[32:35], s76 offen offset:0 sc1
    buffer_load_dwordx4 v[128:131], v19, s[32:35], s76 offen offset:0 sc1
    s_branch L_join
lws_27:
    s_mov_b32 s84, 1600000
lw_26:
    ds_read_b32 v8, v253 offset:12
    s_waitcnt lgkmcnt(0)
    v_readfirstlane_b32 s85, v8
    s_nop 0
    s_cmp_ge_u32 s85, 2
    s_cbranch_scc1 lwd_28
    s_sub_u32 s84, s84, 1
    s_cmp_lg_u32 s84, 0
    s_cbranch_scc1 lw_26
    s_branch lwd_28
lws_30:
    s_mov_b32 s84, 1600000
lw_29:
    ds_read_b32 v9, v253 offset:64
    s_waitcnt lgkmcnt(0)
    v_readfirstlane_b32 s85, v9
    s_nop 0
    s_cmp_ge_u32 s85, 4
    s_cbranch_scc1 lwd_31
    s_sub_u32 s84, s84, 1
    s_cmp_lg_u32 s84, 0
    s_cbranch_scc1 lw_29
    s_branch lwd_31
lws_33:
    s_mov_b32 s84, 1600000
lw_32:
    ds_read_b32 v8, v253 offset:12
    s_waitcnt lgkmcnt(0)
    v_readfirstlane_b32 s85, v8
    s_nop 0
    s_cmp_ge_u32 s85, 3
    s_cbranch_scc1 lwd_34
    s_sub_u32 s84, s84, 1
    s_cmp_lg_u32 s84, 0
    s_cbranch_scc1 lw_32
    s_branch lwd_34
lws_36:
    s_mov_b32 s84, 1600000
lw_35:
    ds_read_b32 v9, v11 offset:32
    s_waitcnt lgkmcnt(0)
    v_readfirstlane_b32 s85, v9
    s_nop 0
    s_cmp_ge_u32 s85, 1
    s_cbranch_scc1 lwd_37
    s_sub_u32 s84, s84, 1
    s_cmp_lg_u32 s84, 0
    s_cbranch_scc1 lw_35
    s_branch lwd_37
lws_39:
    s_mov_b32 s84, 1600000
lw_38:
    ds_read_b32 v8, v253 offset:12
    s_waitcnt lgkmcnt(0)
    v_readfirstlane_b32 s85, v8
    s_nop 0
    s_cmp_ge_u32 s85, 4
    s_cbranch_scc1 lwd_40
    s_sub_u32 s84, s84, 1
    s_cmp_lg_u32 s84, 0
    s_cbranch_scc1 lw_38
    s_branch lwd_40
lws_42:
    s_mov_b32 s84, 1600000
lw_41:
    ds_read_b32 v9, v253 offset:72
    s_waitcnt lgkmcnt(0)
    v_readfirstlane_b32 s85, v9
    s_nop 0
    s_cmp_ge_u32 s85, 4
    s_cbranch_scc1 lwd_43
    s_sub_u32 s84, s84, 1
    s_cmp_lg_u32 s84, 0
    s_cbranch_scc1 lw_41
    s_branch lwd_43
lws_45:
    s_mov_b32 s84, 1600000
lw_44:
    ds_read_b32 v8, v253 offset:12
    s_waitcnt lgkmcnt(0)
    v_readfirstlane_b32 s85, v8
    s_nop 0
    s_cmp_ge_u32 s85, 5
    s_cbranch_scc1 lwd_46
    s_sub_u32 s84, s84, 1
    s_cmp_lg_u32 s84, 0
    s_cbranch_scc1 lw_44
    s_branch lwd_46
L_cK:
    s_lshr_b32 s74, s56, 1
    s_and_b32 s75, s56, 1
    v_and_b32 v5, 15, v0
    v_lshrrev_b32 v6, 4, v0
    v_lshrrev_b32 v7, 1, v5
    v_xor_b32 v7, v7, v6
    v_lshlrev_b32 v7, 4, v7
    v_lshl_add_u32 v7, v5, 7, v7
    s_mul_i32 s72, s74, 10240
    v_add_u32 v1, s72, v7
    v_xor_b32 v2, 64, v1
    v_lshrrev_b32 v5, 2, v0
    v_and_b32 v5, 3, v5
    v_lshl_add_u32 v7, v6, 3, v5
    v_mul_u32_u24 v7, 320, v7
    v_and_b32 v5, 3, v0
    v_lshl_add_u32 v7, v5, 3, v7
    v_and_b32 v6, 1, v6
    s_mul_i32 s72, s75, 5
    s_add_u32 s72, s72, 0
    v_xor_b32 v5, s72, v6
    v_lshl_add_u32 v5, v5, 5, v7
    v_add_u32 v3, 20480, v5
    s_mul_i32 s72, s75, 5
    s_add_u32 s72, s72, 1
    v_xor_b32 v5, s72, v6
    v_lshl_add_u32 v5, v5, 5, v7
    v_add_u32 v4, 20480, v5
    v_lshrrev_b32 v20, 4, v0
    v_lshlrev_b32 v20, 2, v20
    v_and_b32 v21, 15, v0
    s_lshl1_add_u32 s72, s74, s75
    s_mul_i32 s72, s72, 3360
    s_add_u32 s72, s72, 147456
    v_mov_b32 v25, 163728
    v_add_u32 v22, 0, v20
    v_mul_u32_u24 v23, 52429, v22
    v_lshrrev_b32 v23, 20, v23
    v_mul_u32_u24 v8, 1600, v23
    v_lshl_add_u32 v8, v22, 2, v8
    v_add_u32 v22, -8, v21
    v_mul_u32_u24 v24, 20, v23
    v_sub_u32 v22, v22, v24
    v_lshl_add_u32 v24, v21, 1, v23
    v_cmp_gt_u32 vcc, 2, v24
    s_nop 1
    v_cndmask_b32 v22, v22, 20, vcc
    v_cmp_gt_u32 vcc, 21, v22
    v_mul_u32_u24 v22, 80, v22
    v_add_u32 v8, v8, v22
    v_add_u32 v8, s72, v8
    v_cndmask_b32 v8, v25, v8, vcc
    v_add_u32 v22, 0, v20
    v_mul_u32_u24 v23, 52429, v22
    v_lshrrev_b32 v23, 20, v23
    v_mul_u32_u24 v9, 1600, v23
    v_lshl_add_u32 v9, v22, 2, v9
    v_add_u32 v22, 8, v21
    v_mul_u32_u24 v24, 20, v23
    v_sub_u32 v22, v22, v24
    v_cmp_gt_u32 vcc, 20, v22
    v_mul_u32_u24 v22, 80, v22
    v_add_u32 v9, v9, v22
    v_add_u32 v9, s72, v9
    v_cndmask_b32 v9, v25, v9, vcc
    v_add_u32 v22, 16, v20
    v_mul_u32_u24 v23, 52429, v22
    v_lshrrev_b32 v23, 20, v23
    v_mul_u32_u24 v10, 1600, v23
    v_lshl_add_u32 v10, v22, 2, v10
    v_add_u32 v22, -8, v21
    v_mul_u32_u24 v24, 20, v23
    v_sub_u32 v22, v22, v24
    v_lshl_add_u32 v24, v21, 1, v23
    v_cmp_gt_u32 vcc, 2, v24
    s_nop 1
    v_cndmask_b32 v22, v22, 20, vcc
    v_cmp_gt_u32 vcc, 21, v22
    v_mul_u32_u24 v22, 80, v22
    v_add_u32 v10, v10, v22
    v_add_u32 v10, s72, v10
    v_cndmask_b32 v10, v25, v10, vcc
    v_add_u32 v22, 16, v20
    v_mul_u32_u24 v23, 52429, v22
    v_lshrrev_b32 v23, 20, v23
    v_mul_u32_u24 v11, 1600, v23
    v_lshl_add_u32 v11, v22, 2, v11
    v_add_u32 v22, 8, v21
    v_mul_u32_u24 v24, 20, v23
    v_sub_u32 v22, v22, v24
    v_cmp_gt_u32 vcc, 20, v22
    v_mul_u32_u24 v22, 80, v22
    v_add_u32 v11, v11, v22
    v_add_u32 v11, s72, v11
    v_cndmask_b32 v11, v25, v11, vcc
    v_add_u32 v22, 16, v20
    v_mul_u32_u24 v23, 52429, v22
    v_lshrrev_b32 v23, 20, v23
    v_mul_u32_u24 v12, 1600, v23
    v_lshl_add_u32 v12, v22, 2, v12
    v_add_u32 v22, 24, v21
    v_mul_u32_u24 v24, 20, v23
    v_sub_u32 v22, v22, v24
    v_cmp_gt_u32 vcc, 20, v22
    v_mul_u32_u24 v22, 80, v22
    v_add_u32 v12, v12, v22
    v_add_u32 v12, s72, v12
    v_cndmask_b32 v12, v25, v12, vcc
    v_add_u32 v22, 32, v20
    v_mul_u32_u24 v23, 52429, v22
    v_lshrrev_b32 v23, 20, v23
    v_mul_u32_u24 v13, 1600, v23
    v_lshl_add_u32 v13, v22, 2, v13
    v_add_u32 v22, -8, v21
    v_mul_u32_u24 v24, 20, v23
    v_sub_u32 v22, v22, v24
    v_lshl_add_u32 v24, v21, 1, v23
    v_cmp_gt_u32 vcc, 2, v24
    s_nop 1
    v_cndmask_b32 v22, v22, 20, vcc
    v_cmp_gt_u32 vcc, 21, v22
    v_mul_u32_u24 v22, 80, v22
    v_add_u32 v13, v13, v22
    v_add_u32 v13, s72, v13
    v_cndmask_b32 v13, v25, v13, vcc
    v_add_u32 v22, 32, v20
    v_mul_u32_u24 v23, 52429, v22
    v_lshrrev_b32 v23, 20, v23
    v_mul_u32_u24 v14, 1600, v23
    v_lshl_add_u32 v14, v22, 2, v14
    v_add_u32 v22, 8, v21
    v_mul_u32_u24 v24, 20, v23
    v_sub_u32 v22, v22, v24
    v_cmp_gt_u32 vcc, 20, v22
    v_mul_u32_u24 v22, 80, v22
    v_add_u32 v14, v14, v22
    v_add_u32 v14, s72, v14
    v_cndmask_b32 v14, v25, v14, vcc
    v_add_u32 v22, 32, v20
    v_mul_u32_u24 v23, 52429, v22
    v_lshrrev_b32 v23, 20, v23
    v_mul_u32_u24 v15, 1600, v23
    v_lshl_add_u32 v15, v22, 2, v15
    v_add_u32 v22, 24, v21
    v_mul_u32_u24 v24, 20, v23
    v_sub_u32 v22, v22, v24
    v_cmp_gt_u32 vcc, 20, v22
    v_mul_u32_u24 v22, 80, v22
    v_add_u32 v15, v15, v22
    v_add_u32 v15, s72, v15
    v_cndmask_b32 v15, v25, v15, vcc
    v_pk_mov_b32 v[20:21], 0, 0
    v_pk_mov_b32 v[22:23], 0, 0
    v_pk_mov_b32 v[24:25], 0, 0
    v_pk_mov_b32 v[26:27], 0, 0
    v_pk_mov_b32 v[28:29], 0, 0
    v_pk_mov_b32 v[30:31], 0, 0
    v_pk_mov_b32 v[32:33], 0, 0
    v_pk_mov_b32 v[34:35], 0, 0
    v_pk_mov_b32 v[36:37], 0, 0
    v_pk_mov_b32 v[38:39], 0, 0
    v_pk_mov_b32 v[40:41], 0, 0
    v_pk_mov_b32 v[42:43], 0, 0
    v_pk_mov_b32 v[44:45], 0, 0
    v_pk_mov_b32 v[46:47], 0, 0
    v_pk_mov_b32 v[48:49], 0, 0
    v_pk_mov_b32 v[50:51], 0, 0
    v_pk_mov_b32 v[52:53], 0, 0
    v_pk_mov_b32 v[54:55], 0, 0
    v_pk_mov_b32 v[56:57], 0, 0
    v_pk_mov_b32 v[58:59], 0, 0
    v_pk_mov_b32 v[60:61], 0, 0
    v_pk_mov_b32 v[62:63], 0, 0
    v_pk_mov_b32 v[64:65], 0, 0
    v_pk_mov_b32 v[66:67], 0, 0
    v_pk_mov_b32 v[68:69], 0, 0
    v_pk_mov_b32 v[70:71], 0, 0
    v_pk_mov_b32 v[72:73], 0, 0
    v_pk_mov_b32 v[74:75], 0, 0
    v_pk_mov_b32 v[76:77], 0, 0
    v_pk_mov_b32 v[78:79], 0, 0
    v_pk_mov_b32 v[80:81], 0, 0
    v_pk_mov_b32 v[82:83], 0, 0
    v_pk_mov_b32 v[84:85], 0, 0
    v_pk_mov_b32 v[86:87], 0, 0
    v_pk_mov_b32 v[88:89], 0, 0
    v_pk_mov_b32 v[90:91], 0, 0
    v_pk_mov_b32 v[92:93], 0, 0
    v_pk_mov_b32 v[94:95], 0, 0
    v_pk_mov_b32 v[96:97], 0, 0
    v_pk_mov_b32 v[98:99], 0, 0
    v_pk_mov_b32 v[100:101], 0, 0
    v_pk_mov_b32 v[102:103], 0, 0
    v_pk_mov_b32 v[104:105], 0, 0
    v_pk_mov_b32 v[106:107], 0, 0
    v_pk_mov_b32 v[108:109], 0, 0
    v_pk_mov_b32 v[110:111], 0, 0
    v_pk_mov_b32 v[112:113], 0, 0
    v_pk_mov_b32 v[114:115], 0, 0
    v_pk_mov_b32 v[116:117], 0, 0
    v_pk_mov_b32 v[118:119], 0, 0
    s_waitcnt vmcnt(5)
    v_lshlrev_b32 v216, 16, v204
    v_and_b32 v217, 0xffff0000, v204
    v_lshlrev_b32 v218, 16, v205
    v_and_b32 v219, 0xffff0000, v205
    v_lshlrev_b32 v220, 16, v206
    v_and_b32 v221, 0xffff0000, v206
    v_lshlrev_b32 v222, 16, v207
    v_and_b32 v223, 0xffff0000, v207
    v_lshlrev_b32 v224, 16, v208
    v_and_b32 v225, 0xffff0000, v208
    v_lshlrev_b32 v226, 16, v209
    v_and_b32 v227, 0xffff0000, v209
    v_lshlrev_b32 v228, 16, v210
    v_and_b32 v229, 0xffff0000, v210
    v_lshlrev_b32 v230, 16, v211
    v_and_b32 v231, 0xffff0000, v211
    v_lshlrev_b32 v232, 16, v212
    v_and_b32 v233, 0xffff0000, v212
    v_lshlrev_b32 v234, 16, v213
    v_and_b32 v235, 0xffff0000, v213
    v_lshlrev_b32 v236, 16, v214
    v_and_b32 v237, 0xffff0000, v214
    v_lshlrev_b32 v238, 16, v215
    v_and_b32 v239, 0xffff0000, v215
    v_pk_add_f32 v[240:241], v[216:217], v[218:219]
    v_pk_add_f32 v[240:241], v[240:241], v[220:221]
    v_pk_add_f32 v[240:241], v[240:241], v[222:223]
    v_pk_add_f32 v[240:241], v[240:241], v[224:225]
    v_pk_add_f32 v[240:241], v[240:241], v[226:227]
    v_pk_add_f32 v[240:241], v[240:241], v[228:229]
    v_pk_add_f32 v[240:241], v[240:241], v[230:231]
    v_pk_add_f32 v[240:241], v[240:241], v[232:233]
    v_pk_add_f32 v[240:241], v[240:241], v[234:235]
    v_pk_add_f32 v[240:241], v[240:241], v[236:237]
    v_pk_add_f32 v[240:241], v[240:241], v[238:239]
    v_add_f32 v240, v240, v241
    s_nop 1
    v_add_f32_dpp v240, v240, v240 row_ror:8 row_mask:0xf bank_mask:0xf
    s_nop 1
    v_add_f32_dpp v240, v240, v240 row_ror:4 row_mask:0xf bank_mask:0xf
    s_nop 1
    v_add_f32_dpp v240, v240, v240 row_ror:2 row_mask:0xf bank_mask:0xf
    s_nop 1
    v_add_f32_dpp v240, v240, v240 row_ror:1 row_mask:0xf bank_mask:0xf
    v_mov_b32 v242, v240
    s_nop 1
    v_permlane16_swap_b32 v240, v242
    v_add_f32 v240, v240, v242
    v_mul_f32 v240, 0xbacccccd, v240
    v_cndmask_b32 v241, 0, v240, s[80:81]
    v_pk_add_f32 v[216:217], v[216:217], v[240:241] op_sel_hi:[1,0]
    v_pk_add_f32 v[218:219], v[218:219], v[240:241] op_sel_hi:[1,0]
    v_pk_add_f32 v[220:221], v[220:221], v[240:241] op_sel_hi:[1,0]
    v_pk_add_f32 v[222:223], v[222:223], v[240:241] op_sel_hi:[1,0]
    v_pk_add_f32 v[224:225], v[224:225], v[240:241] op_sel_hi:[1,0]
    v_pk_add_f32 v[226:227], v[226:227], v[240:241] op_sel_hi:[1,0]
    v_pk_add_f32 v[228:229], v[228:229], v[240:241] op_sel_hi:[1,0]
    v_pk_add_f32 v[230:231], v[230:231], v[240:241] op_sel_hi:[1,0]
    v_pk_add_f32 v[232:233], v[232:233], v[240:241] op_sel:[0,1] op_sel_hi:[1,1]
    v_pk_add_f32 v[234:235], v[234:235], v[240:241] op_sel:[0,1] op_sel_hi:[1,1]
    v_pk_add_f32 v[236:237], v[236:237], v[240:241] op_sel:[0,1] op_sel_hi:[1,1]
    v_pk_add_f32 v[238:239], v[238:239], v[240:241] op_sel:[0,1] op_sel_hi:[1,1]
    v_pk_mul_f32 v[244:245], v[216:217], v[216:217]
    v_pk_fma_f32 v[244:245], v[218:219], v[218:219], v[244:245]
    v_pk_fma_f32 v[244:245], v[220:221], v[220:221], v[244:245]
    v_pk_fma_f32 v[244:245], v[222:223], v[222:223], v[244:245]
    v_pk_fma_f32 v[244:245], v[224:225], v[224:225], v[244:245]
    v_pk_fma_f32 v[244:245], v[226:227], v[226:227], v[244:245]
    v_pk_fma_f32 v[244:245], v[228:229], v[228:229], v[244:245]
    v_pk_fma_f32 v[244:245], v[230:231], v[230:231], v[244:245]
    v_pk_fma_f32 v[244:245], v[232:233], v[232:233], v[244:245]
    v_pk_fma_f32 v[244:245], v[234:235], v[234:235], v[244:245]
    v_pk_fma_f32 v[244:245], v[236:237], v[236:237], v[244:245]
    v_pk_fma_f32 v[244:245], v[238:239], v[238:239], v[244:245]
    v_add_f32 v244, v244, v245
    s_nop 1
    v_add_f32_dpp v244, v244, v244 row_ror:8 row_mask:0xf bank_mask:0xf
    s_nop 1
    v_add_f32_dpp v244, v244, v244 row_ror:4 row_mask:0xf bank_mask:0xf
    s_nop 1
    v_add_f32_dpp v244, v244, v244 row_ror:2 row_mask:0xf bank_mask:0xf
    s_nop 1
    v_add_f32_dpp v244, v244, v244 row_ror:1 row_mask:0xf bank_mask:0xf
    v_mov_b32 v242, v244
    s_nop 1
    v_permlane16_swap_b32 v244, v242
    v_add_f32 v244, v244, v242
    v_mul_f32 v244, 0x3acccccd, v244
    v_cvt_pk_bf16_f32 v242, v240, v240
    v_lshlrev_b32 v240, 16, v242
    v_cvt_pk_bf16_f32 v242, v244, v244
    v_lshlrev_b32 v244, 16, v242
    v_add_f32 v244, 0x3727c5ac, v244
    v_cvt_pk_bf16_f32 v242, v244, v244
    v_lshlrev_b32 v244, 16, v242
    v_sqrt_f32 v244, v244
    s_nop 0
    v_cvt_pk_bf16_f32 v242, v244, v244
    v_lshlrev_b32 v244, 16, v242
    v_rcp_f32 v244, v244
    v_lshrrev_b32 v242, 5, v0
    s_lshl_b32 s72, s56, 3
    s_add_u32 s72, s72, 160768
    v_lshl_add_u32 v242, v242, 2, s72
    ds_write_b32 v242, v240
    ds_write_b32 v242, v244 offset:32
    s_mov_b32 s76, 9
    s_mov_b32 s77, 0
    v_mov_b32 v251, 2130706432
    v_writelane_b32 v251, 0, 0
    v_mov_b32 v252, 1
    v_mov_b32 v253, 163744
    s_mul_i32 s72, s60, 96
    s_add_u32 s73, s72, 95
    s_min_u32 s73, s73, 2047
    s_min_u32 s72, s72, 2047
    s_mul_i32 s72, s72, 26215
    s_lshr_b32 s72, s72, 22
    s_mul_i32 s73, s73, 26215
    s_lshr_b32 s73, s73, 22
    v_mov_b32 v249, s72
    v_mov_b32 v250, s73
    v_cmp_gt_u32 vcc, 16, v0
    s_nop 1
    v_cndmask_b32 v250, v250, v249, vcc
    v_and_b32 v249, 15, v0
    v_min_u32 v249, 8, v249
    s_mov_b32 s72, 131072
    s_cmp_eq_u32 s56, 0
    s_cselect_b32 s72, s72, 2130706432
    s_cselect_b32 s3, 1, 0
    v_lshl_add_u32 v250, v250, 4, v249
    v_lshlrev_b32 v250, 9, v250
    v_add_u32 v250, s72, v250
    v_mov_b32 v249, 0
    v_lshrrev_b32 v5, 4, v0
    s_mul_i32 s72, s74, 320
    s_add_u32 s72, s72, 160896
    v_lshl_add_u32 v5, v5, 4, s72
    v_and_b32 v7, 15, v0
    s_mul_i32 s72, s75, 320
    s_add_u32 s72, s72, 162944
    v_lshl_add_u32 v6, v7, 2, s72
    v_cmp_gt_u32 s[80:81], 8, v7
    v_mov_b32 v242, 0x358637bd
    v_mov_b32 v243, 0x3fb8aa3b
    s_mul_i32 s72, s74, 80
    s_add_u32 s72, s72, s58
    s_cmp_lt_u32 s72, 2000
    s_cselect_b32 s79, -1, 0
    s_mov_b32 s71, 2130706432
    s_mul_i32 s72, s56, 1792
    v_lshl_add_u32 v244, v0, 2, s72
    v_add_u32 v245, 147456, v244
    v_mov_b32 v7, 2130706432
    v_cmp_gt_u32 vcc, 5440, v244
    s_nop 1
    v_cndmask_b32 v246, v7, v244, vcc
    v_cmp_gt_u32 vcc, 5184, v244
    s_nop 1
    v_cndmask_b32 v247, v7, v244, vcc
    s_mul_i32 s82, s59, 6720
    s_add_u32 s82, s82, 75776
    s_lshl3_add_u32 s72, s62, s59
    s_lshl_b32 s72, s72, 7
    s_add_u32 s83, s72, 262144
    s_waitcnt vmcnt(0)
    v_lshlrev_b32 v188, 16, v168
    v_and_b32 v189, 0xffff0000, v168
    v_lshlrev_b32 v190, 16, v169
    v_and_b32 v191, 0xffff0000, v169
    v_lshlrev_b32 v192, 16, v170
    v_and_b32 v193, 0xffff0000, v170
    v_lshlrev_b32 v194, 16, v171
    v_and_b32 v195, 0xffff0000, v171
    v_lshlrev_b32 v196, 16, v172
    v_and_b32 v197, 0xffff0000, v172
    v_pk_add_f32 v[188:189], v[188:189], v[196:197]
    v_lshlrev_b32 v196, 16, v173
    v_and_b32 v197, 0xffff0000, v173
    v_pk_add_f32 v[190:191], v[190:191], v[196:197]
    v_lshlrev_b32 v196, 16, v174
    v_and_b32 v197, 0xffff0000, v174
    v_pk_add_f32 v[192:193], v[192:193], v[196:197]
    v_lshlrev_b32 v196, 16, v175
    v_and_b32 v197, 0xffff0000, v175
    v_pk_add_f32 v[194:195], v[194:195], v[196:197]
    v_lshlrev_b32 v196, 16, v176
    v_and_b32 v197, 0xffff0000, v176
    v_pk_add_f32 v[188:189], v[188:189], v[196:197]
    v_lshlrev_b32 v196, 16, v177
    v_and_b32 v197, 0xffff0000, v177
    v_pk_add_f32 v[190:191], v[190:191], v[196:197]
    v_lshlrev_b32 v196, 16, v178
    v_and_b32 v197, 0xffff0000, v178
    v_pk_add_f32 v[192:193], v[192:193], v[196:197]
    v_lshlrev_b32 v196, 16, v179
    v_and_b32 v197, 0xffff0000, v179
    v_pk_add_f32 v[194:195], v[194:195], v[196:197]
    v_lshlrev_b32 v196, 16, v180
    v_and_b32 v197, 0xffff0000, v180
    v_pk_add_f32 v[188:189], v[188:189], v[196:197]
    v_lshlrev_b32 v196, 16, v181
    v_and_b32 v197, 0xffff0000, v181
    v_pk_add_f32 v[190:191], v[190:191], v[196:197]
    v_lshlrev_b32 v196, 16, v182
    v_and_b32 v197, 0xffff0000, v182
    v_pk_add_f32 v[192:193], v[192:193], v[196:197]
    v_lshlrev_b32 v196, 16, v183
    v_and_b32 v197, 0xffff0000, v183
    v_pk_add_f32 v[194:195], v[194:195], v[196:197]
    v_lshlrev_b32 v196, 16, v184
    v_and_b32 v197, 0xffff0000, v184
    v_pk_add_f32 v[188:189], v[188:189], v[196:197]
    v_lshlrev_b32 v196, 16, v185
    v_and_b32 v197, 0xffff0000, v185
    v_pk_add_f32 v[190:191], v[190:191], v[196:197]
    v_lshlrev_b32 v196, 16, v186
    v_and_b32 v197, 0xffff0000, v186
    v_pk_add_f32 v[192:193], v[192:193], v[196:197]
    v_lshlrev_b32 v196, 16, v187
    v_and_b32 v197, 0xffff0000, v187
    v_pk_add_f32 v[194:195], v[194:195], v[196:197]
    v_permlane32_swap_b32 v188, v192
    v_permlane32_swap_b32 v189, v193
    v_permlane32_swap_b32 v190, v194
    v_permlane32_swap_b32 v191, v195
    v_add_f32 v188, v188, v192
    v_add_f32 v189, v189, v193
    v_add_f32 v190, v190, v194
    v_add_f32 v191, v191, v195
    s_nop 0
    v_permlane16_swap_b32 v188, v190
    v_permlane16_swap_b32 v189, v191
    v_add_f32 v188, v188, v190
    v_add_f32 v189, v189, v191
    s_nop 0
    v_add_f32_dpp v188, v188, v188 row_ror:8 row_mask:0xf bank_mask:0xf
    v_add_f32_dpp v189, v189, v189 row_ror:8 row_mask:0xf bank_mask:0xf
    v_lshrrev_b32 v199, 4, v0
    v_lshlrev_b32 v199, 3, v199
    v_lshl_add_u32 v199, v198, 5, v199
    s_lshl_b32 s73, s56, 8
    s_add_u32 s73, s73, 159744
    v_add_u32 v199, s73, v199
    ds_write_b64 v199, v[188:189]
    s_branch L_pg_K
.p2align 12
L_pg_K:
    s_waitcnt lgkmcnt(0)
    s_barrier
    ds_read_b128 v[140:143], v1 offset:0
    ds_read_b128 v[144:147], v1 offset:2048
    ds_read_b128 v[148:151], v1 offset:4096
    ds_read_b128 v[152:155], v1 offset:6144
    ds_read_b128 v[156:159], v1 offset:8192
    ds_read_b64_tr_b16 v[120:121], v3 offset:0
    ds_read_b64_tr_b16 v[122:123], v3 offset:1280
    ds_read_b64_tr_b16 v[124:125], v4 offset:0
    ds_read_b64_tr_b16 v[126:127], v4 offset:1280
    ds_read_b64_tr_b16 v[128:129], v3 offset:64
    ds_read_b64_tr_b16 v[130:131], v3 offset:1344
    ds_read_b64_tr_b16 v[132:133], v4 offset:64
    ds_read_b64_tr_b16 v[134:135], v4 offset:1344
    ds_read_b64_tr_b16 v[136:137], v3 offset:128
    ds_read_b64_tr_b16 v[138:139], v3 offset:1408
    s_waitcnt lgkmcnt(0)
.p2align 6
L_main_K:
    s_waitcnt lgkmcnt(6)
    v_mfma_f32_16x16x32_bf16 v[20:23], v[140:143], v[120:123], v[20:23]
    ds_read_b128 v[160:163], v2 offset:0
    v_mfma_f32_16x16x32_bf16 v[40:43], v[144:147], v[120:123], v[40:43]
    ds_read_b128 v[164:167], v2 offset:2048
    v_mfma_f32_16x16x32_bf16 v[60:63], v[148:151], v[120:123], v[60:63]
    ds_read_b128 v[168:171], v2 offset:4096
    v_mfma_f32_16x16x32_bf16 v[80:83], v[152:155], v[120:123], v[80:83]
    ds_read_b128 v[172:175], v2 offset:6144
    v_mfma_f32_16x16x32_bf16 v[100:103], v[156:159], v[120:123], v[100:103]
    ds_read_b64_tr_b16 v[120:121], v3 offset:10240
    v_mfma_f32_16x16x32_bf16 v[24:27], v[140:143], v[124:127], v[24:27]
    ds_read_b64_tr_b16 v[122:123], v3 offset:11520
    v_mfma_f32_16x16x32_bf16 v[44:47], v[144:147], v[124:127], v[44:47]
    ds_read_b128 v[176:179], v2 offset:8192
    v_mfma_f32_16x16x32_bf16 v[64:67], v[148:151], v[124:127], v[64:67]
    s_add_u32 s77, s77, 1
    v_mfma_f32_16x16x32_bf16 v[84:87], v[152:155], v[124:127], v[84:87]
    s_cmp_eq_u32 s77, 3
    s_cselect_b32 s77, 0, s77
    v_mfma_f32_16x16x32_bf16 v[104:107], v[156:159], v[124:127], v[104:107]
    ds_read_b64_tr_b16 v[124:125], v4 offset:10240
    s_waitcnt lgkmcnt(6)
    v_mfma_f32_16x16x32_bf16 v[28:31], v[140:143], v[128:131], v[28:31]
    ds_read_b64_tr_b16 v[126:127], v4 offset:11520
    v_mfma_f32_16x16x32_bf16 v[48:51], v[144:147], v[128:131], v[48:51]
    s_mov_b32 s78, 40960
    s_cselect_b32 s78, -81920, s78
    v_mfma_f32_16x16x32_bf16 v[68:71], v[148:151], v[128:131], v[68:71]
    v_mfma_f32_16x16x32_bf16 v[88:91], v[152:155], v[128:131], v[88:91]
    v_mfma_f32_16x16x32_bf16 v[108:111], v[156:159], v[128:131], v[108:111]
    ds_read_b64_tr_b16 v[128:129], v3 offset:10304
    v_mfma_f32_16x16x32_bf16 v[32:35], v[140:143], v[132:135], v[32:35]
    ds_read_b64_tr_b16 v[130:131], v3 offset:11584
    v_mfma_f32_16x16x32_bf16 v[52:55], v[144:147], v[132:135], v[52:55]
    v_mfma_f32_16x16x32_bf16 v[72:75], v[148:151], v[132:135], v[72:75]
    v_mfma_f32_16x16x32_bf16 v[92:95], v[152:155], v[132:135], v[92:95]
    v_mfma_f32_16x16x32_bf16 v[112:115], v[156:159], v[132:135], v[112:115]
    ds_read_b64_tr_b16 v[132:133], v4 offset:10304
    v_mfma_f32_16x16x32_bf16 v[36:39], v[140:143], v[136:139], v[36:39]
    ds_read_b64_tr_b16 v[134:135], v4 offset:11584
    v_mfma_f32_16x16x32_bf16 v[56:59], v[144:147], v[136:139], v[56:59]
    v_mfma_f32_16x16x32_bf16 v[76:79], v[148:151], v[136:139], v[76:79]
    v_mfma_f32_16x16x32_bf16 v[96:99], v[152:155], v[136:139], v[96:99]
    v_mfma_f32_16x16x32_bf16 v[116:119], v[156:159], v[136:139], v[116:119]
    ds_read_b64_tr_b16 v[136:137], v3 offset:10368
    s_waitcnt lgkmcnt(3)
    v_mfma_f32_16x16x32_bf16 v[20:23], v[160:163], v[120:123], v[20:23]
    ds_read_b64_tr_b16 v[138:139], v3 offset:11648
    v_mfma_f32_16x16x32_bf16 v[40:43], v[164:167], v[120:123], v[40:43]
    v_add_u32 v1, s78, v1
    v_mfma_f32_16x16x32_bf16 v[60:63], v[168:171], v[120:123], v[60:63]
    v_add_u32 v2, s78, v2
    v_mfma_f32_16x16x32_bf16 v[80:83], v[172:175], v[120:123], v[80:83]
    v_add_u32 v3, s78, v3
    v_mfma_f32_16x16x32_bf16 v[100:103], v[176:179], v[120:123], v[100:103]
    v_add_u32 v4, s78, v4
    v_mfma_f32_16x16x32_bf16 v[24:27], v[160:163], v[124:127], v[24:27]
    v_mfma_f32_16x16x32_bf16 v[44:47], v[164:167], v[124:127], v[44:47]
    v_mfma_f32_16x16x32_bf16 v[64:67], v[168:171], v[124:127], v[64:67]
    s_waitcnt lgkmcnt(0)
    s_barrier
    v_mfma_f32_16x16x32_bf16 v[84:87], v[172:175], v[124:127], v[84:87]
    ds_read_b64_tr_b16 v[120:121], v3 offset:0
    v_mfma_f32_16x16x32_bf16 v[104:107], v[176:179], v[124:127], v[104:107]
    ds_read_b64_tr_b16 v[122:123], v3 offset:1280
    v_mfma_f32_16x16x32_bf16 v[28:31], v[160:163], v[128:131], v[28:31]
    ds_read_b128 v[140:143], v1 offset:0
    v_mfma_f32_16x16x32_bf16 v[48:51], v[164:167], v[128:131], v[48:51]
    ds_read_b128 v[144:147], v1 offset:2048
    v_mfma_f32_16x16x32_bf16 v[68:71], v[168:171], v[128:131], v[68:71]
    ds_read_b128 v[148:151], v1 offset:4096
    v_mfma_f32_16x16x32_bf16 v[88:91], v[172:175], v[128:131], v[88:91]
    ds_read_b128 v[152:155], v1 offset:6144
    v_mfma_f32_16x16x32_bf16 v[108:111], v[176:179], v[128:131], v[108:111]
    ds_read_b128 v[156:159], v1 offset:8192
    v_mfma_f32_16x16x32_bf16 v[32:35], v[160:163], v[132:135], v[32:35]
    ds_read_b64_tr_b16 v[124:125], v4 offset:0
    v_mfma_f32_16x16x32_bf16 v[52:55], v[164:167], v[132:135], v[52:55]
    ds_read_b64_tr_b16 v[126:127], v4 offset:1280
    v_mfma_f32_16x16x32_bf16 v[72:75], v[168:171], v[132:135], v[72:75]
    ds_read_b64_tr_b16 v[128:129], v3 offset:64
    v_mfma_f32_16x16x32_bf16 v[92:95], v[172:175], v[132:135], v[92:95]
    ds_read_b64_tr_b16 v[130:131], v3 offset:1344
    v_mfma_f32_16x16x32_bf16 v[112:115], v[176:179], v[132:135], v[112:115]
    ds_read_b64_tr_b16 v[132:133], v4 offset:64
    v_mfma_f32_16x16x32_bf16 v[36:39], v[160:163], v[136:139], v[36:39]
    ds_read_b64_tr_b16 v[134:135], v4 offset:1344
    v_mfma_f32_16x16x32_bf16 v[56:59], v[164:167], v[136:139], v[56:59]
    s_sub_u32 s76, s76, 1
    v_mfma_f32_16x16x32_bf16 v[76:79], v[168:171], v[136:139], v[76:79]
    v_mfma_f32_16x16x32_bf16 v[96:99], v[172:175], v[136:139], v[96:99]
    v_mfma_f32_16x16x32_bf16 v[116:119], v[176:179], v[136:139], v[116:119]
    ds_read_b64_tr_b16 v[136:137], v3 offset:128
    ds_read_b64_tr_b16 v[138:139], v3 offset:1408
    s_cmp_lg_u32 s76, 0
    s_cbranch_scc1 L_main_K
    s_waitcnt lgkmcnt(6)
    v_mfma_f32_16x16x32_bf16 v[20:23], v[140:143], v[120:123], v[20:23]
    ds_read_b128 v[160:163], v2 offset:0
    v_mfma_f32_16x16x32_bf16 v[40:43], v[144:147], v[120:123], v[40:43]
    ds_read_b128 v[164:167], v2 offset:2048
    v_mfma_f32_16x16x32_bf16 v[60:63], v[148:151], v[120:123], v[60:63]
    ds_read_b128 v[168:171], v2 offset:4096
    v_mfma_f32_16x16x32_bf16 v[80:83], v[152:155], v[120:123], v[80:83]
    ds_read_b128 v[172:175], v2 offset:6144
    v_mfma_f32_16x16x32_bf16 v[100:103], v[156:159], v[120:123], v[100:103]
    ds_read_b64_tr_b16 v[120:121], v3 offset:10240
    v_mfma_f32_16x16x32_bf16 v[24:27], v[140:143], v[124:127], v[24:27]
    ds_read_b64_tr_b16 v[122:123], v3 offset:11520
    v_mfma_f32_16x16x32_bf16 v[44:47], v[144:147], v[124:127], v[44:47]
    ds_read_b128 v[176:179], v2 offset:8192
    v_mfma_f32_16x16x32_bf16 v[64:67], v[148:151], v[124:127], v[64:67]
    ds_read_b32 v232, v6 offset:0
    v_mfma_f32_16x16x32_bf16 v[84:87], v[152:155], v[124:127], v[84:87]
    ds_read_b32 v234, v6 offset:64
    v_mfma_f32_16x16x32_bf16 v[104:107], v[156:159], v[124:127], v[104:107]
    ds_read_b64_tr_b16 v[124:125], v4 offset:10240
    s_waitcnt lgkmcnt(8)
    v_mfma_f32_16x16x32_bf16 v[28:31], v[140:143], v[128:131], v[28:31]
    ds_read_b64_tr_b16 v[126:127], v4 offset:11520
    v_mfma_f32_16x16x32_bf16 v[48:51], v[144:147], v[128:131], v[48:51]
    ds_read_b32 v236, v6 offset:128
    v_mfma_f32_16x16x32_bf16 v[68:71], v[148:151], v[128:131], v[68:71]
    ds_read_b32 v238, v6 offset:192
    v_mfma_f32_16x16x32_bf16 v[88:91], v[152:155], v[128:131], v[88:91]
    ds_read_b32 v240, v6 offset:256
    v_mfma_f32_16x16x32_bf16 v[108:111], v[156:159], v[128:131], v[108:111]
    ds_read_b64_tr_b16 v[128:129], v3 offset:10304
    v_mfma_f32_16x16x32_bf16 v[32:35], v[140:143], v[132:135], v[32:35]
    ds_read_b64_tr_b16 v[130:131], v3 offset:11584
    v_mfma_f32_16x16x32_bf16 v[52:55], v[144:147], v[132:135], v[52:55]
    ds_read_b128 v[180:183], v5 offset:0
    v_mfma_f32_16x16x32_bf16 v[72:75], v[148:151], v[132:135], v[72:75]
    ds_read_b128 v[200:203], v5 offset:1024
    v_mfma_f32_16x16x32_bf16 v[92:95], v[152:155], v[132:135], v[92:95]
    ds_read_b128 v[184:187], v5 offset:64
    v_mfma_f32_16x16x32_bf16 v[112:115], v[156:159], v[132:135], v[112:115]
    ds_read_b64_tr_b16 v[132:133], v4 offset:10304
    v_mfma_f32_16x16x32_bf16 v[36:39], v[140:143], v[136:139], v[36:39]
    ds_read_b64_tr_b16 v[134:135], v4 offset:11584
    v_mfma_f32_16x16x32_bf16 v[56:59], v[144:147], v[136:139], v[56:59]
    ds_read_b128 v[204:207], v5 offset:1088
    v_mfma_f32_16x16x32_bf16 v[76:79], v[148:151], v[136:139], v[76:79]
    ds_read_b128 v[188:191], v5 offset:128
    v_mfma_f32_16x16x32_bf16 v[96:99], v[152:155], v[136:139], v[96:99]
    ds_read_b128 v[208:211], v5 offset:1152
    v_mfma_f32_16x16x32_bf16 v[116:119], v[156:159], v[136:139], v[116:119]
    ds_read_b64_tr_b16 v[136:137], v3 offset:10368
    s_waitcnt lgkmcnt(8)
    v_mfma_f32_16x16x32_bf16 v[20:23], v[160:163], v[120:123], v[20:23]
    ds_read_b64_tr_b16 v[138:139], v3 offset:11648
    v_mfma_f32_16x16x32_bf16 v[40:43], v[164:167], v[120:123], v[40:43]
    ds_read_b128 v[192:195], v5 offset:192
    v_mfma_f32_16x16x32_bf16 v[60:63], v[168:171], v[120:123], v[60:63]
    ds_read_b128 v[212:215], v5 offset:1216
    v_mfma_f32_16x16x32_bf16 v[80:83], v[172:175], v[120:123], v[80:83]
    ds_read_b128 v[196:199], v5 offset:256
    v_mfma_f32_16x16x32_bf16 v[100:103], v[176:179], v[120:123], v[100:103]
    ds_read_b128 v[216:219], v5 offset:1280
    v_mfma_f32_16x16x32_bf16 v[24:27], v[160:163], v[124:127], v[24:27]
    v_mfma_f32_16x16x32_bf16 v[44:47], v[164:167], v[124:127], v[44:47]
    v_mfma_f32_16x16x32_bf16 v[64:67], v[168:171], v[124:127], v[64:67]
    s_waitcnt lgkmcnt(0)
    ds_add_u32 v253, v252 offset:0
    v_mfma_f32_16x16x32_bf16 v[84:87], v[172:175], v[124:127], v[84:87]
    v_mfma_f32_16x16x32_bf16 v[104:107], v[176:179], v[124:127], v[104:107]
    v_mfma_f32_16x16x32_bf16 v[28:31], v[160:163], v[128:131], v[28:31]
    v_mfma_f32_16x16x32_bf16 v[48:51], v[164:167], v[128:131], v[48:51]
    v_mfma_f32_16x16x32_bf16 v[68:71], v[168:171], v[128:131], v[68:71]
    v_mfma_f32_16x16x32_bf16 v[88:91], v[172:175], v[128:131], v[88:91]
    v_mfma_f32_16x16x32_bf16 v[108:111], v[176:179], v[128:131], v[108:111]
    v_mfma_f32_16x16x32_bf16 v[32:35], v[160:163], v[132:135], v[32:35]
    v_mfma_f32_16x16x32_bf16 v[52:55], v[164:167], v[132:135], v[52:55]
    v_mfma_f32_16x16x32_bf16 v[72:75], v[168:171], v[132:135], v[72:75]
    v_mfma_f32_16x16x32_bf16 v[92:95], v[172:175], v[132:135], v[92:95]
    v_mfma_f32_16x16x32_bf16 v[112:115], v[176:179], v[132:135], v[112:115]
    v_mfma_f32_16x16x32_bf16 v[36:39], v[160:163], v[136:139], v[36:39]
    v_mfma_f32_16x16x32_bf16 v[56:59], v[164:167], v[136:139], v[56:59]
    v_mfma_f32_16x16x32_bf16 v[76:79], v[168:171], v[136:139], v[76:79]
    v_mfma_f32_16x16x32_bf16 v[96:99], v[172:175], v[136:139], v[96:99]
    v_mfma_f32_16x16x32_bf16 v[116:119], v[176:179], v[136:139], v[116:119]
    s_waitcnt lgkmcnt(0)
    v_mov_b32 v7, 0x3f803f80
    v_pk_mul_f32 v[220:221], v[200:201], v[242:243] op_sel:[0,1] op_sel_hi:[1,1]
    v_pk_mul_f32 v[222:223], v[202:203], v[242:243] op_sel:[0,1] op_sel_hi:[1,1]
    v_pk_fma_f32 v[20:21], v[180:181], v[232:233], v[20:21] op_sel_hi:[1,0,1]
    v_pk_fma_f32 v[22:23], v[182:183], v[232:233], v[22:23] op_sel_hi:[1,0,1]
    v_pk_mul_f32 v[224:225], v[20:21], v[220:221]
    v_pk_mul_f32 v[226:227], v[22:23], v[222:223]
    v_pk_fma_f32 v[228:229], v[20:21], v[200:201], v[242:243] op_sel_hi:[1,1,0]
    v_pk_fma_f32 v[230:231], v[22:23], v[202:203], v[242:243] op_sel_hi:[1,1,0]
    v_exp_f32 v224, v224 clamp
    v_exp_f32 v225, v225 clamp
    v_exp_f32 v226, v226 clamp
    v_exp_f32 v227, v227 clamp
    v_max_f32 v228, v242, v228
    v_max_f32 v229, v242, v229
    v_max_f32 v230, v242, v230
    v_max_f32 v231, v242, v231
    v_pk_add_f32 v[224:225], v[224:225], v[228:229]
    v_pk_add_f32 v[226:227], v[226:227], v[230:231]
    v_cvt_pk_bf16_f32 v120, v224, v225
    v_cvt_pk_bf16_f32 v121, v226, v227
    v_pk_fma_f32 v[24:25], v[180:181], v[234:235], v[24:25] op_sel_hi:[1,0,1]
    v_pk_fma_f32 v[26:27], v[182:183], v[234:235], v[26:27] op_sel_hi:[1,0,1]
    v_pk_mul_f32 v[224:225], v[24:25], v[220:221]
    v_pk_mul_f32 v[226:227], v[26:27], v[222:223]
    v_pk_fma_f32 v[228:229], v[24:25], v[200:201], v[242:243] op_sel_hi:[1,1,0]
    v_pk_fma_f32 v[230:231], v[26:27], v[202:203], v[242:243] op_sel_hi:[1,1,0]
    v_exp_f32 v224, v224 clamp
    v_exp_f32 v225, v225 clamp
    v_exp_f32 v226, v226 clamp
    v_exp_f32 v227, v227 clamp
    v_max_f32 v228, v242, v228
    v_max_f32 v229, v242, v229
    v_max_f32 v230, v242, v230
    v_max_f32 v231, v242, v231
    v_pk_add_f32 v[224:225], v[224:225], v[228:229]
    v_pk_add_f32 v[226:227], v[226:227], v[230:231]
    v_cvt_pk_bf16_f32 v130, v224, v225
    v_cvt_pk_bf16_f32 v131, v226, v227
    v_pk_fma_f32 v[28:29], v[180:181], v[236:237], v[28:29] op_sel_hi:[1,0,1]
    v_pk_fma_f32 v[30:31], v[182:183], v[236:237], v[30:31] op_sel_hi:[1,0,1]
    v_pk_mul_f32 v[224:225], v[28:29], v[220:221]
    v_pk_mul_f32 v[226:227], v[30:31], v[222:223]
    v_pk_fma_f32 v[228:229], v[28:29], v[200:201], v[242:243] op_sel_hi:[1,1,0]
    v_pk_fma_f32 v[230:231], v[30:31], v[202:203], v[242:243] op_sel_hi:[1,1,0]
    v_exp_f32 v224, v224 clamp
    v_exp_f32 v225, v225 clamp
    v_exp_f32 v226, v226 clamp
    v_exp_f32 v227, v227 clamp
    v_max_f32 v228, v242, v228
    v_max_f32 v229, v242, v229
    v_max_f32 v230, v242, v230
    v_max_f32 v231, v242, v231
    v_pk_add_f32 v[224:225], v[224:225], v[228:229]
    v_pk_add_f32 v[226:227], v[226:227], v[230:231]
    v_cvt_pk_bf16_f32 v140, v224, v225
    v_cvt_pk_bf16_f32 v141, v226, v227
    v_pk_mul_f32 v[228:229], v[28:29], v[200:201]
    v_pk_mul_f32 v[230:231], v[30:31], v[202:203]
    v_cvt_pk_bf16_f32 v224, v228, v229
    v_cvt_pk_bf16_f32 v225, v230, v231
    v_cndmask_b32 v170, v224, v7, s[80:81]
    v_cndmask_b32 v171, v225, v7, s[80:81]
    v_pk_fma_f32 v[32:33], v[180:181], v[238:239], v[32:33] op_sel_hi:[1,0,1]
    v_pk_fma_f32 v[34:35], v[182:183], v[238:239], v[34:35] op_sel_hi:[1,0,1]
    v_pk_mul_f32 v[228:229], v[32:33], v[200:201]
    v_pk_mul_f32 v[230:231], v[34:35], v[202:203]
    v_cvt_pk_bf16_f32 v150, v228, v229
    v_cvt_pk_bf16_f32 v151, v230, v231
    v_pk_fma_f32 v[36:37], v[180:181], v[240:241], v[36:37] op_sel_hi:[1,0,1]
    v_pk_fma_f32 v[38:39], v[182:183], v[240:241], v[38:39] op_sel_hi:[1,0,1]
    v_pk_mul_f32 v[228:229], v[36:37], v[200:201]
    v_pk_mul_f32 v[230:231], v[38:39], v[202:203]
    v_cvt_pk_bf16_f32 v160, v228, v229
    v_cvt_pk_bf16_f32 v161, v230, v231
    v_pk_mul_f32 v[220:221], v[204:205], v[242:243] op_sel:[0,1] op_sel_hi:[1,1]
    v_pk_mul_f32 v[222:223], v[206:207], v[242:243] op_sel:[0,1] op_sel_hi:[1,1]
    v_pk_fma_f32 v[40:41], v[184:185], v[232:233], v[40:41] op_sel_hi:[1,0,1]
    v_pk_fma_f32 v[42:43], v[186:187], v[232:233], v[42:43] op_sel_hi:[1,0,1]
    v_pk_mul_f32 v[224:225], v[40:41], v[220:221]
    v_pk_mul_f32 v[226:227], v[42:43], v[222:223]
    v_pk_fma_f32 v[228:229], v[40:41], v[204:205], v[242:243] op_sel_hi:[1,1,0]
    v_pk_fma_f32 v[230:231], v[42:43], v[206:207], v[242:243] op_sel_hi:[1,1,0]
    v_exp_f32 v224, v224 clamp
    v_exp_f32 v225, v225 clamp
    v_exp_f32 v226, v226 clamp
    v_exp_f32 v227, v227 clamp
    v_max_f32 v228, v242, v228
    v_max_f32 v229, v242, v229
    v_max_f32 v230, v242, v230
    v_max_f32 v231, v242, v231
    v_pk_add_f32 v[224:225], v[224:225], v[228:229]
    v_pk_add_f32 v[226:227], v[226:227], v[230:231]
    v_cvt_pk_bf16_f32 v122, v224, v225
    v_cvt_pk_bf16_f32 v123, v226, v227
    v_pk_fma_f32 v[44:45], v[184:185], v[234:235], v[44:45] op_sel_hi:[1,0,1]
    v_pk_fma_f32 v[46:47], v[186:187], v[234:235], v[46:47] op_sel_hi:[1,0,1]
    v_pk_mul_f32 v[224:225], v[44:45], v[220:221]
    v_pk_mul_f32 v[226:227], v[46:47], v[222:223]
    v_pk_fma_f32 v[228:229], v[44:45], v[204:205], v[242:243] op_sel_hi:[1,1,0]
    v_pk_fma_f32 v[230:231], v[46:47], v[206:207], v[242:243] op_sel_hi:[1,1,0]
    v_exp_f32 v224, v224 clamp
    v_exp_f32 v225, v225 clamp
    v_exp_f32 v226, v226 clamp
    v_exp_f32 v227, v227 clamp
    v_max_f32 v228, v242, v228
    v_max_f32 v229, v242, v229
    v_max_f32 v230, v242, v230
    v_max_f32 v231, v242, v231
    v_pk_add_f32 v[224:225], v[224:225], v[228:229]
    v_pk_add_f32 v[226:227], v[226:227], v[230:231]
    v_cvt_pk_bf16_f32 v132, v224, v225
    v_cvt_pk_bf16_f32 v133, v226, v227
    v_pk_fma_f32 v[48:49], v[184:185], v[236:237], v[48:49] op_sel_hi:[1,0,1]
    v_pk_fma_f32 v[50:51], v[186:187], v[236:237], v[50:51] op_sel_hi:[1,0,1]
    v_pk_mul_f32 v[224:225], v[48:49], v[220:221]
    v_pk_mul_f32 v[226:227], v[50:51], v[222:223]
    v_pk_fma_f32 v[228:229], v[48:49], v[204:205], v[242:243] op_sel_hi:[1,1,0]
    v_pk_fma_f32 v[230:231], v[50:51], v[206:207], v[242:243] op_sel_hi:[1,1,0]
    v_exp_f32 v224, v224 clamp
    v_exp_f32 v225, v225 clamp
    v_exp_f32 v226, v226 clamp
    v_exp_f32 v227, v227 clamp
    v_max_f32 v228, v242, v228
    v_max_f32 v229, v242, v229
    v_max_f32 v230, v242, v230
    v_max_f32 v231, v242, v231
    v_pk_add_f32 v[224:225], v[224:225], v[228:229]
    v_pk_add_f32 v[226:227], v[226:227], v[230:231]
    v_cvt_pk_bf16_f32 v142, v224, v225
    v_cvt_pk_bf16_f32 v143, v226, v227
    v_pk_mul_f32 v[228:229], v[48:49], v[204:205]
    v_pk_mul_f32 v[230:231], v[50:51], v[206:207]
    v_cvt_pk_bf16_f32 v224, v228, v229
    v_cvt_pk_bf16_f32 v225, v230, v231
    v_cndmask_b32 v172, v224, v7, s[80:81]
    v_cndmask_b32 v173, v225, v7, s[80:81]
    v_pk_fma_f32 v[52:53], v[184:185], v[238:239], v[52:53] op_sel_hi:[1,0,1]
    v_pk_fma_f32 v[54:55], v[186:187], v[238:239], v[54:55] op_sel_hi:[1,0,1]
    v_pk_mul_f32 v[228:229], v[52:53], v[204:205]
    v_pk_mul_f32 v[230:231], v[54:55], v[206:207]
    v_cvt_pk_bf16_f32 v152, v228, v229
    v_cvt_pk_bf16_f32 v153, v230, v231
    v_pk_fma_f32 v[56:57], v[184:185], v[240:241], v[56:57] op_sel_hi:[1,0,1]
    v_pk_fma_f32 v[58:59], v[186:187], v[240:241], v[58:59] op_sel_hi:[1,0,1]
    v_pk_mul_f32 v[228:229], v[56:57], v[204:205]
    v_pk_mul_f32 v[230:231], v[58:59], v[206:207]
    v_cvt_pk_bf16_f32 v162, v228, v229
    v_cvt_pk_bf16_f32 v163, v230, v231
    v_pk_mul_f32 v[220:221], v[208:209], v[242:243] op_sel:[0,1] op_sel_hi:[1,1]
    v_pk_mul_f32 v[222:223], v[210:211], v[242:243] op_sel:[0,1] op_sel_hi:[1,1]
    v_pk_fma_f32 v[60:61], v[188:189], v[232:233], v[60:61] op_sel_hi:[1,0,1]
    v_pk_fma_f32 v[62:63], v[190:191], v[232:233], v[62:63] op_sel_hi:[1,0,1]
    v_pk_mul_f32 v[224:225], v[60:61], v[220:221]
    v_pk_mul_f32 v[226:227], v[62:63], v[222:223]
    v_pk_fma_f32 v[228:229], v[60:61], v[208:209], v[242:243] op_sel_hi:[1,1,0]
    v_pk_fma_f32 v[230:231], v[62:63], v[210:211], v[242:243] op_sel_hi:[1,1,0]
    v_mfma_f32_16x16x32_bf16 v[20:23], v[120:123], v[170:173], 0
    v_exp_f32 v224, v224 clamp
    v_mfma_f32_16x16x32_bf16 v[24:27], v[120:123], v[150:153], 0
    v_exp_f32 v225, v225 clamp
    v_mfma_f32_16x16x32_bf16 v[28:31], v[130:133], v[170:173], 0
    v_exp_f32 v226, v226 clamp
    v_exp_f32 v227, v227 clamp
    v_max_f32 v228, v242, v228
    v_max_f32 v229, v242, v229
    v_max_f32 v230, v242, v230
    v_max_f32 v231, v242, v231
    v_pk_add_f32 v[224:225], v[224:225], v[228:229]
    v_pk_add_f32 v[226:227], v[226:227], v[230:231]
    v_cvt_pk_bf16_f32 v124, v224, v225
    v_cvt_pk_bf16_f32 v125, v226, v227
    v_pk_fma_f32 v[64:65], v[188:189], v[234:235], v[64:65] op_sel_hi:[1,0,1]
    v_pk_fma_f32 v[66:67], v[190:191], v[234:235], v[66:67] op_sel_hi:[1,0,1]
    v_pk_mul_f32 v[224:225], v[64:65], v[220:221]
    v_pk_mul_f32 v[226:227], v[66:67], v[222:223]
    v_pk_fma_f32 v[228:229], v[64:65], v[208:209], v[242:243] op_sel_hi:[1,1,0]
    v_pk_fma_f32 v[230:231], v[66:67], v[210:211], v[242:243] op_sel_hi:[1,1,0]
    v_mfma_f32_16x16x32_bf16 v[32:35], v[130:133], v[150:153], 0
    v_exp_f32 v224, v224 clamp
    v_mfma_f32_16x16x32_bf16 v[36:39], v[130:133], v[160:163], 0
    v_exp_f32 v225, v225 clamp
    v_mfma_f32_16x16x32_bf16 v[40:43], v[140:143], v[170:173], 0
    v_exp_f32 v226, v226 clamp
    v_exp_f32 v227, v227 clamp
    v_max_f32 v228, v242, v228
    v_max_f32 v229, v242, v229
    v_max_f32 v230, v242, v230
    v_max_f32 v231, v242, v231
    v_pk_add_f32 v[224:225], v[224:225], v[228:229]
    v_pk_add_f32 v[226:227], v[226:227], v[230:231]
    v_cvt_pk_bf16_f32 v134, v224, v225
    v_cvt_pk_bf16_f32 v135, v226, v227
    v_pk_fma_f32 v[68:69], v[188:189], v[236:237], v[68:69] op_sel_hi:[1,0,1]
    v_pk_fma_f32 v[70:71], v[190:191], v[236:237], v[70:71] op_sel_hi:[1,0,1]
    v_pk_mul_f32 v[224:225], v[68:69], v[220:221]
    v_pk_mul_f32 v[226:227], v[70:71], v[222:223]
    v_pk_fma_f32 v[228:229], v[68:69], v[208:209], v[242:243] op_sel_hi:[1,1,0]
    v_pk_fma_f32 v[230:231], v[70:71], v[210:211], v[242:243] op_sel_hi:[1,1,0]
    v_mfma_f32_16x16x32_bf16 v[44:47], v[140:143], v[150:153], 0
    v_exp_f32 v224, v224 clamp
    v_mfma_f32_16x16x32_bf16 v[48:51], v[140:143], v[160:163], 0
    v_exp_f32 v225, v225 clamp
    v_exp_f32 v226, v226 clamp
    v_exp_f32 v227, v227 clamp
    v_max_f32 v228, v242, v228
    v_max_f32 v229, v242, v229
    v_max_f32 v230, v242, v230
    v_max_f32 v231, v242, v231
    v_pk_add_f32 v[224:225], v[224:225], v[228:229]
    v_pk_add_f32 v[226:227], v[226:227], v[230:231]
    v_cvt_pk_bf16_f32 v144, v224, v225
    v_cvt_pk_bf16_f32 v145, v226, v227
    v_pk_mul_f32 v[228:229], v[68:69], v[208:209]
    v_pk_mul_f32 v[230:231], v[70:71], v[210:211]
    v_cvt_pk_bf16_f32 v224, v228, v229
    v_cvt_pk_bf16_f32 v225, v230, v231
    v_cndmask_b32 v174, v224, v7, s[80:81]
    v_cndmask_b32 v175, v225, v7, s[80:81]
    v_pk_fma_f32 v[72:73], v[188:189], v[238:239], v[72:73] op_sel_hi:[1,0,1]
    v_pk_fma_f32 v[74:75], v[190:191], v[238:239], v[74:75] op_sel_hi:[1,0,1]
    v_pk_mul_f32 v[228:229], v[72:73], v[208:209]
    v_pk_mul_f32 v[230:231], v[74:75], v[210:211]
    v_cvt_pk_bf16_f32 v154, v228, v229
    v_cvt_pk_bf16_f32 v155, v230, v231
    v_pk_fma_f32 v[76:77], v[188:189], v[240:241], v[76:77] op_sel_hi:[1,0,1]
    v_pk_fma_f32 v[78:79], v[190:191], v[240:241], v[78:79] op_sel_hi:[1,0,1]
    v_pk_mul_f32 v[228:229], v[76:77], v[208:209]
    v_pk_mul_f32 v[230:231], v[78:79], v[210:211]
    v_cvt_pk_bf16_f32 v164, v228, v229
    v_cvt_pk_bf16_f32 v165, v230, v231
    v_pk_mul_f32 v[220:221], v[212:213], v[242:243] op_sel:[0,1] op_sel_hi:[1,1]
    v_pk_mul_f32 v[222:223], v[214:215], v[242:243] op_sel:[0,1] op_sel_hi:[1,1]
    v_pk_fma_f32 v[80:81], v[192:193], v[232:233], v[80:81] op_sel_hi:[1,0,1]
    v_pk_fma_f32 v[82:83], v[194:195], v[232:233], v[82:83] op_sel_hi:[1,0,1]
    v_pk_mul_f32 v[224:225], v[80:81], v[220:221]
    v_pk_mul_f32 v[226:227], v[82:83], v[222:223]
    v_pk_fma_f32 v[228:229], v[80:81], v[212:213], v[242:243] op_sel_hi:[1,1,0]
    v_pk_fma_f32 v[230:231], v[82:83], v[214:215], v[242:243] op_sel_hi:[1,1,0]
    v_exp_f32 v224, v224 clamp
    v_exp_f32 v225, v225 clamp
    v_exp_f32 v226, v226 clamp
    v_exp_f32 v227, v227 clamp
    v_max_f32 v228, v242, v228
    v_max_f32 v229, v242, v229
    v_max_f32 v230, v242, v230
    v_max_f32 v231, v242, v231
    v_pk_add_f32 v[224:225], v[224:225], v[228:229]
    v_pk_add_f32 v[226:227], v[226:227], v[230:231]
    v_cvt_pk_bf16_f32 v126, v224, v225
    v_cvt_pk_bf16_f32 v127, v226, v227
    v_and_b32 v126, s79, v126
    v_and_b32 v127, s79, v127
    v_pk_fma_f32 v[84:85], v[192:193], v[234:235], v[84:85] op_sel_hi:[1,0,1]
    v_pk_fma_f32 v[86:87], v[194:195], v[234:235], v[86:87] op_sel_hi:[1,0,1]
    v_pk_mul_f32 v[224:225], v[84:85], v[220:221]
    v_pk_mul_f32 v[226:227], v[86:87], v[222:223]
    v_pk_fma_f32 v[228:229], v[84:85], v[212:213], v[242:243] op_sel_hi:[1,1,0]
    v_pk_fma_f32 v[230:231], v[86:87], v[214:215], v[242:243] op_sel_hi:[1,1,0]
    v_exp_f32 v224, v224 clamp
    v_exp_f32 v225, v225 clamp
    v_exp_f32 v226, v226 clamp
    v_exp_f32 v227, v227 clamp
    v_max_f32 v228, v242, v228
    v_max_f32 v229, v242, v229
    v_max_f32 v230, v242, v230
    v_max_f32 v231, v242, v231
    v_pk_add_f32 v[224:225], v[224:225], v[228:229]
    v_pk_add_f32 v[226:227], v[226:227], v[230:231]
    v_cvt_pk_bf16_f32 v136, v224, v225
    v_cvt_pk_bf16_f32 v137, v226, v227
    v_and_b32 v136, s79, v136
    v_and_b32 v137, s79, v137
    v_pk_fma_f32 v[88:89], v[192:193], v[236:237], v[88:89] op_sel_hi:[1,0,1]
    v_pk_fma_f32 v[90:91], v[194:195], v[236:237], v[90:91] op_sel_hi:[1,0,1]
    v_pk_mul_f32 v[224:225], v[88:89], v[220:221]
    v_pk_mul_f32 v[226:227], v[90:91], v[222:223]
    v_pk_fma_f32 v[228:229], v[88:89], v[212:213], v[242:243] op_sel_hi:[1,1,0]
    v_pk_fma_f32 v[230:231], v[90:91], v[214:215], v[242:243] op_sel_hi:[1,1,0]
    v_exp_f32 v224, v224 clamp
    v_exp_f32 v225, v225 clamp
    v_exp_f32 v226, v226 clamp
    v_exp_f32 v227, v227 clamp
    v_max_f32 v228, v242, v228
    v_max_f32 v229, v242, v229
    v_max_f32 v230, v242, v230
    v_max_f32 v231, v242, v231
    v_pk_add_f32 v[224:225], v[224:225], v[228:229]
    v_pk_add_f32 v[226:227], v[226:227], v[230:231]
    v_cvt_pk_bf16_f32 v146, v224, v225
    v_cvt_pk_bf16_f32 v147, v226, v227
    v_and_b32 v146, s79, v146
    v_and_b32 v147, s79, v147
    v_pk_mul_f32 v[228:229], v[88:89], v[212:213]
    v_pk_mul_f32 v[230:231], v[90:91], v[214:215]
    v_cvt_pk_bf16_f32 v224, v228, v229
    v_cvt_pk_bf16_f32 v225, v230, v231
    v_cndmask_b32 v176, v224, v7, s[80:81]
    v_cndmask_b32 v177, v225, v7, s[80:81]
    v_pk_fma_f32 v[92:93], v[192:193], v[238:239], v[92:93] op_sel_hi:[1,0,1]
    v_pk_fma_f32 v[94:95], v[194:195], v[238:239], v[94:95] op_sel_hi:[1,0,1]
    v_pk_mul_f32 v[228:229], v[92:93], v[212:213]
    v_pk_mul_f32 v[230:231], v[94:95], v[214:215]
    v_cvt_pk_bf16_f32 v156, v228, v229
    v_cvt_pk_bf16_f32 v157, v230, v231
    v_pk_fma_f32 v[96:97], v[192:193], v[240:241], v[96:97] op_sel_hi:[1,0,1]
    v_pk_fma_f32 v[98:99], v[194:195], v[240:241], v[98:99] op_sel_hi:[1,0,1]
    v_pk_mul_f32 v[228:229], v[96:97], v[212:213]
    v_pk_mul_f32 v[230:231], v[98:99], v[214:215]
    v_cvt_pk_bf16_f32 v166, v228, v229
    v_cvt_pk_bf16_f32 v167, v230, v231
    v_pk_mul_f32 v[220:221], v[216:217], v[242:243] op_sel:[0,1] op_sel_hi:[1,1]
    v_pk_mul_f32 v[222:223], v[218:219], v[242:243] op_sel:[0,1] op_sel_hi:[1,1]
    v_pk_fma_f32 v[100:101], v[196:197], v[232:233], v[100:101] op_sel_hi:[1,0,1]
    v_pk_fma_f32 v[102:103], v[198:199], v[232:233], v[102:103] op_sel_hi:[1,0,1]
    v_pk_mul_f32 v[224:225], v[100:101], v[220:221]
    v_pk_mul_f32 v[226:227], v[102:103], v[222:223]
    v_pk_fma_f32 v[228:229], v[100:101], v[216:217], v[242:243] op_sel_hi:[1,1,0]
    v_pk_fma_f32 v[230:231], v[102:103], v[218:219], v[242:243] op_sel_hi:[1,1,0]
    v_mfma_f32_16x16x32_bf16 v[20:23], v[124:127], v[174:177], v[20:23]
    v_exp_f32 v224, v224 clamp
    v_mfma_f32_16x16x32_bf16 v[24:27], v[124:127], v[154:157], v[24:27]
    v_exp_f32 v225, v225 clamp
    v_mfma_f32_16x16x32_bf16 v[28:31], v[134:137], v[174:177], v[28:31]
    v_exp_f32 v226, v226 clamp
    v_exp_f32 v227, v227 clamp
    v_max_f32 v228, v242, v228
    v_max_f32 v229, v242, v229
    v_max_f32 v230, v242, v230
    v_max_f32 v231, v242, v231
    v_pk_add_f32 v[224:225], v[224:225], v[228:229]
    v_pk_add_f32 v[226:227], v[226:227], v[230:231]
    v_cvt_pk_bf16_f32 v128, v224, v225
    v_cvt_pk_bf16_f32 v129, v226, v227
    v_and_b32 v128, s79, v128
    v_and_b32 v129, s79, v129
    v_pk_fma_f32 v[104:105], v[196:197], v[234:235], v[104:105] op_sel_hi:[1,0,1]
    v_pk_fma_f32 v[106:107], v[198:199], v[234:235], v[106:107] op_sel_hi:[1,0,1]
    v_pk_mul_f32 v[224:225], v[104:105], v[220:221]
    v_pk_mul_f32 v[226:227], v[106:107], v[222:223]
    v_pk_fma_f32 v[228:229], v[104:105], v[216:217], v[242:243] op_sel_hi:[1,1,0]
    v_pk_fma_f32 v[230:231], v[106:107], v[218:219], v[242:243] op_sel_hi:[1,1,0]
    v_mfma_f32_16x16x32_bf16 v[32:35], v[134:137], v[154:157], v[32:35]
    v_exp_f32 v224, v224 clamp
    v_mfma_f32_16x16x32_bf16 v[36:39], v[134:137], v[164:167], v[36:39]
L_pad_5:
    s_cbranch_execz L_pad_1
    v_exp_f32 v225, v225 clamp
    v_mfma_f32_16x16x32_bf16 v[40:43], v[144:147], v[174:177], v[40:43]
    v_exp_f32 v226, v226 clamp
    v_exp_f32 v227, v227 clamp
    v_max_f32 v228, v242, v228
    v_max_f32 v229, v242, v229
    v_max_f32 v230, v242, v230
    v_max_f32 v231, v242, v231
    v_pk_add_f32 v[224:225], v[224:225], v[228:229]
    v_pk_add_f32 v[226:227], v[226:227], v[230:231]
    v_cvt_pk_bf16_f32 v138, v224, v225
    v_cvt_pk_bf16_f32 v139, v226, v227
    v_and_b32 v138, s79, v138
    v_and_b32 v139, s79, v139
    v_pk_fma_f32 v[108:109], v[196:197], v[236:237], v[108:109] op_sel_hi:[1,0,1]
    v_pk_fma_f32 v[110:111], v[198:199], v[236:237], v[110:111] op_sel_hi:[1,0,1]
    v_pk_mul_f32 v[224:225], v[108:109], v[220:221]
    v_pk_mul_f32 v[226:227], v[110:111], v[222:223]
    v_pk_fma_f32 v[228:229], v[108:109], v[216:217], v[242:243] op_sel_hi:[1,1,0]
    v_pk_fma_f32 v[230:231], v[110:111], v[218:219], v[242:243] op_sel_hi:[1,1,0]
    v_mfma_f32_16x16x32_bf16 v[44:47], v[144:147], v[154:157], v[44:47]
    v_exp_f32 v224, v224 clamp
    v_mfma_f32_16x16x32_bf16 v[48:51], v[144:147], v[164:167], v[48:51]
    v_exp_f32 v225, v225 clamp
    v_exp_f32 v226, v226 clamp
    v_exp_f32 v227, v227 clamp
    v_max_f32 v228, v242, v228
    v_max_f32 v229, v242, v229
    v_max_f32 v230, v242, v230
    v_max_f32 v231, v242, v231
    v_pk_add_f32 v[224:225], v[224:225], v[228:229]
    v_pk_add_f32 v[226:227], v[226:227], v[230:231]
    v_cvt_pk_bf16_f32 v148, v224, v225
    v_cvt_pk_bf16_f32 v149, v226, v227
    v_and_b32 v148, s79, v148
    v_and_b32 v149, s79, v149
    v_pk_mul_f32 v[228:229], v[108:109], v[216:217]
    v_pk_mul_f32 v[230:231], v[110:111], v[218:219]
    v_cvt_pk_bf16_f32 v224, v228, v229
    v_cvt_pk_bf16_f32 v225, v230, v231
    v_cndmask_b32 v178, v224, v7, s[80:81]
    v_cndmask_b32 v179, v225, v7, s[80:81]
    v_pk_fma_f32 v[112:113], v[196:197], v[238:239], v[112:113] op_sel_hi:[1,0,1]
    v_pk_fma_f32 v[114:115], v[198:199], v[238:239], v[114:115] op_sel_hi:[1,0,1]
    v_pk_mul_f32 v[228:229], v[112:113], v[216:217]
    v_pk_mul_f32 v[230:231], v[114:115], v[218:219]
    v_cvt_pk_bf16_f32 v158, v228, v229
    v_cvt_pk_bf16_f32 v159, v230, v231
    v_pk_fma_f32 v[116:117], v[196:197], v[240:241], v[116:117] op_sel_hi:[1,0,1]
    v_pk_fma_f32 v[118:119], v[198:199], v[240:241], v[118:119] op_sel_hi:[1,0,1]
    v_pk_mul_f32 v[228:229], v[116:117], v[216:217]
    v_pk_mul_f32 v[230:231], v[118:119], v[218:219]
    v_cvt_pk_bf16_f32 v168, v228, v229
    v_cvt_pk_bf16_f32 v169, v230, v231
    v_mfma_f32_16x16x16_bf16 v[20:23], v[128:129], v[178:179], v[20:23]
    v_mfma_f32_16x16x16_bf16 v[24:27], v[128:129], v[158:159], v[24:27]
    v_mfma_f32_16x16x16_bf16 v[28:31], v[138:139], v[178:179], v[28:31]
    v_mfma_f32_16x16x16_bf16 v[32:35], v[138:139], v[158:159], v[32:35]
    v_mfma_f32_16x16x16_bf16 v[36:39], v[138:139], v[168:169], v[36:39]
    v_mfma_f32_16x16x16_bf16 v[40:43], v[148:149], v[178:179], v[40:43]
    v_mfma_f32_16x16x16_bf16 v[44:47], v[148:149], v[158:159], v[44:47]
    v_mfma_f32_16x16x16_bf16 v[48:51], v[148:149], v[168:169], v[48:51]
    s_nop 0
    ds_write_b128 v8, v[20:23]
    ds_write_b128 v9, v[24:27]
    ds_write_b128 v10, v[28:31]
    ds_write_b128 v11, v[32:35]
    ds_write_b128 v12, v[36:39]
    ds_write_b128 v13, v[40:43]
    ds_write_b128 v14, v[44:47]
    ds_write_b128 v15, v[48:51]
    s_waitcnt lgkmcnt(0)
    s_mov_b64 exec, 1
    ds_add_u32 v253, v252 offset:4
    s_mov_b64 exec, -1
    ds_read_b32 v1, v253 offset:4
    s_waitcnt lgkmcnt(0)
    v_readfirstlane_b32 s85, v1
    s_nop 0
    s_cmp_lt_u32 s85, 4
    s_cbranch_scc1 lws_48
lwd_49:
    ds_read_b32 v64, v245 offset:0
    ds_read_b32 v65, v245 offset:6720
    ds_read_b32 v66, v245 offset:256
    ds_read_b32 v67, v245 offset:6976
    ds_read_b32 v68, v245 offset:512
    ds_read_b32 v69, v245 offset:7232
    ds_read_b32 v70, v245 offset:768
    ds_read_b32 v71, v245 offset:7488
    ds_read_b32 v72, v245 offset:1024
    ds_read_b32 v73, v245 offset:7744
    ds_read_b32 v74, v245 offset:1280
    ds_read_b32 v75, v245 offset:8000
    ds_read_b32 v76, v245 offset:1536
    ds_read_b32 v77, v245 offset:8256
    s_waitcnt lgkmcnt(12)
    v_add_f32 v64, v64, v65
    buffer_atomic_add_f32 v64, v244, s[36:39], s82 offen offset:0
    s_waitcnt lgkmcnt(10)
    v_add_f32 v66, v66, v67
    buffer_atomic_add_f32 v66, v244, s[36:39], s82 offen offset:256
    s_waitcnt lgkmcnt(8)
    v_add_f32 v68, v68, v69
    buffer_atomic_add_f32 v68, v244, s[36:39], s82 offen offset:512
    s_waitcnt lgkmcnt(6)
    v_add_f32 v70, v70, v71
    buffer_atomic_add_f32 v70, v244, s[36:39], s82 offen offset:768
    s_waitcnt lgkmcnt(4)
    v_add_f32 v72, v72, v73
    buffer_atomic_add_f32 v72, v244, s[36:39], s82 offen offset:1024
    s_waitcnt lgkmcnt(2)
    v_add_f32 v74, v74, v75
    buffer_atomic_add_f32 v74, v246, s[36:39], s82 offen offset:1280
    s_waitcnt lgkmcnt(0)
    v_add_f32 v76, v76, v77
    buffer_atomic_add_f32 v76, v247, s[36:39], s82 offen offset:1536
    s_waitcnt vmcnt(0)
    s_mov_b64 exec, 1
    ds_add_rtn_u32 v254, v253, v252 offset:24
    s_mov_b64 exec, -1
    s_waitcnt lgkmcnt(0)
    v_readfirstlane_b32 s85, v254
    s_nop 0
    s_cmp_eq_u32 s85, 3
    s_cselect_b32 s85, s83, 2130706432
    s_nop 1
    buffer_store_dword v252, v251, s[36:39], s85 offen offset:0 sc1
    s_cmp_lg_u32 s63, 0
    s_cbranch_scc1 L_c2
    s_endpgm
lws_48:
    s_mov_b32 s84, 1600000
lw_47:
    ds_read_b32 v1, v253 offset:4
    s_waitcnt lgkmcnt(0)
    v_readfirstlane_b32 s85, v1
    s_nop 0
    s_cmp_ge_u32 s85, 4
    s_cbranch_scc1 lwd_49
    s_sub_u32 s84, s84, 1
    s_cmp_lg_u32 s84, 0
    s_cbranch_scc1 lw_47
    s_branch lwd_49
L_cQ:
    s_mov_b32 s74, s56
    s_mov_b32 s75, 0
    v_and_b32 v5, 15, v0
    v_lshrrev_b32 v6, 4, v0
    v_lshrrev_b32 v7, 1, v5
    v_xor_b32 v7, v7, v6
    v_lshlrev_b32 v7, 4, v7
    v_lshl_add_u32 v7, v5, 7, v7
    s_mul_i32 s72, s74, 8192
    v_add_u32 v1, s72, v7
    v_xor_b32 v2, 64, v1
    v_lshrrev_b32 v5, 2, v0
    v_and_b32 v5, 3, v5
    v_lshl_add_u32 v7, v6, 3, v5
    v_mul_u32_u24 v7, 320, v7
    v_and_b32 v5, 3, v0
    v_lshl_add_u32 v7, v5, 3, v7
    v_and_b32 v6, 1, v6
    s_mul_i32 s72, s75, 5
    s_add_u32 s72, s72, 0
    v_xor_b32 v5, s72, v6
    v_lshl_add_u32 v5, v5, 5, v7
    v_add_u32 v3, 32768, v5
    s_mul_i32 s72, s75, 5
    s_add_u32 s72, s72, 1
    v_xor_b32 v5, s72, v6
    v_lshl_add_u32 v5, v5, 5, v7
    v_add_u32 v4, 32768, v5
    v_pk_mov_b32 v[8:9], 0, 0
    v_pk_mov_b32 v[10:11], 0, 0
    v_pk_mov_b32 v[12:13], 0, 0
    v_pk_mov_b32 v[14:15], 0, 0
    v_pk_mov_b32 v[16:17], 0, 0
    v_pk_mov_b32 v[18:19], 0, 0
    v_pk_mov_b32 v[20:21], 0, 0
    v_pk_mov_b32 v[22:23], 0, 0
    v_pk_mov_b32 v[24:25], 0, 0
    v_pk_mov_b32 v[26:27], 0, 0
    v_pk_mov_b32 v[28:29], 0, 0
    v_pk_mov_b32 v[30:31], 0, 0
    v_pk_mov_b32 v[32:33], 0, 0
    v_pk_mov_b32 v[34:35], 0, 0
    v_pk_mov_b32 v[36:37], 0, 0
    v_pk_mov_b32 v[38:39], 0, 0
    v_pk_mov_b32 v[40:41], 0, 0
    v_pk_mov_b32 v[42:43], 0, 0
    v_pk_mov_b32 v[44:45], 0, 0
    v_pk_mov_b32 v[46:47], 0, 0
    v_pk_mov_b32 v[48:49], 0, 0
    v_pk_mov_b32 v[50:51], 0, 0
    v_pk_mov_b32 v[52:53], 0, 0
    v_pk_mov_b32 v[54:55], 0, 0
    v_pk_mov_b32 v[56:57], 0, 0
    v_pk_mov_b32 v[58:59], 0, 0
    v_pk_mov_b32 v[60:61], 0, 0
    v_pk_mov_b32 v[62:63], 0, 0
    v_pk_mov_b32 v[64:65], 0, 0
    v_pk_mov_b32 v[66:67], 0, 0
    v_pk_mov_b32 v[68:69], 0, 0
    v_pk_mov_b32 v[70:71], 0, 0
    v_pk_mov_b32 v[72:73], 0, 0
    v_pk_mov_b32 v[74:75], 0, 0
    v_pk_mov_b32 v[76:77], 0, 0
    v_pk_mov_b32 v[78:79], 0, 0
    v_pk_mov_b32 v[80:81], 0, 0
    v_pk_mov_b32 v[82:83], 0, 0
    v_pk_mov_b32 v[84:85], 0, 0
    v_pk_mov_b32 v[86:87], 0, 0
    v_pk_mov_b32 v[88:89], 0, 0
    v_pk_mov_b32 v[90:91], 0, 0
    v_pk_mov_b32 v[92:93], 0, 0
    v_pk_mov_b32 v[94:95], 0, 0
    v_pk_mov_b32 v[96:97], 0, 0
    v_pk_mov_b32 v[98:99], 0, 0
    v_pk_mov_b32 v[100:101], 0, 0
    v_pk_mov_b32 v[102:103], 0, 0
    v_pk_mov_b32 v[104:105], 0, 0
    v_pk_mov_b32 v[106:107], 0, 0
    v_pk_mov_b32 v[108:109], 0, 0
    v_pk_mov_b32 v[110:111], 0, 0
    v_pk_mov_b32 v[112:113], 0, 0
    v_pk_mov_b32 v[114:115], 0, 0
    v_pk_mov_b32 v[116:117], 0, 0
    v_pk_mov_b32 v[118:119], 0, 0
    v_pk_mov_b32 v[120:121], 0, 0
    v_pk_mov_b32 v[122:123], 0, 0
    v_pk_mov_b32 v[124:125], 0, 0
    v_pk_mov_b32 v[126:127], 0, 0
    v_pk_mov_b32 v[128:129], 0, 0
    v_pk_mov_b32 v[130:131], 0, 0
    v_pk_mov_b32 v[132:133], 0, 0
    v_pk_mov_b32 v[134:135], 0, 0
    v_pk_mov_b32 v[136:137], 0, 0
    v_pk_mov_b32 v[138:139], 0, 0
    v_pk_mov_b32 v[140:141], 0, 0
    v_pk_mov_b32 v[142:143], 0, 0
    v_pk_mov_b32 v[144:145], 0, 0
    v_pk_mov_b32 v[146:147], 0, 0
    v_pk_mov_b32 v[148:149], 0, 0
    v_pk_mov_b32 v[150:151], 0, 0
    v_pk_mov_b32 v[152:153], 0, 0
    v_pk_mov_b32 v[154:155], 0, 0
    v_pk_mov_b32 v[156:157], 0, 0
    v_pk_mov_b32 v[158:159], 0, 0
    v_pk_mov_b32 v[160:161], 0, 0
    v_pk_mov_b32 v[162:163], 0, 0
    v_pk_mov_b32 v[164:165], 0, 0
    v_pk_mov_b32 v[166:167], 0, 0
    s_waitcnt vmcnt(5)
    v_lshlrev_b32 v216, 16, v204
    v_and_b32 v217, 0xffff0000, v204
    v_lshlrev_b32 v218, 16, v205
    v_and_b32 v219, 0xffff0000, v205
    v_lshlrev_b32 v220, 16, v206
    v_and_b32 v221, 0xffff0000, v206
    v_lshlrev_b32 v222, 16, v207
    v_and_b32 v223, 0xffff0000, v207
    v_lshlrev_b32 v224, 16, v208
    v_and_b32 v225, 0xffff0000, v208
    v_lshlrev_b32 v226, 16, v209
    v_and_b32 v227, 0xffff0000, v209
    v_lshlrev_b32 v228, 16, v210
    v_and_b32 v229, 0xffff0000, v210
    v_lshlrev_b32 v230, 16, v211
    v_and_b32 v231, 0xffff0000, v211
    v_lshlrev_b32 v232, 16, v212
    v_and_b32 v233, 0xffff0000, v212
    v_lshlrev_b32 v234, 16, v213
    v_and_b32 v235, 0xffff0000, v213
    v_lshlrev_b32 v236, 16, v214
    v_and_b32 v237, 0xffff0000, v214
    v_lshlrev_b32 v238, 16, v215
    v_and_b32 v239, 0xffff0000, v215
    v_pk_add_f32 v[240:241], v[216:217], v[218:219]
    v_pk_add_f32 v[240:241], v[240:241], v[220:221]
    v_pk_add_f32 v[240:241], v[240:241], v[222:223]
    v_pk_add_f32 v[240:241], v[240:241], v[224:225]
    v_pk_add_f32 v[240:241], v[240:241], v[226:227]
    v_pk_add_f32 v[240:241], v[240:241], v[228:229]
    v_pk_add_f32 v[240:241], v[240:241], v[230:231]
    v_pk_add_f32 v[240:241], v[240:241], v[232:233]
    v_pk_add_f32 v[240:241], v[240:241], v[234:235]
    v_pk_add_f32 v[240:241], v[240:241], v[236:237]
    v_pk_add_f32 v[240:241], v[240:241], v[238:239]
    v_add_f32 v240, v240, v241
    s_nop 1
    v_add_f32_dpp v240, v240, v240 row_ror:8 row_mask:0xf bank_mask:0xf
    s_nop 1
    v_add_f32_dpp v240, v240, v240 row_ror:4 row_mask:0xf bank_mask:0xf
    s_nop 1
    v_add_f32_dpp v240, v240, v240 row_ror:2 row_mask:0xf bank_mask:0xf
    s_nop 1
    v_add_f32_dpp v240, v240, v240 row_ror:1 row_mask:0xf bank_mask:0xf
    v_mov_b32 v242, v240
    s_nop 1
    v_permlane16_swap_b32 v240, v242
    v_add_f32 v240, v240, v242
    v_mul_f32 v240, 0xbacccccd, v240
    v_cndmask_b32 v241, 0, v240, s[80:81]
    v_pk_add_f32 v[216:217], v[216:217], v[240:241] op_sel_hi:[1,0]
    v_pk_add_f32 v[218:219], v[218:219], v[240:241] op_sel_hi:[1,0]
    v_pk_add_f32 v[220:221], v[220:221], v[240:241] op_sel_hi:[1,0]
    v_pk_add_f32 v[222:223], v[222:223], v[240:241] op_sel_hi:[1,0]
    v_pk_add_f32 v[224:225], v[224:225], v[240:241] op_sel_hi:[1,0]
    v_pk_add_f32 v[226:227], v[226:227], v[240:241] op_sel_hi:[1,0]
    v_pk_add_f32 v[228:229], v[228:229], v[240:241] op_sel_hi:[1,0]
    v_pk_add_f32 v[230:231], v[230:231], v[240:241] op_sel_hi:[1,0]
    v_pk_add_f32 v[232:233], v[232:233], v[240:241] op_sel:[0,1] op_sel_hi:[1,1]
    v_pk_add_f32 v[234:235], v[234:235], v[240:241] op_sel:[0,1] op_sel_hi:[1,1]
    v_pk_add_f32 v[236:237], v[236:237], v[240:241] op_sel:[0,1] op_sel_hi:[1,1]
    v_pk_add_f32 v[238:239], v[238:239], v[240:241] op_sel:[0,1] op_sel_hi:[1,1]
    v_pk_mul_f32 v[244:245], v[216:217], v[216:217]
    v_pk_fma_f32 v[244:245], v[218:219], v[218:219], v[244:245]
    v_pk_fma_f32 v[244:245], v[220:221], v[220:221], v[244:245]
    v_pk_fma_f32 v[244:245], v[222:223], v[222:223], v[244:245]
    v_pk_fma_f32 v[244:245], v[224:225], v[224:225], v[244:245]
    v_pk_fma_f32 v[244:245], v[226:227], v[226:227], v[244:245]
    v_pk_fma_f32 v[244:245], v[228:229], v[228:229], v[244:245]
    v_pk_fma_f32 v[244:245], v[230:231], v[230:231], v[244:245]
    v_pk_fma_f32 v[244:245], v[232:233], v[232:233], v[244:245]
    v_pk_fma_f32 v[244:245], v[234:235], v[234:235], v[244:245]
    v_pk_fma_f32 v[244:245], v[236:237], v[236:237], v[244:245]
    v_pk_fma_f32 v[244:245], v[238:239], v[238:239], v[244:245]
    v_add_f32 v244, v244, v245
    s_nop 1
    v_add_f32_dpp v244, v244, v244 row_ror:8 row_mask:0xf bank_mask:0xf
    s_nop 1
    v_add_f32_dpp v244, v244, v244 row_ror:4 row_mask:0xf bank_mask:0xf
    s_nop 1
    v_add_f32_dpp v244, v244, v244 row_ror:2 row_mask:0xf bank_mask:0xf
    s_nop 1
    v_add_f32_dpp v244, v244, v244 row_ror:1 row_mask:0xf bank_mask:0xf
    v_mov_b32 v242, v244
    s_nop 1
    v_permlane16_swap_b32 v244, v242
    v_add_f32 v244, v244, v242
    v_mul_f32 v244, 0x3acccccd, v244
    v_cvt_pk_bf16_f32 v242, v240, v240
    v_lshlrev_b32 v240, 16, v242
    v_cvt_pk_bf16_f32 v242, v244, v244
    v_lshlrev_b32 v244, 16, v242
    v_add_f32 v244, 0x3727c5ac, v244
    v_cvt_pk_bf16_f32 v242, v244, v244
    v_lshlrev_b32 v244, 16, v242
    v_sqrt_f32 v244, v244
    s_nop 0
    v_cvt_pk_bf16_f32 v242, v244, v244
    v_lshlrev_b32 v244, 16, v242
    v_rcp_f32 v244, v244
    v_lshrrev_b32 v242, 5, v0
    s_lshl_b32 s72, s56, 3
    s_add_u32 s72, s72, 160768
    v_lshl_add_u32 v242, v242, 2, s72
    ds_write_b32 v242, v240
    ds_write_b32 v242, v244 offset:32
    s_mov_b32 s76, 9
    s_mov_b32 s77, 0
    v_mov_b32 v251, 2130706432
    v_writelane_b32 v251, 0, 0
    v_mov_b32 v252, 1
    v_mov_b32 v253, 163744
    v_and_b32 v5, 15, v0
    s_mul_i32 s72, s74, 256
    s_add_u32 s72, s72, 160896
    v_lshl_add_u32 v5, v5, 2, s72
    v_lshrrev_b32 v6, 4, v0
    s_mul_i32 s72, s75, 640
    s_add_u32 s72, s72, 162944
    v_lshl_add_u32 v6, v6, 4, s72
    v_mov_b32 v248, 0x358637bd
    v_mov_b32 v249, 0x3fb8aa3b
    s_waitcnt vmcnt(0)
    v_lshlrev_b32 v188, 16, v168
    v_and_b32 v189, 0xffff0000, v168
    v_lshlrev_b32 v190, 16, v169
    v_and_b32 v191, 0xffff0000, v169
    v_lshlrev_b32 v192, 16, v170
    v_and_b32 v193, 0xffff0000, v170
    v_lshlrev_b32 v194, 16, v171
    v_and_b32 v195, 0xffff0000, v171
    v_lshlrev_b32 v196, 16, v172
    v_and_b32 v197, 0xffff0000, v172
    v_pk_add_f32 v[188:189], v[188:189], v[196:197]
    v_lshlrev_b32 v196, 16, v173
    v_and_b32 v197, 0xffff0000, v173
    v_pk_add_f32 v[190:191], v[190:191], v[196:197]
    v_lshlrev_b32 v196, 16, v174
    v_and_b32 v197, 0xffff0000, v174
    v_pk_add_f32 v[192:193], v[192:193], v[196:197]
    v_lshlrev_b32 v196, 16, v175
    v_and_b32 v197, 0xffff0000, v175
    v_pk_add_f32 v[194:195], v[194:195], v[196:197]
    v_lshlrev_b32 v196, 16, v176
    v_and_b32 v197, 0xffff0000, v176
    v_pk_add_f32 v[188:189], v[188:189], v[196:197]
    v_lshlrev_b32 v196, 16, v177
    v_and_b32 v197, 0xffff0000, v177
    v_pk_add_f32 v[190:191], v[190:191], v[196:197]
    v_lshlrev_b32 v196, 16, v178
    v_and_b32 v197, 0xffff0000, v178
    v_pk_add_f32 v[192:193], v[192:193], v[196:197]
    v_lshlrev_b32 v196, 16, v179
    v_and_b32 v197, 0xffff0000, v179
    v_pk_add_f32 v[194:195], v[194:195], v[196:197]
    v_lshlrev_b32 v196, 16, v180
    v_and_b32 v197, 0xffff0000, v180
    v_pk_add_f32 v[188:189], v[188:189], v[196:197]
    v_lshlrev_b32 v196, 16, v181
    v_and_b32 v197, 0xffff0000, v181
    v_pk_add_f32 v[190:191], v[190:191], v[196:197]
    v_lshlrev_b32 v196, 16, v182
    v_and_b32 v197, 0xffff0000, v182
    v_pk_add_f32 v[192:193], v[192:193], v[196:197]
    v_lshlrev_b32 v196, 16, v183
    v_and_b32 v197, 0xffff0000, v183
    v_pk_add_f32 v[194:195], v[194:195], v[196:197]
    v_lshlrev_b32 v196, 16, v184
    v_and_b32 v197, 0xffff0000, v184
    v_pk_add_f32 v[188:189], v[188:189], v[196:197]
    v_lshlrev_b32 v196, 16, v185
    v_and_b32 v197, 0xffff0000, v185
    v_pk_add_f32 v[190:191], v[190:191], v[196:197]
    v_lshlrev_b32 v196, 16, v186
    v_and_b32 v197, 0xffff0000, v186
    v_pk_add_f32 v[192:193], v[192:193], v[196:197]
    v_lshlrev_b32 v196, 16, v187
    v_and_b32 v197, 0xffff0000, v187
    v_pk_add_f32 v[194:195], v[194:195], v[196:197]
    v_permlane32_swap_b32 v188, v192
    v_permlane32_swap_b32 v189, v193
    v_permlane32_swap_b32 v190, v194
    v_permlane32_swap_b32 v191, v195
    v_add_f32 v188, v188, v192
    v_add_f32 v189, v189, v193
    v_add_f32 v190, v190, v194
    v_add_f32 v191, v191, v195
    s_nop 0
    v_permlane16_swap_b32 v188, v190
    v_permlane16_swap_b32 v189, v191
    v_add_f32 v188, v188, v190
    v_add_f32 v189, v189, v191
    s_nop 0
    v_add_f32_dpp v188, v188, v188 row_ror:8 row_mask:0xf bank_mask:0xf
    v_add_f32_dpp v189, v189, v189 row_ror:8 row_mask:0xf bank_mask:0xf
    v_lshrrev_b32 v199, 4, v0
    v_lshlrev_b32 v199, 3, v199
    v_lshl_add_u32 v199, v198, 5, v199
    s_lshl_b32 s73, s56, 8
    s_add_u32 s73, s73, 159744
    v_add_u32 v199, s73, v199
    ds_write_b64 v199, v[188:189]
    s_branch L_pg_Q
.p2align 12
L_pg_Q:
    s_waitcnt lgkmcnt(0)
    s_barrier
    ds_read_b128 v[208:211], v1 offset:0
    ds_read_b128 v[212:215], v1 offset:2048
    ds_read_b128 v[216:219], v1 offset:4096
    ds_read_b128 v[220:223], v1 offset:6144
    ds_read_b64_tr_b16 v[168:169], v3 offset:0
    ds_read_b64_tr_b16 v[170:171], v3 offset:1280
    ds_read_b64_tr_b16 v[172:173], v4 offset:0
    ds_read_b64_tr_b16 v[174:175], v4 offset:1280
    ds_read_b64_tr_b16 v[176:177], v3 offset:64
    ds_read_b64_tr_b16 v[178:179], v3 offset:1344
    ds_read_b64_tr_b16 v[180:181], v4 offset:64
    ds_read_b64_tr_b16 v[182:183], v4 offset:1344
    ds_read_b64_tr_b16 v[184:185], v3 offset:128
    ds_read_b64_tr_b16 v[186:187], v3 offset:1408
    ds_read_b64_tr_b16 v[188:189], v4 offset:128
    ds_read_b64_tr_b16 v[190:191], v4 offset:1408
    ds_read_b64_tr_b16 v[192:193], v3 offset:192
    ds_read_b64_tr_b16 v[194:195], v3 offset:1472
    ds_read_b64_tr_b16 v[196:197], v4 offset:192
    ds_read_b64_tr_b16 v[198:199], v4 offset:1472
    ds_read_b64_tr_b16 v[200:201], v3 offset:256
    ds_read_b64_tr_b16 v[202:203], v3 offset:1536
    ds_read_b64_tr_b16 v[204:205], v4 offset:256
    ds_read_b64_tr_b16 v[206:207], v4 offset:1536
    s_waitcnt lgkmcnt(0)
.p2align 6
L_main_Q:
    s_waitcnt lgkmcnt(5)
    v_mfma_f32_16x16x32_bf16 v[8:11], v[168:171], v[208:211], v[8:11]
    ds_read_b128 v[224:227], v2 offset:0
    v_mfma_f32_16x16x32_bf16 v[48:51], v[168:171], v[212:215], v[48:51]
    ds_read_b128 v[228:231], v2 offset:2048
    v_mfma_f32_16x16x32_bf16 v[88:91], v[168:171], v[216:219], v[88:91]
    ds_read_b128 v[232:235], v2 offset:4096
    v_mfma_f32_16x16x32_bf16 v[128:131], v[168:171], v[220:223], v[128:131]
    ds_read_b64_tr_b16 v[168:169], v3 offset:10240
    v_mfma_f32_16x16x32_bf16 v[12:15], v[172:175], v[208:211], v[12:15]
    ds_read_b64_tr_b16 v[170:171], v3 offset:11520
    v_mfma_f32_16x16x32_bf16 v[52:55], v[172:175], v[212:215], v[52:55]
    ds_read_b128 v[236:239], v2 offset:6144
    v_mfma_f32_16x16x32_bf16 v[92:95], v[172:175], v[216:219], v[92:95]
    s_add_u32 s77, s77, 1
    v_mfma_f32_16x16x32_bf16 v[132:135], v[172:175], v[220:223], v[132:135]
    ds_read_b64_tr_b16 v[172:173], v4 offset:10240
    v_mfma_f32_16x16x32_bf16 v[16:19], v[176:179], v[208:211], v[16:19]
    ds_read_b64_tr_b16 v[174:175], v4 offset:11520
    v_mfma_f32_16x16x32_bf16 v[56:59], v[176:179], v[212:215], v[56:59]
    s_cmp_eq_u32 s77, 3
    s_cselect_b32 s77, 0, s77
    v_mfma_f32_16x16x32_bf16 v[96:99], v[176:179], v[216:219], v[96:99]
    s_mov_b32 s78, 53248
    s_cselect_b32 s78, -106496, s78
    v_mfma_f32_16x16x32_bf16 v[136:139], v[176:179], v[220:223], v[136:139]
    ds_read_b64_tr_b16 v[176:177], v3 offset:10304
    v_mfma_f32_16x16x32_bf16 v[20:23], v[180:183], v[208:211], v[20:23]
    ds_read_b64_tr_b16 v[178:179], v3 offset:11584
    v_mfma_f32_16x16x32_bf16 v[60:63], v[180:183], v[212:215], v[60:63]
    v_mfma_f32_16x16x32_bf16 v[100:103], v[180:183], v[216:219], v[100:103]
    v_mfma_f32_16x16x32_bf16 v[140:143], v[180:183], v[220:223], v[140:143]
    ds_read_b64_tr_b16 v[180:181], v4 offset:10304
    v_mfma_f32_16x16x32_bf16 v[24:27], v[184:187], v[208:211], v[24:27]
    ds_read_b64_tr_b16 v[182:183], v4 offset:11584
    v_mfma_f32_16x16x32_bf16 v[64:67], v[184:187], v[212:215], v[64:67]
    v_mfma_f32_16x16x32_bf16 v[104:107], v[184:187], v[216:219], v[104:107]
    v_mfma_f32_16x16x32_bf16 v[144:147], v[184:187], v[220:223], v[144:147]
    ds_read_b64_tr_b16 v[184:185], v3 offset:10368
    v_mfma_f32_16x16x32_bf16 v[28:31], v[188:191], v[208:211], v[28:31]
    ds_read_b64_tr_b16 v[186:187], v3 offset:11648
    v_mfma_f32_16x16x32_bf16 v[68:71], v[188:191], v[212:215], v[68:71]
    v_mfma_f32_16x16x32_bf16 v[108:111], v[188:191], v[216:219], v[108:111]
    v_mfma_f32_16x16x32_bf16 v[148:151], v[188:191], v[220:223], v[148:151]
    ds_read_b64_tr_b16 v[188:189], v4 offset:10368
    v_mfma_f32_16x16x32_bf16 v[32:35], v[192:195], v[208:211], v[32:35]
    ds_read_b64_tr_b16 v[190:191], v4 offset:11648
    v_mfma_f32_16x16x32_bf16 v[72:75], v[192:195], v[212:215], v[72:75]
    v_mfma_f32_16x16x32_bf16 v[112:115], v[192:195], v[216:219], v[112:115]
    v_mfma_f32_16x16x32_bf16 v[152:155], v[192:195], v[220:223], v[152:155]
    ds_read_b64_tr_b16 v[192:193], v3 offset:10432
    s_waitcnt lgkmcnt(4)
    v_mfma_f32_16x16x32_bf16 v[36:39], v[196:199], v[208:211], v[36:39]
    ds_read_b64_tr_b16 v[194:195], v3 offset:11712
    v_mfma_f32_16x16x32_bf16 v[76:79], v[196:199], v[212:215], v[76:79]
    v_mfma_f32_16x16x32_bf16 v[116:119], v[196:199], v[216:219], v[116:119]
    v_mfma_f32_16x16x32_bf16 v[156:159], v[196:199], v[220:223], v[156:159]
    ds_read_b64_tr_b16 v[196:197], v4 offset:10432
    v_mfma_f32_16x16x32_bf16 v[40:43], v[200:203], v[208:211], v[40:43]
    ds_read_b64_tr_b16 v[198:199], v4 offset:11712
    v_mfma_f32_16x16x32_bf16 v[80:83], v[200:203], v[212:215], v[80:83]
    v_mfma_f32_16x16x32_bf16 v[120:123], v[200:203], v[216:219], v[120:123]
    v_mfma_f32_16x16x32_bf16 v[160:163], v[200:203], v[220:223], v[160:163]
    ds_read_b64_tr_b16 v[200:201], v3 offset:10496
    v_mfma_f32_16x16x32_bf16 v[44:47], v[204:207], v[208:211], v[44:47]
    ds_read_b64_tr_b16 v[202:203], v3 offset:11776
    v_mfma_f32_16x16x32_bf16 v[84:87], v[204:207], v[212:215], v[84:87]
    v_mfma_f32_16x16x32_bf16 v[124:127], v[204:207], v[216:219], v[124:127]
    v_mfma_f32_16x16x32_bf16 v[164:167], v[204:207], v[220:223], v[164:167]
    ds_read_b64_tr_b16 v[204:205], v4 offset:10496
    v_mfma_f32_16x16x32_bf16 v[8:11], v[168:171], v[224:227], v[8:11]
    ds_read_b64_tr_b16 v[206:207], v4 offset:11776
    v_mfma_f32_16x16x32_bf16 v[48:51], v[168:171], v[228:231], v[48:51]
    v_add_u32 v1, s78, v1
    v_mfma_f32_16x16x32_bf16 v[88:91], v[168:171], v[232:235], v[88:91]
    v_add_u32 v2, s78, v2
    v_mfma_f32_16x16x32_bf16 v[128:131], v[168:171], v[236:239], v[128:131]
    v_add_u32 v3, s78, v3
    v_mfma_f32_16x16x32_bf16 v[12:15], v[172:175], v[224:227], v[12:15]
    v_add_u32 v4, s78, v4
    v_mfma_f32_16x16x32_bf16 v[52:55], v[172:175], v[228:231], v[52:55]
    v_mfma_f32_16x16x32_bf16 v[92:95], v[172:175], v[232:235], v[92:95]
    v_mfma_f32_16x16x32_bf16 v[132:135], v[172:175], v[236:239], v[132:135]
    s_waitcnt lgkmcnt(0)
    s_barrier
    v_mfma_f32_16x16x32_bf16 v[16:19], v[176:179], v[224:227], v[16:19]
    ds_read_b64_tr_b16 v[168:169], v3 offset:0
    v_mfma_f32_16x16x32_bf16 v[56:59], v[176:179], v[228:231], v[56:59]
    ds_read_b64_tr_b16 v[170:171], v3 offset:1280
    v_mfma_f32_16x16x32_bf16 v[96:99], v[176:179], v[232:235], v[96:99]
    ds_read_b128 v[208:211], v1 offset:0
    v_mfma_f32_16x16x32_bf16 v[136:139], v[176:179], v[236:239], v[136:139]
    ds_read_b128 v[212:215], v1 offset:2048
    v_mfma_f32_16x16x32_bf16 v[20:23], v[180:183], v[224:227], v[20:23]
    ds_read_b128 v[216:219], v1 offset:4096
    v_mfma_f32_16x16x32_bf16 v[60:63], v[180:183], v[228:231], v[60:63]
    ds_read_b128 v[220:223], v1 offset:6144
    v_mfma_f32_16x16x32_bf16 v[100:103], v[180:183], v[232:235], v[100:103]
    ds_read_b64_tr_b16 v[172:173], v4 offset:0
    v_mfma_f32_16x16x32_bf16 v[140:143], v[180:183], v[236:239], v[140:143]
    ds_read_b64_tr_b16 v[174:175], v4 offset:1280
    v_mfma_f32_16x16x32_bf16 v[24:27], v[184:187], v[224:227], v[24:27]
    ds_read_b64_tr_b16 v[176:177], v3 offset:64
    v_mfma_f32_16x16x32_bf16 v[64:67], v[184:187], v[228:231], v[64:67]
    ds_read_b64_tr_b16 v[178:179], v3 offset:1344
    v_mfma_f32_16x16x32_bf16 v[104:107], v[184:187], v[232:235], v[104:107]
    ds_read_b64_tr_b16 v[180:181], v4 offset:64
    v_mfma_f32_16x16x32_bf16 v[144:147], v[184:187], v[236:239], v[144:147]
    ds_read_b64_tr_b16 v[182:183], v4 offset:1344
    v_mfma_f32_16x16x32_bf16 v[28:31], v[188:191], v[224:227], v[28:31]
    ds_read_b64_tr_b16 v[184:185], v3 offset:128
    v_mfma_f32_16x16x32_bf16 v[68:71], v[188:191], v[228:231], v[68:71]
    ds_read_b64_tr_b16 v[186:187], v3 offset:1408
    v_mfma_f32_16x16x32_bf16 v[108:111], v[188:191], v[232:235], v[108:111]
    s_sub_u32 s76, s76, 1
    v_mfma_f32_16x16x32_bf16 v[148:151], v[188:191], v[236:239], v[148:151]
    ds_read_b64_tr_b16 v[188:189], v4 offset:128
    v_mfma_f32_16x16x32_bf16 v[32:35], v[192:195], v[224:227], v[32:35]
    ds_read_b64_tr_b16 v[190:191], v4 offset:1408
    v_mfma_f32_16x16x32_bf16 v[72:75], v[192:195], v[228:231], v[72:75]
    v_mfma_f32_16x16x32_bf16 v[112:115], v[192:195], v[232:235], v[112:115]
    v_mfma_f32_16x16x32_bf16 v[152:155], v[192:195], v[236:239], v[152:155]
    ds_read_b64_tr_b16 v[192:193], v3 offset:192
    v_mfma_f32_16x16x32_bf16 v[36:39], v[196:199], v[224:227], v[36:39]
    ds_read_b64_tr_b16 v[194:195], v3 offset:1472
    v_mfma_f32_16x16x32_bf16 v[76:79], v[196:199], v[228:231], v[76:79]
    v_mfma_f32_16x16x32_bf16 v[116:119], v[196:199], v[232:235], v[116:119]
    v_mfma_f32_16x16x32_bf16 v[156:159], v[196:199], v[236:239], v[156:159]
    ds_read_b64_tr_b16 v[196:197], v4 offset:192
    v_mfma_f32_16x16x32_bf16 v[40:43], v[200:203], v[224:227], v[40:43]
    ds_read_b64_tr_b16 v[198:199], v4 offset:1472
    v_mfma_f32_16x16x32_bf16 v[80:83], v[200:203], v[228:231], v[80:83]
    v_mfma_f32_16x16x32_bf16 v[120:123], v[200:203], v[232:235], v[120:123]
    v_mfma_f32_16x16x32_bf16 v[160:163], v[200:203], v[236:239], v[160:163]
    ds_read_b64_tr_b16 v[200:201], v3 offset:256
    v_mfma_f32_16x16x32_bf16 v[44:47], v[204:207], v[224:227], v[44:47]
    ds_read_b64_tr_b16 v[202:203], v3 offset:1536
    v_mfma_f32_16x16x32_bf16 v[84:87], v[204:207], v[228:231], v[84:87]
    v_mfma_f32_16x16x32_bf16 v[124:127], v[204:207], v[232:235], v[124:127]
    v_mfma_f32_16x16x32_bf16 v[164:167], v[204:207], v[236:239], v[164:167]
    ds_read_b64_tr_b16 v[204:205], v4 offset:256
    ds_read_b64_tr_b16 v[206:207], v4 offset:1536
    s_cmp_lg_u32 s76, 0
    s_cbranch_scc1 L_main_Q
    s_waitcnt lgkmcnt(5)
    v_mfma_f32_16x16x32_bf16 v[8:11], v[168:171], v[208:211], v[8:11]
    ds_read_b128 v[224:227], v2 offset:0
    v_mfma_f32_16x16x32_bf16 v[48:51], v[168:171], v[212:215], v[48:51]
    ds_read_b128 v[228:231], v2 offset:2048
    v_mfma_f32_16x16x32_bf16 v[88:91], v[168:171], v[216:219], v[88:91]
    ds_read_b128 v[232:235], v2 offset:4096
    v_mfma_f32_16x16x32_bf16 v[128:131], v[168:171], v[220:223], v[128:131]
    ds_read_b64_tr_b16 v[168:169], v3 offset:10240
    v_mfma_f32_16x16x32_bf16 v[12:15], v[172:175], v[208:211], v[12:15]
    ds_read_b64_tr_b16 v[170:171], v3 offset:11520
    v_mfma_f32_16x16x32_bf16 v[52:55], v[172:175], v[212:215], v[52:55]
    ds_read_b128 v[236:239], v2 offset:6144
    v_mfma_f32_16x16x32_bf16 v[92:95], v[172:175], v[216:219], v[92:95]
    ds_read_b32 v240, v5 offset:0
    v_mfma_f32_16x16x32_bf16 v[132:135], v[172:175], v[220:223], v[132:135]
    ds_read_b64_tr_b16 v[172:173], v4 offset:10240
    v_mfma_f32_16x16x32_bf16 v[16:19], v[176:179], v[208:211], v[16:19]
    ds_read_b64_tr_b16 v[174:175], v4 offset:11520
    v_mfma_f32_16x16x32_bf16 v[56:59], v[176:179], v[212:215], v[56:59]
    ds_read_b32 v241, v5 offset:1024
    v_mfma_f32_16x16x32_bf16 v[96:99], v[176:179], v[216:219], v[96:99]
    ds_read_b32 v242, v5 offset:64
    v_mfma_f32_16x16x32_bf16 v[136:139], v[176:179], v[220:223], v[136:139]
    ds_read_b64_tr_b16 v[176:177], v3 offset:10304
    v_mfma_f32_16x16x32_bf16 v[20:23], v[180:183], v[208:211], v[20:23]
    ds_read_b64_tr_b16 v[178:179], v3 offset:11584
    v_mfma_f32_16x16x32_bf16 v[60:63], v[180:183], v[212:215], v[60:63]
    ds_read_b32 v243, v5 offset:1088
    v_mfma_f32_16x16x32_bf16 v[100:103], v[180:183], v[216:219], v[100:103]
    ds_read_b32 v244, v5 offset:128
    v_mfma_f32_16x16x32_bf16 v[140:143], v[180:183], v[220:223], v[140:143]
    ds_read_b64_tr_b16 v[180:181], v4 offset:10304
    v_mfma_f32_16x16x32_bf16 v[24:27], v[184:187], v[208:211], v[24:27]
    ds_read_b64_tr_b16 v[182:183], v4 offset:11584
    v_mfma_f32_16x16x32_bf16 v[64:67], v[184:187], v[212:215], v[64:67]
    ds_read_b32 v245, v5 offset:1152
    v_mfma_f32_16x16x32_bf16 v[104:107], v[184:187], v[216:219], v[104:107]
    ds_read_b32 v246, v5 offset:192
    v_mfma_f32_16x16x32_bf16 v[144:147], v[184:187], v[220:223], v[144:147]
    ds_read_b64_tr_b16 v[184:185], v3 offset:10368
    v_mfma_f32_16x16x32_bf16 v[28:31], v[188:191], v[208:211], v[28:31]
    ds_read_b64_tr_b16 v[186:187], v3 offset:11648
    v_mfma_f32_16x16x32_bf16 v[68:71], v[188:191], v[212:215], v[68:71]
    ds_read_b32 v247, v5 offset:1216
    v_mfma_f32_16x16x32_bf16 v[108:111], v[188:191], v[216:219], v[108:111]
    v_mfma_f32_16x16x32_bf16 v[148:151], v[188:191], v[220:223], v[148:151]
    ds_read_b64_tr_b16 v[188:189], v4 offset:10368
    v_mfma_f32_16x16x32_bf16 v[32:35], v[192:195], v[208:211], v[32:35]
    ds_read_b64_tr_b16 v[190:191], v4 offset:11648
    v_mfma_f32_16x16x32_bf16 v[72:75], v[192:195], v[212:215], v[72:75]
    v_mfma_f32_16x16x32_bf16 v[112:115], v[192:195], v[216:219], v[112:115]
    v_mfma_f32_16x16x32_bf16 v[152:155], v[192:195], v[220:223], v[152:155]
    ds_read_b64_tr_b16 v[192:193], v3 offset:10432
    s_waitcnt lgkmcnt(5)
    v_mfma_f32_16x16x32_bf16 v[36:39], v[196:199], v[208:211], v[36:39]
    ds_read_b64_tr_b16 v[194:195], v3 offset:11712
    v_mfma_f32_16x16x32_bf16 v[76:79], v[196:199], v[212:215], v[76:79]
    v_mfma_f32_16x16x32_bf16 v[116:119], v[196:199], v[216:219], v[116:119]
    v_mfma_f32_16x16x32_bf16 v[156:159], v[196:199], v[220:223], v[156:159]
    ds_read_b64_tr_b16 v[196:197], v4 offset:10432
    v_mfma_f32_16x16x32_bf16 v[40:43], v[200:203], v[208:211], v[40:43]
    ds_read_b64_tr_b16 v[198:199], v4 offset:11712
    v_mfma_f32_16x16x32_bf16 v[80:83], v[200:203], v[212:215], v[80:83]
    v_mfma_f32_16x16x32_bf16 v[120:123], v[200:203], v[216:219], v[120:123]
    v_mfma_f32_16x16x32_bf16 v[160:163], v[200:203], v[220:223], v[160:163]
    ds_read_b64_tr_b16 v[200:201], v3 offset:10496
    v_mfma_f32_16x16x32_bf16 v[44:47], v[204:207], v[208:211], v[44:47]
    ds_read_b64_tr_b16 v[202:203], v3 offset:11776
    v_mfma_f32_16x16x32_bf16 v[84:87], v[204:207], v[212:215], v[84:87]
    v_mfma_f32_16x16x32_bf16 v[124:127], v[204:207], v[216:219], v[124:127]
    v_mfma_f32_16x16x32_bf16 v[164:167], v[204:207], v[220:223], v[164:167]
    ds_read_b64_tr_b16 v[204:205], v4 offset:10496
    v_mfma_f32_16x16x32_bf16 v[8:11], v[168:171], v[224:227], v[8:11]
    ds_read_b64_tr_b16 v[206:207], v4 offset:11776
    v_mfma_f32_16x16x32_bf16 v[48:51], v[168:171], v[228:231], v[48:51]
    v_mfma_f32_16x16x32_bf16 v[88:91], v[168:171], v[232:235], v[88:91]
    v_mfma_f32_16x16x32_bf16 v[128:131], v[168:171], v[236:239], v[128:131]
    ds_read_b128 v[168:171], v6 offset:0
    v_mfma_f32_16x16x32_bf16 v[12:15], v[172:175], v[224:227], v[12:15]
    v_mfma_f32_16x16x32_bf16 v[52:55], v[172:175], v[228:231], v[52:55]
    v_mfma_f32_16x16x32_bf16 v[92:95], v[172:175], v[232:235], v[92:95]
    v_mfma_f32_16x16x32_bf16 v[132:135], v[172:175], v[236:239], v[132:135]
    ds_read_b128 v[172:175], v6 offset:64
    v_mfma_f32_16x16x32_bf16 v[16:19], v[176:179], v[224:227], v[16:19]
    v_mfma_f32_16x16x32_bf16 v[56:59], v[176:179], v[228:231], v[56:59]
    v_mfma_f32_16x16x32_bf16 v[96:99], v[176:179], v[232:235], v[96:99]
    v_mfma_f32_16x16x32_bf16 v[136:139], v[176:179], v[236:239], v[136:139]
    ds_read_b128 v[176:179], v6 offset:128
    v_mfma_f32_16x16x32_bf16 v[20:23], v[180:183], v[224:227], v[20:23]
    v_mfma_f32_16x16x32_bf16 v[60:63], v[180:183], v[228:231], v[60:63]
    v_mfma_f32_16x16x32_bf16 v[100:103], v[180:183], v[232:235], v[100:103]
    v_mfma_f32_16x16x32_bf16 v[140:143], v[180:183], v[236:239], v[140:143]
    ds_read_b128 v[180:183], v6 offset:192
    s_waitcnt lgkmcnt(2)
    v_mfma_f32_16x16x32_bf16 v[24:27], v[184:187], v[224:227], v[24:27]
    v_mfma_f32_16x16x32_bf16 v[64:67], v[184:187], v[228:231], v[64:67]
    v_mfma_f32_16x16x32_bf16 v[104:107], v[184:187], v[232:235], v[104:107]
    v_mfma_f32_16x16x32_bf16 v[144:147], v[184:187], v[236:239], v[144:147]
    ds_read_b128 v[184:187], v6 offset:256
    v_mfma_f32_16x16x32_bf16 v[28:31], v[188:191], v[224:227], v[28:31]
    v_mfma_f32_16x16x32_bf16 v[68:71], v[188:191], v[228:231], v[68:71]
    v_mfma_f32_16x16x32_bf16 v[108:111], v[188:191], v[232:235], v[108:111]
    v_mfma_f32_16x16x32_bf16 v[148:151], v[188:191], v[236:239], v[148:151]
    ds_read_b128 v[188:191], v6 offset:320
    v_mfma_f32_16x16x32_bf16 v[32:35], v[192:195], v[224:227], v[32:35]
    v_mfma_f32_16x16x32_bf16 v[72:75], v[192:195], v[228:231], v[72:75]
    v_mfma_f32_16x16x32_bf16 v[112:115], v[192:195], v[232:235], v[112:115]
    v_mfma_f32_16x16x32_bf16 v[152:155], v[192:195], v[236:239], v[152:155]
    ds_read_b128 v[192:195], v6 offset:384
    v_mfma_f32_16x16x32_bf16 v[36:39], v[196:199], v[224:227], v[36:39]
    v_mfma_f32_16x16x32_bf16 v[76:79], v[196:199], v[228:231], v[76:79]
    v_mfma_f32_16x16x32_bf16 v[116:119], v[196:199], v[232:235], v[116:119]
    v_mfma_f32_16x16x32_bf16 v[156:159], v[196:199], v[236:239], v[156:159]
    ds_read_b128 v[196:199], v6 offset:448
    v_mfma_f32_16x16x32_bf16 v[40:43], v[200:203], v[224:227], v[40:43]
    v_mfma_f32_16x16x32_bf16 v[80:83], v[200:203], v[228:231], v[80:83]
    v_mfma_f32_16x16x32_bf16 v[120:123], v[200:203], v[232:235], v[120:123]
    v_mfma_f32_16x16x32_bf16 v[160:163], v[200:203], v[236:239], v[160:163]
    ds_read_b128 v[200:203], v6 offset:512
    v_mfma_f32_16x16x32_bf16 v[44:47], v[204:207], v[224:227], v[44:47]
    v_mfma_f32_16x16x32_bf16 v[84:87], v[204:207], v[228:231], v[84:87]
    v_mfma_f32_16x16x32_bf16 v[124:127], v[204:207], v[232:235], v[124:127]
    v_mfma_f32_16x16x32_bf16 v[164:167], v[204:207], v[236:239], v[164:167]
    ds_read_b128 v[204:207], v6 offset:576
    s_waitcnt lgkmcnt(0)
    v_mov_b32 v216, 0xb5c1a2a0
    v_pk_fma_f32 v[8:9], v[168:169], v[240:241], v[8:9] op_sel_hi:[1,0,1]
    v_pk_fma_f32 v[10:11], v[170:171], v[240:241], v[10:11] op_sel_hi:[1,0,1]
    v_pk_fma_f32 v[12:13], v[172:173], v[240:241], v[12:13] op_sel_hi:[1,0,1]
    v_pk_fma_f32 v[14:15], v[174:175], v[240:241], v[14:15] op_sel_hi:[1,0,1]
    v_pk_fma_f32 v[8:9], v[8:9], v[240:241], v[248:249] op_sel:[0,1,0] op_sel_hi:[1,1,0]
    v_pk_fma_f32 v[10:11], v[10:11], v[240:241], v[248:249] op_sel:[0,1,0] op_sel_hi:[1,1,0]
    v_pk_fma_f32 v[12:13], v[12:13], v[240:241], v[248:249] op_sel:[0,1,0] op_sel_hi:[1,1,0]
    v_pk_fma_f32 v[14:15], v[14:15], v[240:241], v[248:249] op_sel:[0,1,0] op_sel_hi:[1,1,0]
    v_pk_fma_f32 v[208:209], v[8:9], v[248:249], v[216:217] op_sel:[0,1,0] op_sel_hi:[1,1,0]
    v_pk_fma_f32 v[210:211], v[10:11], v[248:249], v[216:217] op_sel:[0,1,0] op_sel_hi:[1,1,0]
    v_pk_fma_f32 v[212:213], v[12:13], v[248:249], v[216:217] op_sel:[0,1,0] op_sel_hi:[1,1,0]
    v_pk_fma_f32 v[214:215], v[14:15], v[248:249], v[216:217] op_sel:[0,1,0] op_sel_hi:[1,1,0]
    v_exp_f32 v208, v208 clamp
    v_exp_f32 v209, v209 clamp
    v_exp_f32 v210, v210 clamp
    v_exp_f32 v211, v211 clamp
    v_exp_f32 v212, v212 clamp
    v_exp_f32 v213, v213 clamp
    v_exp_f32 v214, v214 clamp
    v_exp_f32 v215, v215 clamp
    v_max_f32 v8, v248, v8
    v_max_f32 v9, v248, v9
    v_max_f32 v10, v248, v10
    v_max_f32 v11, v248, v11
    v_max_f32 v12, v248, v12
    v_max_f32 v13, v248, v13
    v_max_f32 v14, v248, v14
    v_max_f32 v15, v248, v15
    v_pk_add_f32 v[208:209], v[208:209], v[8:9]
    v_pk_add_f32 v[210:211], v[210:211], v[10:11]
    v_pk_add_f32 v[212:213], v[212:213], v[12:13]
    v_pk_add_f32 v[214:215], v[214:215], v[14:15]
    v_cvt_pk_bf16_f32 v8, v208, v209
    v_cvt_pk_bf16_f32 v9, v210, v211
    v_cvt_pk_bf16_f32 v10, v212, v213
    v_cvt_pk_bf16_f32 v11, v214, v215
    v_pk_fma_f32 v[16:17], v[176:177], v[240:241], v[16:17] op_sel_hi:[1,0,1]
    v_pk_fma_f32 v[18:19], v[178:179], v[240:241], v[18:19] op_sel_hi:[1,0,1]
    v_pk_fma_f32 v[20:21], v[180:181], v[240:241], v[20:21] op_sel_hi:[1,0,1]
    v_pk_fma_f32 v[22:23], v[182:183], v[240:241], v[22:23] op_sel_hi:[1,0,1]
    v_pk_fma_f32 v[16:17], v[16:17], v[240:241], v[248:249] op_sel:[0,1,0] op_sel_hi:[1,1,0]
    v_pk_fma_f32 v[18:19], v[18:19], v[240:241], v[248:249] op_sel:[0,1,0] op_sel_hi:[1,1,0]
    v_pk_fma_f32 v[20:21], v[20:21], v[240:241], v[248:249] op_sel:[0,1,0] op_sel_hi:[1,1,0]
    v_pk_fma_f32 v[22:23], v[22:23], v[240:241], v[248:249] op_sel:[0,1,0] op_sel_hi:[1,1,0]
    v_pk_fma_f32 v[208:209], v[16:17], v[248:249], v[216:217] op_sel:[0,1,0] op_sel_hi:[1,1,0]
    v_pk_fma_f32 v[210:211], v[18:19], v[248:249], v[216:217] op_sel:[0,1,0] op_sel_hi:[1,1,0]
    v_pk_fma_f32 v[212:213], v[20:21], v[248:249], v[216:217] op_sel:[0,1,0] op_sel_hi:[1,1,0]
    v_pk_fma_f32 v[214:215], v[22:23], v[248:249], v[216:217] op_sel:[0,1,0] op_sel_hi:[1,1,0]
    v_exp_f32 v208, v208 clamp
    v_exp_f32 v209, v209 clamp
    v_exp_f32 v210, v210 clamp
    v_exp_f32 v211, v211 clamp
    v_exp_f32 v212, v212 clamp
    v_exp_f32 v213, v213 clamp
    v_exp_f32 v214, v214 clamp
    v_exp_f32 v215, v215 clamp
    v_max_f32 v16, v248, v16
    v_max_f32 v17, v248, v17
    v_max_f32 v18, v248, v18
    v_max_f32 v19, v248, v19
    v_max_f32 v20, v248, v20
    v_max_f32 v21, v248, v21
    v_max_f32 v22, v248, v22
    v_max_f32 v23, v248, v23
    v_pk_add_f32 v[208:209], v[208:209], v[16:17]
    v_pk_add_f32 v[210:211], v[210:211], v[18:19]
    v_pk_add_f32 v[212:213], v[212:213], v[20:21]
    v_pk_add_f32 v[214:215], v[214:215], v[22:23]
    v_cvt_pk_bf16_f32 v16, v208, v209
    v_cvt_pk_bf16_f32 v17, v210, v211
    v_cvt_pk_bf16_f32 v18, v212, v213
    v_cvt_pk_bf16_f32 v19, v214, v215
    v_pk_fma_f32 v[24:25], v[184:185], v[240:241], v[24:25] op_sel_hi:[1,0,1]
    v_pk_fma_f32 v[26:27], v[186:187], v[240:241], v[26:27] op_sel_hi:[1,0,1]
    v_pk_fma_f32 v[28:29], v[188:189], v[240:241], v[28:29] op_sel_hi:[1,0,1]
    v_pk_fma_f32 v[30:31], v[190:191], v[240:241], v[30:31] op_sel_hi:[1,0,1]
    v_pk_fma_f32 v[24:25], v[24:25], v[240:241], v[248:249] op_sel:[0,1,0] op_sel_hi:[1,1,0]
    v_pk_fma_f32 v[26:27], v[26:27], v[240:241], v[248:249] op_sel:[0,1,0] op_sel_hi:[1,1,0]
    v_pk_fma_f32 v[28:29], v[28:29], v[240:241], v[248:249] op_sel:[0,1,0] op_sel_hi:[1,1,0]
    v_pk_fma_f32 v[30:31], v[30:31], v[240:241], v[248:249] op_sel:[0,1,0] op_sel_hi:[1,1,0]
    v_pk_fma_f32 v[208:209], v[24:25], v[248:249], v[216:217] op_sel:[0,1,0] op_sel_hi:[1,1,0]
    v_pk_fma_f32 v[210:211], v[26:27], v[248:249], v[216:217] op_sel:[0,1,0] op_sel_hi:[1,1,0]
    v_pk_fma_f32 v[212:213], v[28:29], v[248:249], v[216:217] op_sel:[0,1,0] op_sel_hi:[1,1,0]
    v_pk_fma_f32 v[214:215], v[30:31], v[248:249], v[216:217] op_sel:[0,1,0] op_sel_hi:[1,1,0]
    v_exp_f32 v208, v208 clamp
    v_exp_f32 v209, v209 clamp
    v_exp_f32 v210, v210 clamp
    v_exp_f32 v211, v211 clamp
    v_exp_f32 v212, v212 clamp
    v_exp_f32 v213, v213 clamp
    v_exp_f32 v214, v214 clamp
    v_exp_f32 v215, v215 clamp
    v_max_f32 v24, v248, v24
    v_max_f32 v25, v248, v25
    v_max_f32 v26, v248, v26
    v_max_f32 v27, v248, v27
    v_max_f32 v28, v248, v28
    v_max_f32 v29, v248, v29
    v_max_f32 v30, v248, v30
    v_max_f32 v31, v248, v31
    v_pk_add_f32 v[208:209], v[208:209], v[24:25]
    v_pk_add_f32 v[210:211], v[210:211], v[26:27]
    v_pk_add_f32 v[212:213], v[212:213], v[28:29]
    v_pk_add_f32 v[214:215], v[214:215], v[30:31]
    v_cvt_pk_bf16_f32 v24, v208, v209
    v_cvt_pk_bf16_f32 v25, v210, v211
    v_cvt_pk_bf16_f32 v26, v212, v213
    v_cvt_pk_bf16_f32 v27, v214, v215
    v_pk_fma_f32 v[32:33], v[192:193], v[240:241], v[32:33] op_sel_hi:[1,0,1]
    v_pk_fma_f32 v[34:35], v[194:195], v[240:241], v[34:35] op_sel_hi:[1,0,1]
    v_pk_fma_f32 v[36:37], v[196:197], v[240:241], v[36:37] op_sel_hi:[1,0,1]
    v_pk_fma_f32 v[38:39], v[198:199], v[240:241], v[38:39] op_sel_hi:[1,0,1]
    v_pk_fma_f32 v[32:33], v[32:33], v[240:241], v[248:249] op_sel:[0,1,0] op_sel_hi:[1,1,0]
    v_pk_fma_f32 v[34:35], v[34:35], v[240:241], v[248:249] op_sel:[0,1,0] op_sel_hi:[1,1,0]
    v_pk_fma_f32 v[36:37], v[36:37], v[240:241], v[248:249] op_sel:[0,1,0] op_sel_hi:[1,1,0]
    v_pk_fma_f32 v[38:39], v[38:39], v[240:241], v[248:249] op_sel:[0,1,0] op_sel_hi:[1,1,0]
    v_pk_fma_f32 v[208:209], v[32:33], v[248:249], v[216:217] op_sel:[0,1,0] op_sel_hi:[1,1,0]
    v_pk_fma_f32 v[210:211], v[34:35], v[248:249], v[216:217] op_sel:[0,1,0] op_sel_hi:[1,1,0]
    v_pk_fma_f32 v[212:213], v[36:37], v[248:249], v[216:217] op_sel:[0,1,0] op_sel_hi:[1,1,0]
    v_pk_fma_f32 v[214:215], v[38:39], v[248:249], v[216:217] op_sel:[0,1,0] op_sel_hi:[1,1,0]
    v_exp_f32 v208, v208 clamp
    v_exp_f32 v209, v209 clamp
    v_exp_f32 v210, v210 clamp
    v_exp_f32 v211, v211 clamp
    v_exp_f32 v212, v212 clamp
    v_exp_f32 v213, v213 clamp
    v_exp_f32 v214, v214 clamp
    v_exp_f32 v215, v215 clamp
    v_max_f32 v32, v248, v32
    v_max_f32 v33, v248, v33
    v_max_f32 v34, v248, v34
    v_max_f32 v35, v248, v35
    v_max_f32 v36, v248, v36
    v_max_f32 v37, v248, v37
    v_max_f32 v38, v248, v38
    v_max_f32 v39, v248, v39
    v_pk_add_f32 v[208:209], v[208:209], v[32:33]
    v_pk_add_f32 v[210:211], v[210:211], v[34:35]
    v_pk_add_f32 v[212:213], v[212:213], v[36:37]
    v_pk_add_f32 v[214:215], v[214:215], v[38:39]
    v_cvt_pk_bf16_f32 v32, v208, v209
    v_cvt_pk_bf16_f32 v33, v210, v211
    v_cvt_pk_bf16_f32 v34, v212, v213
    v_cvt_pk_bf16_f32 v35, v214, v215
    v_pk_fma_f32 v[40:41], v[200:201], v[240:241], v[40:41] op_sel_hi:[1,0,1]
    v_pk_fma_f32 v[42:43], v[202:203], v[240:241], v[42:43] op_sel_hi:[1,0,1]
    v_pk_fma_f32 v[44:45], v[204:205], v[240:241], v[44:45] op_sel_hi:[1,0,1]
    v_pk_fma_f32 v[46:47], v[206:207], v[240:241], v[46:47] op_sel_hi:[1,0,1]
    v_pk_fma_f32 v[40:41], v[40:41], v[240:241], v[248:249] op_sel:[0,1,0] op_sel_hi:[1,1,0]
    v_pk_fma_f32 v[42:43], v[42:43], v[240:241], v[248:249] op_sel:[0,1,0] op_sel_hi:[1,1,0]
    v_pk_fma_f32 v[44:45], v[44:45], v[240:241], v[248:249] op_sel:[0,1,0] op_sel_hi:[1,1,0]
    v_pk_fma_f32 v[46:47], v[46:47], v[240:241], v[248:249] op_sel:[0,1,0] op_sel_hi:[1,1,0]
    v_pk_fma_f32 v[208:209], v[40:41], v[248:249], v[216:217] op_sel:[0,1,0] op_sel_hi:[1,1,0]
    v_pk_fma_f32 v[210:211], v[42:43], v[248:249], v[216:217] op_sel:[0,1,0] op_sel_hi:[1,1,0]
    v_pk_fma_f32 v[212:213], v[44:45], v[248:249], v[216:217] op_sel:[0,1,0] op_sel_hi:[1,1,0]
    v_pk_fma_f32 v[214:215], v[46:47], v[248:249], v[216:217] op_sel:[0,1,0] op_sel_hi:[1,1,0]
    v_exp_f32 v208, v208 clamp
    v_exp_f32 v209, v209 clamp
    v_exp_f32 v210, v210 clamp
    v_exp_f32 v211, v211 clamp
    v_exp_f32 v212, v212 clamp
    v_exp_f32 v213, v213 clamp
    v_exp_f32 v214, v214 clamp
    v_exp_f32 v215, v215 clamp
    v_max_f32 v40, v248, v40
    v_max_f32 v41, v248, v41
    v_max_f32 v42, v248, v42
    v_max_f32 v43, v248, v43
    v_max_f32 v44, v248, v44
    v_max_f32 v45, v248, v45
    v_max_f32 v46, v248, v46
    v_max_f32 v47, v248, v47
    v_pk_add_f32 v[208:209], v[208:209], v[40:41]
    v_pk_add_f32 v[210:211], v[210:211], v[42:43]
    v_pk_add_f32 v[212:213], v[212:213], v[44:45]
    v_pk_add_f32 v[214:215], v[214:215], v[46:47]
    v_cvt_pk_bf16_f32 v40, v208, v209
    v_cvt_pk_bf16_f32 v41, v210, v211
    v_cvt_pk_bf16_f32 v42, v212, v213
    v_cvt_pk_bf16_f32 v43, v214, v215
    v_pk_fma_f32 v[48:49], v[168:169], v[242:243], v[48:49] op_sel_hi:[1,0,1]
    v_pk_fma_f32 v[50:51], v[170:171], v[242:243], v[50:51] op_sel_hi:[1,0,1]
    v_pk_fma_f32 v[52:53], v[172:173], v[242:243], v[52:53] op_sel_hi:[1,0,1]
    v_pk_fma_f32 v[54:55], v[174:175], v[242:243], v[54:55] op_sel_hi:[1,0,1]
    v_pk_fma_f32 v[48:49], v[48:49], v[242:243], v[248:249] op_sel:[0,1,0] op_sel_hi:[1,1,0]
    v_pk_fma_f32 v[50:51], v[50:51], v[242:243], v[248:249] op_sel:[0,1,0] op_sel_hi:[1,1,0]
    v_pk_fma_f32 v[52:53], v[52:53], v[242:243], v[248:249] op_sel:[0,1,0] op_sel_hi:[1,1,0]
    v_pk_fma_f32 v[54:55], v[54:55], v[242:243], v[248:249] op_sel:[0,1,0] op_sel_hi:[1,1,0]
    v_pk_fma_f32 v[208:209], v[48:49], v[248:249], v[216:217] op_sel:[0,1,0] op_sel_hi:[1,1,0]
    v_pk_fma_f32 v[210:211], v[50:51], v[248:249], v[216:217] op_sel:[0,1,0] op_sel_hi:[1,1,0]
    v_pk_fma_f32 v[212:213], v[52:53], v[248:249], v[216:217] op_sel:[0,1,0] op_sel_hi:[1,1,0]
    v_pk_fma_f32 v[214:215], v[54:55], v[248:249], v[216:217] op_sel:[0,1,0] op_sel_hi:[1,1,0]
    v_exp_f32 v208, v208 clamp
    v_exp_f32 v209, v209 clamp
    v_exp_f32 v210, v210 clamp
    v_exp_f32 v211, v211 clamp
    v_exp_f32 v212, v212 clamp
    v_exp_f32 v213, v213 clamp
    v_exp_f32 v214, v214 clamp
    v_exp_f32 v215, v215 clamp
    v_max_f32 v48, v248, v48
    v_max_f32 v49, v248, v49
    v_max_f32 v50, v248, v50
    v_max_f32 v51, v248, v51
    v_max_f32 v52, v248, v52
    v_max_f32 v53, v248, v53
    v_max_f32 v54, v248, v54
    v_max_f32 v55, v248, v55
    v_pk_add_f32 v[208:209], v[208:209], v[48:49]
    v_pk_add_f32 v[210:211], v[210:211], v[50:51]
    v_pk_add_f32 v[212:213], v[212:213], v[52:53]
    v_pk_add_f32 v[214:215], v[214:215], v[54:55]
    v_cvt_pk_bf16_f32 v48, v208, v209
    v_cvt_pk_bf16_f32 v49, v210, v211
    v_cvt_pk_bf16_f32 v50, v212, v213
    v_cvt_pk_bf16_f32 v51, v214, v215
    v_pk_fma_f32 v[56:57], v[176:177], v[242:243], v[56:57] op_sel_hi:[1,0,1]
    v_pk_fma_f32 v[58:59], v[178:179], v[242:243], v[58:59] op_sel_hi:[1,0,1]
    v_pk_fma_f32 v[60:61], v[180:181], v[242:243], v[60:61] op_sel_hi:[1,0,1]
    v_pk_fma_f32 v[62:63], v[182:183], v[242:243], v[62:63] op_sel_hi:[1,0,1]
    v_pk_fma_f32 v[56:57], v[56:57], v[242:243], v[248:249] op_sel:[0,1,0] op_sel_hi:[1,1,0]
    v_pk_fma_f32 v[58:59], v[58:59], v[242:243], v[248:249] op_sel:[0,1,0] op_sel_hi:[1,1,0]
    v_pk_fma_f32 v[60:61], v[60:61], v[242:243], v[248:249] op_sel:[0,1,0] op_sel_hi:[1,1,0]
    v_pk_fma_f32 v[62:63], v[62:63], v[242:243], v[248:249] op_sel:[0,1,0] op_sel_hi:[1,1,0]
    v_pk_fma_f32 v[208:209], v[56:57], v[248:249], v[216:217] op_sel:[0,1,0] op_sel_hi:[1,1,0]
    v_pk_fma_f32 v[210:211], v[58:59], v[248:249], v[216:217] op_sel:[0,1,0] op_sel_hi:[1,1,0]
    v_pk_fma_f32 v[212:213], v[60:61], v[248:249], v[216:217] op_sel:[0,1,0] op_sel_hi:[1,1,0]
    v_pk_fma_f32 v[214:215], v[62:63], v[248:249], v[216:217] op_sel:[0,1,0] op_sel_hi:[1,1,0]
    v_exp_f32 v208, v208 clamp
    v_exp_f32 v209, v209 clamp
    v_exp_f32 v210, v210 clamp
    v_exp_f32 v211, v211 clamp
    v_exp_f32 v212, v212 clamp
    v_exp_f32 v213, v213 clamp
    v_exp_f32 v214, v214 clamp
    v_exp_f32 v215, v215 clamp
    v_max_f32 v56, v248, v56
    v_max_f32 v57, v248, v57
    v_max_f32 v58, v248, v58
    v_max_f32 v59, v248, v59
    v_max_f32 v60, v248, v60
    v_max_f32 v61, v248, v61
    v_max_f32 v62, v248, v62
    v_max_f32 v63, v248, v63
    v_pk_add_f32 v[208:209], v[208:209], v[56:57]
    v_pk_add_f32 v[210:211], v[210:211], v[58:59]
L_pad_6:
    s_cbranch_execz L_padret_Q
    v_pk_add_f32 v[212:213], v[212:213], v[60:61]
    v_pk_add_f32 v[214:215], v[214:215], v[62:63]
    v_cvt_pk_bf16_f32 v56, v208, v209
    v_cvt_pk_bf16_f32 v57, v210, v211
    v_cvt_pk_bf16_f32 v58, v212, v213
    v_cvt_pk_bf16_f32 v59, v214, v215
    v_pk_fma_f32 v[64:65], v[184:185], v[242:243], v[64:65] op_sel_hi:[1,0,1]
    v_pk_fma_f32 v[66:67], v[186:187], v[242:243], v[66:67] op_sel_hi:[1,0,1]
    v_pk_fma_f32 v[68:69], v[188:189], v[242:243], v[68:69] op_sel_hi:[1,0,1]
    v_pk_fma_f32 v[70:71], v[190:191], v[242:243], v[70:71] op_sel_hi:[1,0,1]
    v_pk_fma_f32 v[64:65], v[64:65], v[242:243], v[248:249] op_sel:[0,1,0] op_sel_hi:[1,1,0]
    v_pk_fma_f32 v[66:67], v[66:67], v[242:243], v[248:249] op_sel:[0,1,0] op_sel_hi:[1,1,0]
    v_pk_fma_f32 v[68:69], v[68:69], v[242:243], v[248:249] op_sel:[0,1,0] op_sel_hi:[1,1,0]
    v_pk_fma_f32 v[70:71], v[70:71], v[242:243], v[248:249] op_sel:[0,1,0] op_sel_hi:[1,1,0]
    v_pk_fma_f32 v[208:209], v[64:65], v[248:249], v[216:217] op_sel:[0,1,0] op_sel_hi:[1,1,0]
    v_pk_fma_f32 v[210:211], v[66:67], v[248:249], v[216:217] op_sel:[0,1,0] op_sel_hi:[1,1,0]
    v_pk_fma_f32 v[212:213], v[68:69], v[248:249], v[216:217] op_sel:[0,1,0] op_sel_hi:[1,1,0]
    v_pk_fma_f32 v[214:215], v[70:71], v[248:249], v[216:217] op_sel:[0,1,0] op_sel_hi:[1,1,0]
    v_exp_f32 v208, v208 clamp
    v_exp_f32 v209, v209 clamp
    v_exp_f32 v210, v210 clamp
    v_exp_f32 v211, v211 clamp
    v_exp_f32 v212, v212 clamp
    v_exp_f32 v213, v213 clamp
    v_exp_f32 v214, v214 clamp
    v_exp_f32 v215, v215 clamp
    v_max_f32 v64, v248, v64
    v_max_f32 v65, v248, v65
    v_max_f32 v66, v248, v66
    v_max_f32 v67, v248, v67
    v_max_f32 v68, v248, v68
    v_max_f32 v69, v248, v69
    v_max_f32 v70, v248, v70
    v_max_f32 v71, v248, v71
    v_pk_add_f32 v[208:209], v[208:209], v[64:65]
    v_pk_add_f32 v[210:211], v[210:211], v[66:67]
    v_pk_add_f32 v[212:213], v[212:213], v[68:69]
    v_pk_add_f32 v[214:215], v[214:215], v[70:71]
    v_cvt_pk_bf16_f32 v64, v208, v209
    v_cvt_pk_bf16_f32 v65, v210, v211
    v_cvt_pk_bf16_f32 v66, v212, v213
    v_cvt_pk_bf16_f32 v67, v214, v215
    v_pk_fma_f32 v[72:73], v[192:193], v[242:243], v[72:73] op_sel_hi:[1,0,1]
    v_pk_fma_f32 v[74:75], v[194:195], v[242:243], v[74:75] op_sel_hi:[1,0,1]
    v_pk_fma_f32 v[76:77], v[196:197], v[242:243], v[76:77] op_sel_hi:[1,0,1]
    v_pk_fma_f32 v[78:79], v[198:199], v[242:243], v[78:79] op_sel_hi:[1,0,1]
    v_pk_fma_f32 v[72:73], v[72:73], v[242:243], v[248:249] op_sel:[0,1,0] op_sel_hi:[1,1,0]
    v_pk_fma_f32 v[74:75], v[74:75], v[242:243], v[248:249] op_sel:[0,1,0] op_sel_hi:[1,1,0]
    v_pk_fma_f32 v[76:77], v[76:77], v[242:243], v[248:249] op_sel:[0,1,0] op_sel_hi:[1,1,0]
    v_pk_fma_f32 v[78:79], v[78:79], v[242:243], v[248:249] op_sel:[0,1,0] op_sel_hi:[1,1,0]
    v_pk_fma_f32 v[208:209], v[72:73], v[248:249], v[216:217] op_sel:[0,1,0] op_sel_hi:[1,1,0]
    v_pk_fma_f32 v[210:211], v[74:75], v[248:249], v[216:217] op_sel:[0,1,0] op_sel_hi:[1,1,0]
    v_pk_fma_f32 v[212:213], v[76:77], v[248:249], v[216:217] op_sel:[0,1,0] op_sel_hi:[1,1,0]
    v_pk_fma_f32 v[214:215], v[78:79], v[248:249], v[216:217] op_sel:[0,1,0] op_sel_hi:[1,1,0]
    v_exp_f32 v208, v208 clamp
    v_exp_f32 v209, v209 clamp
    v_exp_f32 v210, v210 clamp
    v_exp_f32 v211, v211 clamp
    v_exp_f32 v212, v212 clamp
    v_exp_f32 v213, v213 clamp
    v_exp_f32 v214, v214 clamp
    v_exp_f32 v215, v215 clamp
    v_max_f32 v72, v248, v72
    v_max_f32 v73, v248, v73
    v_max_f32 v74, v248, v74
    v_max_f32 v75, v248, v75
    v_max_f32 v76, v248, v76
    v_max_f32 v77, v248, v77
    v_max_f32 v78, v248, v78
    v_max_f32 v79, v248, v79
    v_pk_add_f32 v[208:209], v[208:209], v[72:73]
    v_pk_add_f32 v[210:211], v[210:211], v[74:75]
    v_pk_add_f32 v[212:213], v[212:213], v[76:77]
    v_pk_add_f32 v[214:215], v[214:215], v[78:79]
    v_cvt_pk_bf16_f32 v72, v208, v209
    v_cvt_pk_bf16_f32 v73, v210, v211
    v_cvt_pk_bf16_f32 v74, v212, v213
    v_cvt_pk_bf16_f32 v75, v214, v215
    v_pk_fma_f32 v[80:81], v[200:201], v[242:243], v[80:81] op_sel_hi:[1,0,1]
    v_pk_fma_f32 v[82:83], v[202:203], v[242:243], v[82:83] op_sel_hi:[1,0,1]
    v_pk_fma_f32 v[84:85], v[204:205], v[242:243], v[84:85] op_sel_hi:[1,0,1]
    v_pk_fma_f32 v[86:87], v[206:207], v[242:243], v[86:87] op_sel_hi:[1,0,1]
    v_pk_fma_f32 v[80:81], v[80:81], v[242:243], v[248:249] op_sel:[0,1,0] op_sel_hi:[1,1,0]
    v_pk_fma_f32 v[82:83], v[82:83], v[242:243], v[248:249] op_sel:[0,1,0] op_sel_hi:[1,1,0]
    v_pk_fma_f32 v[84:85], v[84:85], v[242:243], v[248:249] op_sel:[0,1,0] op_sel_hi:[1,1,0]
    v_pk_fma_f32 v[86:87], v[86:87], v[242:243], v[248:249] op_sel:[0,1,0] op_sel_hi:[1,1,0]
    v_pk_fma_f32 v[208:209], v[80:81], v[248:249], v[216:217] op_sel:[0,1,0] op_sel_hi:[1,1,0]
    v_pk_fma_f32 v[210:211], v[82:83], v[248:249], v[216:217] op_sel:[0,1,0] op_sel_hi:[1,1,0]
    v_pk_fma_f32 v[212:213], v[84:85], v[248:249], v[216:217] op_sel:[0,1,0] op_sel_hi:[1,1,0]
    v_pk_fma_f32 v[214:215], v[86:87], v[248:249], v[216:217] op_sel:[0,1,0] op_sel_hi:[1,1,0]
    v_exp_f32 v208, v208 clamp
    v_exp_f32 v209, v209 clamp
    v_exp_f32 v210, v210 clamp
    v_exp_f32 v211, v211 clamp
    v_exp_f32 v212, v212 clamp
    v_exp_f32 v213, v213 clamp
    v_exp_f32 v214, v214 clamp
    v_exp_f32 v215, v215 clamp
    v_max_f32 v80, v248, v80
    v_max_f32 v81, v248, v81
    v_max_f32 v82, v248, v82
    v_max_f32 v83, v248, v83
    v_max_f32 v84, v248, v84
    v_max_f32 v85, v248, v85
    v_max_f32 v86, v248, v86
    v_max_f32 v87, v248, v87
    v_pk_add_f32 v[208:209], v[208:209], v[80:81]
    v_pk_add_f32 v[210:211], v[210:211], v[82:83]
    v_pk_add_f32 v[212:213], v[212:213], v[84:85]
    v_pk_add_f32 v[214:215], v[214:215], v[86:87]
    v_cvt_pk_bf16_f32 v80, v208, v209
    v_cvt_pk_bf16_f32 v81, v210, v211
    v_cvt_pk_bf16_f32 v82, v212, v213
    v_cvt_pk_bf16_f32 v83, v214, v215
    v_pk_fma_f32 v[88:89], v[168:169], v[244:245], v[88:89] op_sel_hi:[1,0,1]
    v_pk_fma_f32 v[90:91], v[170:171], v[244:245], v[90:91] op_sel_hi:[1,0,1]
    v_pk_fma_f32 v[92:93], v[172:173], v[244:245], v[92:93] op_sel_hi:[1,0,1]
    v_pk_fma_f32 v[94:95], v[174:175], v[244:245], v[94:95] op_sel_hi:[1,0,1]
    v_pk_fma_f32 v[88:89], v[88:89], v[244:245], v[248:249] op_sel:[0,1,0] op_sel_hi:[1,1,0]
    v_pk_fma_f32 v[90:91], v[90:91], v[244:245], v[248:249] op_sel:[0,1,0] op_sel_hi:[1,1,0]
    v_pk_fma_f32 v[92:93], v[92:93], v[244:245], v[248:249] op_sel:[0,1,0] op_sel_hi:[1,1,0]
    v_pk_fma_f32 v[94:95], v[94:95], v[244:245], v[248:249] op_sel:[0,1,0] op_sel_hi:[1,1,0]
    v_pk_fma_f32 v[208:209], v[88:89], v[248:249], v[216:217] op_sel:[0,1,0] op_sel_hi:[1,1,0]
    v_pk_fma_f32 v[210:211], v[90:91], v[248:249], v[216:217] op_sel:[0,1,0] op_sel_hi:[1,1,0]
    v_pk_fma_f32 v[212:213], v[92:93], v[248:249], v[216:217] op_sel:[0,1,0] op_sel_hi:[1,1,0]
    v_pk_fma_f32 v[214:215], v[94:95], v[248:249], v[216:217] op_sel:[0,1,0] op_sel_hi:[1,1,0]
    v_exp_f32 v208, v208 clamp
    v_exp_f32 v209, v209 clamp
    v_exp_f32 v210, v210 clamp
    v_exp_f32 v211, v211 clamp
    v_exp_f32 v212, v212 clamp
    v_exp_f32 v213, v213 clamp
    v_exp_f32 v214, v214 clamp
    v_exp_f32 v215, v215 clamp
    v_max_f32 v88, v248, v88
    v_max_f32 v89, v248, v89
    v_max_f32 v90, v248, v90
    v_max_f32 v91, v248, v91
    v_max_f32 v92, v248, v92
    v_max_f32 v93, v248, v93
    v_max_f32 v94, v248, v94
    v_max_f32 v95, v248, v95
    v_pk_add_f32 v[208:209], v[208:209], v[88:89]
    v_pk_add_f32 v[210:211], v[210:211], v[90:91]
    v_pk_add_f32 v[212:213], v[212:213], v[92:93]
    v_pk_add_f32 v[214:215], v[214:215], v[94:95]
    v_cvt_pk_bf16_f32 v88, v208, v209
    v_cvt_pk_bf16_f32 v89, v210, v211
    v_cvt_pk_bf16_f32 v90, v212, v213
    v_cvt_pk_bf16_f32 v91, v214, v215
    v_pk_fma_f32 v[96:97], v[176:177], v[244:245], v[96:97] op_sel_hi:[1,0,1]
    v_pk_fma_f32 v[98:99], v[178:179], v[244:245], v[98:99] op_sel_hi:[1,0,1]
    v_pk_fma_f32 v[100:101], v[180:181], v[244:245], v[100:101] op_sel_hi:[1,0,1]
    v_pk_fma_f32 v[102:103], v[182:183], v[244:245], v[102:103] op_sel_hi:[1,0,1]
    v_pk_fma_f32 v[96:97], v[96:97], v[244:245], v[248:249] op_sel:[0,1,0] op_sel_hi:[1,1,0]
    v_pk_fma_f32 v[98:99], v[98:99], v[244:245], v[248:249] op_sel:[0,1,0] op_sel_hi:[1,1,0]
    v_pk_fma_f32 v[100:101], v[100:101], v[244:245], v[248:249] op_sel:[0,1,0] op_sel_hi:[1,1,0]
    v_pk_fma_f32 v[102:103], v[102:103], v[244:245], v[248:249] op_sel:[0,1,0] op_sel_hi:[1,1,0]
    v_pk_fma_f32 v[208:209], v[96:97], v[248:249], v[216:217] op_sel:[0,1,0] op_sel_hi:[1,1,0]
    v_pk_fma_f32 v[210:211], v[98:99], v[248:249], v[216:217] op_sel:[0,1,0] op_sel_hi:[1,1,0]
    v_pk_fma_f32 v[212:213], v[100:101], v[248:249], v[216:217] op_sel:[0,1,0] op_sel_hi:[1,1,0]
    v_pk_fma_f32 v[214:215], v[102:103], v[248:249], v[216:217] op_sel:[0,1,0] op_sel_hi:[1,1,0]
    v_exp_f32 v208, v208 clamp
    v_exp_f32 v209, v209 clamp
    v_exp_f32 v210, v210 clamp
    v_exp_f32 v211, v211 clamp
    v_exp_f32 v212, v212 clamp
    v_exp_f32 v213, v213 clamp
    v_exp_f32 v214, v214 clamp
    v_exp_f32 v215, v215 clamp
    v_max_f32 v96, v248, v96
    v_max_f32 v97, v248, v97
    v_max_f32 v98, v248, v98
    v_max_f32 v99, v248, v99
    v_max_f32 v100, v248, v100
    v_max_f32 v101, v248, v101
    v_max_f32 v102, v248, v102
    v_max_f32 v103, v248, v103
    v_pk_add_f32 v[208:209], v[208:209], v[96:97]
    v_pk_add_f32 v[210:211], v[210:211], v[98:99]
    v_pk_add_f32 v[212:213], v[212:213], v[100:101]
    v_pk_add_f32 v[214:215], v[214:215], v[102:103]
    v_cvt_pk_bf16_f32 v96, v208, v209
    v_cvt_pk_bf16_f32 v97, v210, v211
    v_cvt_pk_bf16_f32 v98, v212, v213
    v_cvt_pk_bf16_f32 v99, v214, v215
    v_pk_fma_f32 v[104:105], v[184:185], v[244:245], v[104:105] op_sel_hi:[1,0,1]
    v_pk_fma_f32 v[106:107], v[186:187], v[244:245], v[106:107] op_sel_hi:[1,0,1]
    v_pk_fma_f32 v[108:109], v[188:189], v[244:245], v[108:109] op_sel_hi:[1,0,1]
    v_pk_fma_f32 v[110:111], v[190:191], v[244:245], v[110:111] op_sel_hi:[1,0,1]
    v_pk_fma_f32 v[104:105], v[104:105], v[244:245], v[248:249] op_sel:[0,1,0] op_sel_hi:[1,1,0]
    v_pk_fma_f32 v[106:107], v[106:107], v[244:245], v[248:249] op_sel:[0,1,0] op_sel_hi:[1,1,0]
    v_pk_fma_f32 v[108:109], v[108:109], v[244:245], v[248:249] op_sel:[0,1,0] op_sel_hi:[1,1,0]
    v_pk_fma_f32 v[110:111], v[110:111], v[244:245], v[248:249] op_sel:[0,1,0] op_sel_hi:[1,1,0]
    v_pk_fma_f32 v[208:209], v[104:105], v[248:249], v[216:217] op_sel:[0,1,0] op_sel_hi:[1,1,0]
    v_pk_fma_f32 v[210:211], v[106:107], v[248:249], v[216:217] op_sel:[0,1,0] op_sel_hi:[1,1,0]
    v_pk_fma_f32 v[212:213], v[108:109], v[248:249], v[216:217] op_sel:[0,1,0] op_sel_hi:[1,1,0]
    v_pk_fma_f32 v[214:215], v[110:111], v[248:249], v[216:217] op_sel:[0,1,0] op_sel_hi:[1,1,0]
    v_exp_f32 v208, v208 clamp
    v_exp_f32 v209, v209 clamp
    v_exp_f32 v210, v210 clamp
    v_exp_f32 v211, v211 clamp
    v_exp_f32 v212, v212 clamp
    v_exp_f32 v213, v213 clamp
    v_exp_f32 v214, v214 clamp
    v_exp_f32 v215, v215 clamp
    v_max_f32 v104, v248, v104
    v_max_f32 v105, v248, v105
    v_max_f32 v106, v248, v106
    v_max_f32 v107, v248, v107
    v_max_f32 v108, v248, v108
    v_max_f32 v109, v248, v109
    v_max_f32 v110, v248, v110
    v_max_f32 v111, v248, v111
    v_pk_add_f32 v[208:209], v[208:209], v[104:105]
    v_pk_add_f32 v[210:211], v[210:211], v[106:107]
    v_pk_add_f32 v[212:213], v[212:213], v[108:109]
    v_pk_add_f32 v[214:215], v[214:215], v[110:111]
    v_cvt_pk_bf16_f32 v104, v208, v209
    v_cvt_pk_bf16_f32 v105, v210, v211
    v_cvt_pk_bf16_f32 v106, v212, v213
    v_cvt_pk_bf16_f32 v107, v214, v215
    v_pk_fma_f32 v[112:113], v[192:193], v[244:245], v[112:113] op_sel_hi:[1,0,1]
    v_pk_fma_f32 v[114:115], v[194:195], v[244:245], v[114:115] op_sel_hi:[1,0,1]
    v_pk_fma_f32 v[116:117], v[196:197], v[244:245], v[116:117] op_sel_hi:[1,0,1]
    v_pk_fma_f32 v[118:119], v[198:199], v[244:245], v[118:119] op_sel_hi:[1,0,1]
    v_pk_fma_f32 v[112:113], v[112:113], v[244:245], v[248:249] op_sel:[0,1,0] op_sel_hi:[1,1,0]
    v_pk_fma_f32 v[114:115], v[114:115], v[244:245], v[248:249] op_sel:[0,1,0] op_sel_hi:[1,1,0]
    v_pk_fma_f32 v[116:117], v[116:117], v[244:245], v[248:249] op_sel:[0,1,0] op_sel_hi:[1,1,0]
    v_pk_fma_f32 v[118:119], v[118:119], v[244:245], v[248:249] op_sel:[0,1,0] op_sel_hi:[1,1,0]
    v_pk_fma_f32 v[208:209], v[112:113], v[248:249], v[216:217] op_sel:[0,1,0] op_sel_hi:[1,1,0]
    v_pk_fma_f32 v[210:211], v[114:115], v[248:249], v[216:217] op_sel:[0,1,0] op_sel_hi:[1,1,0]
    v_pk_fma_f32 v[212:213], v[116:117], v[248:249], v[216:217] op_sel:[0,1,0] op_sel_hi:[1,1,0]
    v_pk_fma_f32 v[214:215], v[118:119], v[248:249], v[216:217] op_sel:[0,1,0] op_sel_hi:[1,1,0]
    v_exp_f32 v208, v208 clamp
    v_exp_f32 v209, v209 clamp
    v_exp_f32 v210, v210 clamp
    v_exp_f32 v211, v211 clamp
    v_exp_f32 v212, v212 clamp
    v_exp_f32 v213, v213 clamp
    v_exp_f32 v214, v214 clamp
    v_exp_f32 v215, v215 clamp
    v_max_f32 v112, v248, v112
    v_max_f32 v113, v248, v113
    v_max_f32 v114, v248, v114
    v_max_f32 v115, v248, v115
    v_max_f32 v116, v248, v116
    v_max_f32 v117, v248, v117
    v_max_f32 v118, v248, v118
    v_max_f32 v119, v248, v119
    v_pk_add_f32 v[208:209], v[208:209], v[112:113]
    v_pk_add_f32 v[210:211], v[210:211], v[114:115]
    v_pk_add_f32 v[212:213], v[212:213], v[116:117]
    v_pk_add_f32 v[214:215], v[214:215], v[118:119]
    v_cvt_pk_bf16_f32 v112, v208, v209
    v_cvt_pk_bf16_f32 v113, v210, v211
    v_cvt_pk_bf16_f32 v114, v212, v213
    v_cvt_pk_bf16_f32 v115, v214, v215
    v_pk_fma_f32 v[120:121], v[200:201], v[244:245], v[120:121] op_sel_hi:[1,0,1]
    v_pk_fma_f32 v[122:123], v[202:203], v[244:245], v[122:123] op_sel_hi:[1,0,1]
    v_pk_fma_f32 v[124:125], v[204:205], v[244:245], v[124:125] op_sel_hi:[1,0,1]
    v_pk_fma_f32 v[126:127], v[206:207], v[244:245], v[126:127] op_sel_hi:[1,0,1]
    v_pk_fma_f32 v[120:121], v[120:121], v[244:245], v[248:249] op_sel:[0,1,0] op_sel_hi:[1,1,0]
    v_pk_fma_f32 v[122:123], v[122:123], v[244:245], v[248:249] op_sel:[0,1,0] op_sel_hi:[1,1,0]
    v_pk_fma_f32 v[124:125], v[124:125], v[244:245], v[248:249] op_sel:[0,1,0] op_sel_hi:[1,1,0]
    v_pk_fma_f32 v[126:127], v[126:127], v[244:245], v[248:249] op_sel:[0,1,0] op_sel_hi:[1,1,0]
    v_pk_fma_f32 v[208:209], v[120:121], v[248:249], v[216:217] op_sel:[0,1,0] op_sel_hi:[1,1,0]
    v_pk_fma_f32 v[210:211], v[122:123], v[248:249], v[216:217] op_sel:[0,1,0] op_sel_hi:[1,1,0]
    v_pk_fma_f32 v[212:213], v[124:125], v[248:249], v[216:217] op_sel:[0,1,0] op_sel_hi:[1,1,0]
    v_pk_fma_f32 v[214:215], v[126:127], v[248:249], v[216:217] op_sel:[0,1,0] op_sel_hi:[1,1,0]
    v_exp_f32 v208, v208 clamp
    v_exp_f32 v209, v209 clamp
    v_exp_f32 v210, v210 clamp
    v_exp_f32 v211, v211 clamp
    v_exp_f32 v212, v212 clamp
    v_exp_f32 v213, v213 clamp
    v_exp_f32 v214, v214 clamp
    v_exp_f32 v215, v215 clamp
    v_max_f32 v120, v248, v120
    v_max_f32 v121, v248, v121
    v_max_f32 v122, v248, v122
    v_max_f32 v123, v248, v123
    v_max_f32 v124, v248, v124
    v_max_f32 v125, v248, v125
    v_max_f32 v126, v248, v126
    v_max_f32 v127, v248, v127
    v_pk_add_f32 v[208:209], v[208:209], v[120:121]
    v_pk_add_f32 v[210:211], v[210:211], v[122:123]
    v_pk_add_f32 v[212:213], v[212:213], v[124:125]
    v_pk_add_f32 v[214:215], v[214:215], v[126:127]
    v_cvt_pk_bf16_f32 v120, v208, v209
    v_cvt_pk_bf16_f32 v121, v210, v211
    v_cvt_pk_bf16_f32 v122, v212, v213
    v_cvt_pk_bf16_f32 v123, v214, v215
    v_pk_fma_f32 v[128:129], v[168:169], v[246:247], v[128:129] op_sel_hi:[1,0,1]
    v_pk_fma_f32 v[130:131], v[170:171], v[246:247], v[130:131] op_sel_hi:[1,0,1]
    v_pk_fma_f32 v[132:133], v[172:173], v[246:247], v[132:133] op_sel_hi:[1,0,1]
    v_pk_fma_f32 v[134:135], v[174:175], v[246:247], v[134:135] op_sel_hi:[1,0,1]
    v_pk_fma_f32 v[128:129], v[128:129], v[246:247], v[248:249] op_sel:[0,1,0] op_sel_hi:[1,1,0]
    v_pk_fma_f32 v[130:131], v[130:131], v[246:247], v[248:249] op_sel:[0,1,0] op_sel_hi:[1,1,0]
    v_pk_fma_f32 v[132:133], v[132:133], v[246:247], v[248:249] op_sel:[0,1,0] op_sel_hi:[1,1,0]
    v_pk_fma_f32 v[134:135], v[134:135], v[246:247], v[248:249] op_sel:[0,1,0] op_sel_hi:[1,1,0]
    v_pk_fma_f32 v[208:209], v[128:129], v[248:249], v[216:217] op_sel:[0,1,0] op_sel_hi:[1,1,0]
    v_pk_fma_f32 v[210:211], v[130:131], v[248:249], v[216:217] op_sel:[0,1,0] op_sel_hi:[1,1,0]
    v_pk_fma_f32 v[212:213], v[132:133], v[248:249], v[216:217] op_sel:[0,1,0] op_sel_hi:[1,1,0]
    v_pk_fma_f32 v[214:215], v[134:135], v[248:249], v[216:217] op_sel:[0,1,0] op_sel_hi:[1,1,0]
    v_exp_f32 v208, v208 clamp
    v_exp_f32 v209, v209 clamp
    v_exp_f32 v210, v210 clamp
    v_exp_f32 v211, v211 clamp
    v_exp_f32 v212, v212 clamp
    v_exp_f32 v213, v213 clamp
    v_exp_f32 v214, v214 clamp
    v_exp_f32 v215, v215 clamp
    v_max_f32 v128, v248, v128
    v_max_f32 v129, v248, v129
    v_max_f32 v130, v248, v130
    v_max_f32 v131, v248, v131
    v_max_f32 v132, v248, v132
    v_max_f32 v133, v248, v133
    v_max_f32 v134, v248, v134
    v_max_f32 v135, v248, v135
    v_pk_add_f32 v[208:209], v[208:209], v[128:129]
    v_pk_add_f32 v[210:211], v[210:211], v[130:131]
    v_pk_add_f32 v[212:213], v[212:213], v[132:133]
    v_pk_add_f32 v[214:215], v[214:215], v[134:135]
    v_cvt_pk_bf16_f32 v128, v208, v209
    v_cvt_pk_bf16_f32 v129, v210, v211
    v_cvt_pk_bf16_f32 v130, v212, v213
    v_cvt_pk_bf16_f32 v131, v214, v215
    v_pk_fma_f32 v[136:137], v[176:177], v[246:247], v[136:137] op_sel_hi:[1,0,1]
    v_pk_fma_f32 v[138:139], v[178:179], v[246:247], v[138:139] op_sel_hi:[1,0,1]
    v_pk_fma_f32 v[140:141], v[180:181], v[246:247], v[140:141] op_sel_hi:[1,0,1]
    v_pk_fma_f32 v[142:143], v[182:183], v[246:247], v[142:143] op_sel_hi:[1,0,1]
    v_pk_fma_f32 v[136:137], v[136:137], v[246:247], v[248:249] op_sel:[0,1,0] op_sel_hi:[1,1,0]
    v_pk_fma_f32 v[138:139], v[138:139], v[246:247], v[248:249] op_sel:[0,1,0] op_sel_hi:[1,1,0]
    v_pk_fma_f32 v[140:141], v[140:141], v[246:247], v[248:249] op_sel:[0,1,0] op_sel_hi:[1,1,0]
    v_pk_fma_f32 v[142:143], v[142:143], v[246:247], v[248:249] op_sel:[0,1,0] op_sel_hi:[1,1,0]
    v_pk_fma_f32 v[208:209], v[136:137], v[248:249], v[216:217] op_sel:[0,1,0] op_sel_hi:[1,1,0]
    v_pk_fma_f32 v[210:211], v[138:139], v[248:249], v[216:217] op_sel:[0,1,0] op_sel_hi:[1,1,0]
    v_pk_fma_f32 v[212:213], v[140:141], v[248:249], v[216:217] op_sel:[0,1,0] op_sel_hi:[1,1,0]
    v_pk_fma_f32 v[214:215], v[142:143], v[248:249], v[216:217] op_sel:[0,1,0] op_sel_hi:[1,1,0]
    v_exp_f32 v208, v208 clamp
    v_exp_f32 v209, v209 clamp
    v_exp_f32 v210, v210 clamp
    v_exp_f32 v211, v211 clamp
    v_exp_f32 v212, v212 clamp
    v_exp_f32 v213, v213 clamp
    v_exp_f32 v214, v214 clamp
    v_exp_f32 v215, v215 clamp
    v_max_f32 v136, v248, v136
    v_max_f32 v137, v248, v137
    v_max_f32 v138, v248, v138
    v_max_f32 v139, v248, v139
    v_max_f32 v140, v248, v140
    v_max_f32 v141, v248, v141
    v_max_f32 v142, v248, v142
    v_max_f32 v143, v248, v143
    v_pk_add_f32 v[208:209], v[208:209], v[136:137]
    v_pk_add_f32 v[210:211], v[210:211], v[138:139]
    v_pk_add_f32 v[212:213], v[212:213], v[140:141]
    v_pk_add_f32 v[214:215], v[214:215], v[142:143]
    v_cvt_pk_bf16_f32 v136, v208, v209
    v_cvt_pk_bf16_f32 v137, v210, v211
    v_cvt_pk_bf16_f32 v138, v212, v213
    v_cvt_pk_bf16_f32 v139, v214, v215
    v_pk_fma_f32 v[144:145], v[184:185], v[246:247], v[144:145] op_sel_hi:[1,0,1]
    v_pk_fma_f32 v[146:147], v[186:187], v[246:247], v[146:147] op_sel_hi:[1,0,1]
    v_pk_fma_f32 v[148:149], v[188:189], v[246:247], v[148:149] op_sel_hi:[1,0,1]
    v_pk_fma_f32 v[150:151], v[190:191], v[246:247], v[150:151] op_sel_hi:[1,0,1]
    v_pk_fma_f32 v[144:145], v[144:145], v[246:247], v[248:249] op_sel:[0,1,0] op_sel_hi:[1,1,0]
    v_pk_fma_f32 v[146:147], v[146:147], v[246:247], v[248:249] op_sel:[0,1,0] op_sel_hi:[1,1,0]
    v_pk_fma_f32 v[148:149], v[148:149], v[246:247], v[248:249] op_sel:[0,1,0] op_sel_hi:[1,1,0]
    v_pk_fma_f32 v[150:151], v[150:151], v[246:247], v[248:249] op_sel:[0,1,0] op_sel_hi:[1,1,0]
    v_pk_fma_f32 v[208:209], v[144:145], v[248:249], v[216:217] op_sel:[0,1,0] op_sel_hi:[1,1,0]
    v_pk_fma_f32 v[210:211], v[146:147], v[248:249], v[216:217] op_sel:[0,1,0] op_sel_hi:[1,1,0]
    v_pk_fma_f32 v[212:213], v[148:149], v[248:249], v[216:217] op_sel:[0,1,0] op_sel_hi:[1,1,0]
    v_pk_fma_f32 v[214:215], v[150:151], v[248:249], v[216:217] op_sel:[0,1,0] op_sel_hi:[1,1,0]
    v_exp_f32 v208, v208 clamp
    v_exp_f32 v209, v209 clamp
    v_exp_f32 v210, v210 clamp
    v_exp_f32 v211, v211 clamp
    v_exp_f32 v212, v212 clamp
    v_exp_f32 v213, v213 clamp
    v_exp_f32 v214, v214 clamp
    v_exp_f32 v215, v215 clamp
    v_max_f32 v144, v248, v144
    v_max_f32 v145, v248, v145
    v_max_f32 v146, v248, v146
    v_max_f32 v147, v248, v147
    v_max_f32 v148, v248, v148
    v_max_f32 v149, v248, v149
    v_max_f32 v150, v248, v150
    v_max_f32 v151, v248, v151
    v_pk_add_f32 v[208:209], v[208:209], v[144:145]
    v_pk_add_f32 v[210:211], v[210:211], v[146:147]
    v_pk_add_f32 v[212:213], v[212:213], v[148:149]
    v_pk_add_f32 v[214:215], v[214:215], v[150:151]
    v_cvt_pk_bf16_f32 v144, v208, v209
    v_cvt_pk_bf16_f32 v145, v210, v211
    v_cvt_pk_bf16_f32 v146, v212, v213
    v_cvt_pk_bf16_f32 v147, v214, v215
    v_pk_fma_f32 v[152:153], v[192:193], v[246:247], v[152:153] op_sel_hi:[1,0,1]
    v_pk_fma_f32 v[154:155], v[194:195], v[246:247], v[154:155] op_sel_hi:[1,0,1]
    v_pk_fma_f32 v[156:157], v[196:197], v[246:247], v[156:157] op_sel_hi:[1,0,1]
    v_pk_fma_f32 v[158:159], v[198:199], v[246:247], v[158:159] op_sel_hi:[1,0,1]
    v_pk_fma_f32 v[152:153], v[152:153], v[246:247], v[248:249] op_sel:[0,1,0] op_sel_hi:[1,1,0]
    v_pk_fma_f32 v[154:155], v[154:155], v[246:247], v[248:249] op_sel:[0,1,0] op_sel_hi:[1,1,0]
    v_pk_fma_f32 v[156:157], v[156:157], v[246:247], v[248:249] op_sel:[0,1,0] op_sel_hi:[1,1,0]
    v_pk_fma_f32 v[158:159], v[158:159], v[246:247], v[248:249] op_sel:[0,1,0] op_sel_hi:[1,1,0]
    v_pk_fma_f32 v[208:209], v[152:153], v[248:249], v[216:217] op_sel:[0,1,0] op_sel_hi:[1,1,0]
    v_pk_fma_f32 v[210:211], v[154:155], v[248:249], v[216:217] op_sel:[0,1,0] op_sel_hi:[1,1,0]
    v_pk_fma_f32 v[212:213], v[156:157], v[248:249], v[216:217] op_sel:[0,1,0] op_sel_hi:[1,1,0]
    v_pk_fma_f32 v[214:215], v[158:159], v[248:249], v[216:217] op_sel:[0,1,0] op_sel_hi:[1,1,0]
    v_exp_f32 v208, v208 clamp
    v_exp_f32 v209, v209 clamp
    v_exp_f32 v210, v210 clamp
    v_exp_f32 v211, v211 clamp
    v_exp_f32 v212, v212 clamp
    v_exp_f32 v213, v213 clamp
    v_exp_f32 v214, v214 clamp
    v_exp_f32 v215, v215 clamp
    v_max_f32 v152, v248, v152
    v_max_f32 v153, v248, v153
    v_max_f32 v154, v248, v154
    v_max_f32 v155, v248, v155
    v_max_f32 v156, v248, v156
    v_max_f32 v157, v248, v157
    v_max_f32 v158, v248, v158
    v_max_f32 v159, v248, v159
    v_pk_add_f32 v[208:209], v[208:209], v[152:153]
    v_pk_add_f32 v[210:211], v[210:211], v[154:155]
    v_pk_add_f32 v[212:213], v[212:213], v[156:157]
    v_pk_add_f32 v[214:215], v[214:215], v[158:159]
    v_cvt_pk_bf16_f32 v152, v208, v209
    v_cvt_pk_bf16_f32 v153, v210, v211
    v_cvt_pk_bf16_f32 v154, v212, v213
    v_cvt_pk_bf16_f32 v155, v214, v215
    v_pk_fma_f32 v[160:161], v[200:201], v[246:247], v[160:161] op_sel_hi:[1,0,1]
    v_pk_fma_f32 v[162:163], v[202:203], v[246:247], v[162:163] op_sel_hi:[1,0,1]
    v_pk_fma_f32 v[164:165], v[204:205], v[246:247], v[164:165] op_sel_hi:[1,0,1]
    v_pk_fma_f32 v[166:167], v[206:207], v[246:247], v[166:167] op_sel_hi:[1,0,1]
    v_pk_fma_f32 v[160:161], v[160:161], v[246:247], v[248:249] op_sel:[0,1,0] op_sel_hi:[1,1,0]
    v_pk_fma_f32 v[162:163], v[162:163], v[246:247], v[248:249] op_sel:[0,1,0] op_sel_hi:[1,1,0]
    v_pk_fma_f32 v[164:165], v[164:165], v[246:247], v[248:249] op_sel:[0,1,0] op_sel_hi:[1,1,0]
    v_pk_fma_f32 v[166:167], v[166:167], v[246:247], v[248:249] op_sel:[0,1,0] op_sel_hi:[1,1,0]
    v_pk_fma_f32 v[208:209], v[160:161], v[248:249], v[216:217] op_sel:[0,1,0] op_sel_hi:[1,1,0]
    v_pk_fma_f32 v[210:211], v[162:163], v[248:249], v[216:217] op_sel:[0,1,0] op_sel_hi:[1,1,0]
    v_pk_fma_f32 v[212:213], v[164:165], v[248:249], v[216:217] op_sel:[0,1,0] op_sel_hi:[1,1,0]
    v_pk_fma_f32 v[214:215], v[166:167], v[248:249], v[216:217] op_sel:[0,1,0] op_sel_hi:[1,1,0]
    v_exp_f32 v208, v208 clamp
    v_exp_f32 v209, v209 clamp
    v_exp_f32 v210, v210 clamp
    v_exp_f32 v211, v211 clamp
    v_exp_f32 v212, v212 clamp
    v_exp_f32 v213, v213 clamp
    v_exp_f32 v214, v214 clamp
    v_exp_f32 v215, v215 clamp
    v_max_f32 v160, v248, v160
    v_max_f32 v161, v248, v161
    v_max_f32 v162, v248, v162
    v_max_f32 v163, v248, v163
    v_max_f32 v164, v248, v164
    v_max_f32 v165, v248, v165
    v_max_f32 v166, v248, v166
    v_max_f32 v167, v248, v167
    v_pk_add_f32 v[208:209], v[208:209], v[160:161]
    v_pk_add_f32 v[210:211], v[210:211], v[162:163]
    v_pk_add_f32 v[212:213], v[212:213], v[164:165]
    v_pk_add_f32 v[214:215], v[214:215], v[166:167]
    v_cvt_pk_bf16_f32 v160, v208, v209
    v_cvt_pk_bf16_f32 v161, v210, v211
    v_cvt_pk_bf16_f32 v162, v212, v213
    v_cvt_pk_bf16_f32 v163, v214, v215
    v_mov_b32 v168, 0x358637bd
    v_lshlrev_b32 v3, 4, v0
    v_add_u32 v1, 53248, v3
    v_lshrrev_b32 v2, 4, v0
    v_cmp_lt_u32 s[76:77], 0, v2
    v_cmp_lt_u32 s[78:79], 1, v2
    v_cmp_lt_u32 s[80:81], 2, v2
    s_lshr_b32 s72, s58, 4
    s_lshl2_add_u32 s72, s56, s72
    s_mul_i32 s72, s72, 74
    s_add_u32 s72, s72, s59
    s_add_u32 s72, s72, 54
    s_lshl_b32 s74, s72, 10
    s_add_u32 s75, s74, 75776
    s_add_u32 s82, s75, 75776
    s_add_u32 s83, s82, 75776
    s_lshl2_add_u32 s72, s62, s59
    s_lshl_b32 s72, s72, 10
    s_add_u32 s72, s72, 294912
    s_barrier
    ds_read_b128 v[228:231], v1 offset:20480
    ds_read_b128 v[232:235], v1 offset:21504
    ds_read_b128 v[236:239], v1 offset:22528
    ds_read_b128 v[172:175], v1 offset:0
    ds_read_b128 v[180:183], v1 offset:2048
    ds_read_b128 v[184:187], v1 offset:3072
    ds_read_b128 v[240:243], v1 offset:23552
    ds_read_b128 v[244:247], v1 offset:24576
    ds_read_b128 v[4:7], v1 offset:25600
    ds_read_b128 v[188:191], v1 offset:4096
    ds_read_b128 v[192:195], v1 offset:5120
    ds_read_b128 v[200:203], v1 offset:7168
    ds_read_b128 v[196:199], v1 offset:6144
    s_waitcnt lgkmcnt(12)
    v_mfma_f32_16x16x32_bf16 v[12:15], v[228:231], v[8:11], 0
    v_mfma_f32_16x16x32_bf16 v[28:31], v[228:231], v[48:51], 0
    v_mfma_f32_16x16x32_bf16 v[44:47], v[228:231], v[88:91], 0
    v_mfma_f32_16x16x32_bf16 v[60:63], v[228:231], v[128:131], 0
    s_waitcnt lgkmcnt(11)
    v_mfma_f32_16x16x32_bf16 v[12:15], v[232:235], v[16:19], v[12:15]
    v_mfma_f32_16x16x32_bf16 v[28:31], v[232:235], v[56:59], v[28:31]
    v_mfma_f32_16x16x32_bf16 v[44:47], v[232:235], v[96:99], v[44:47]
    v_mfma_f32_16x16x32_bf16 v[60:63], v[232:235], v[136:139], v[60:63]
    s_waitcnt lgkmcnt(10)
    v_mfma_f32_16x16x32_bf16 v[12:15], v[236:239], v[24:27], v[12:15]
    v_mfma_f32_16x16x32_bf16 v[28:31], v[236:239], v[64:67], v[28:31]
    v_mfma_f32_16x16x32_bf16 v[44:47], v[236:239], v[104:107], v[44:47]
    v_mfma_f32_16x16x32_bf16 v[60:63], v[236:239], v[144:147], v[60:63]
    s_waitcnt lgkmcnt(7)
    v_mfma_f32_16x16x32_bf16 v[76:79], v[172:175], v[8:11], 0
    v_mfma_f32_16x16x32_bf16 v[84:87], v[180:183], v[8:11], 0
    v_mfma_f32_16x16x32_bf16 v[92:95], v[172:175], v[48:51], 0
    v_mfma_f32_16x16x32_bf16 v[100:103], v[180:183], v[48:51], 0
    v_mfma_f32_16x16x32_bf16 v[108:111], v[172:175], v[88:91], 0
    v_add_f32 v12, v168, v12
    v_add_f32 v13, v168, v13
    v_add_f32 v14, v168, v14
    v_add_f32 v15, v168, v15
    v_mfma_f32_16x16x32_bf16 v[116:119], v[180:183], v[88:91], 0
    v_rcp_f32 v12, v12
    v_rcp_f32 v13, v13
    v_rcp_f32 v14, v14
    v_rcp_f32 v15, v15
    v_mfma_f32_16x16x32_bf16 v[124:127], v[172:175], v[128:131], 0
    v_add_f32 v28, v168, v28
    v_add_f32 v29, v168, v29
    v_add_f32 v30, v168, v30
    v_add_f32 v31, v168, v31
    v_mfma_f32_16x16x32_bf16 v[132:135], v[180:183], v[128:131], 0
    v_rcp_f32 v28, v28
    v_rcp_f32 v29, v29
    v_rcp_f32 v30, v30
    v_rcp_f32 v31, v31
    v_mfma_f32_16x16x32_bf16 v[84:87], v[184:187], v[16:19], v[84:87]
    v_add_f32 v44, v168, v44
    v_add_f32 v45, v168, v45
    v_add_f32 v46, v168, v46
    v_add_f32 v47, v168, v47
    v_mfma_f32_16x16x32_bf16 v[100:103], v[184:187], v[56:59], v[100:103]
    v_rcp_f32 v44, v44
    v_rcp_f32 v45, v45
    v_rcp_f32 v46, v46
    v_rcp_f32 v47, v47
    v_mfma_f32_16x16x32_bf16 v[116:119], v[184:187], v[96:99], v[116:119]
    v_add_f32 v60, v168, v60
    v_add_f32 v61, v168, v61
    v_add_f32 v62, v168, v62
    v_add_f32 v63, v168, v63
    v_mfma_f32_16x16x32_bf16 v[132:135], v[184:187], v[136:139], v[132:135]
    v_rcp_f32 v60, v60
    v_rcp_f32 v61, v61
    v_rcp_f32 v62, v62
    v_rcp_f32 v63, v63
    s_waitcnt lgkmcnt(0)
    ds_read_b128 v[176:179], v1 offset:9216
    ds_read_b128 v[172:175], v1 offset:8192
    ds_read_b128 v[180:183], v1 offset:10240
    ds_read_b128 v[184:187], v1 offset:11264
    v_mfma_f32_16x16x32_bf16 v[140:143], v[188:191], v[8:11], 0
    v_mul_f32 v76, v12, v76
    v_mul_f32 v77, v12, v77
    v_mul_f32 v78, v12, v78
    v_mfma_f32_16x16x32_bf16 v[148:151], v[200:203], v[16:19], 0
    v_mul_f32 v79, v12, v79
    v_cvt_pk_bf16_f32 v204, v76, v77
    v_cvt_pk_bf16_f32 v205, v78, v79
    v_mfma_f32_16x16x32_bf16 v[156:159], v[188:191], v[48:51], 0
    v_cndmask_b32 v169, v12, v13, s[76:77]
    v_mul_f32 v84, v169, v84
    v_mul_f32 v85, v169, v85
    v_mfma_f32_16x16x32_bf16 v[164:167], v[200:203], v[56:59], 0
    v_mul_f32 v86, v169, v86
    v_mul_f32 v87, v169, v87
    v_cvt_pk_bf16_f32 v206, v84, v85
    v_mfma_f32_16x16x32_bf16 v[212:215], v[188:191], v[88:91], 0
    v_cvt_pk_bf16_f32 v207, v86, v87
    buffer_store_dwordx4 v[204:207], v3, s[32:35], s74 offen sc1
L_pad_7:
    s_cbranch_execz L_padret_Q
    v_mul_f32 v92, v28, v92
    v_mfma_f32_16x16x32_bf16 v[216:219], v[200:203], v[96:99], 0
    v_mul_f32 v93, v28, v93
    v_mul_f32 v94, v28, v94
    v_mul_f32 v95, v28, v95
    v_mfma_f32_16x16x32_bf16 v[220:223], v[188:191], v[128:131], 0
    v_cvt_pk_bf16_f32 v208, v92, v93
    v_cvt_pk_bf16_f32 v209, v94, v95
    v_cndmask_b32 v169, v28, v29, s[76:77]
    v_mfma_f32_16x16x32_bf16 v[224:227], v[200:203], v[136:139], 0
    v_mul_f32 v100, v169, v100
    v_mul_f32 v101, v169, v101
    v_mul_f32 v102, v169, v102
    v_mfma_f32_16x16x32_bf16 v[140:143], v[192:195], v[16:19], v[140:143]
    v_mul_f32 v103, v169, v103
    v_cvt_pk_bf16_f32 v210, v100, v101
    v_cvt_pk_bf16_f32 v211, v102, v103
    v_mfma_f32_16x16x32_bf16 v[148:151], v[196:199], v[24:27], v[148:151]
    buffer_store_dwordx4 v[208:211], v3, s[32:35], s75 offen sc1
    v_mul_f32 v108, v44, v108
    v_mul_f32 v109, v44, v109
    v_mfma_f32_16x16x32_bf16 v[156:159], v[192:195], v[56:59], v[156:159]
    v_mul_f32 v110, v44, v110
    v_mul_f32 v111, v44, v111
    v_cvt_pk_bf16_f32 v204, v108, v109
    v_mfma_f32_16x16x32_bf16 v[164:167], v[196:199], v[64:67], v[164:167]
    v_cvt_pk_bf16_f32 v205, v110, v111
    v_cndmask_b32 v169, v44, v45, s[76:77]
    v_mul_f32 v116, v169, v116
    v_mfma_f32_16x16x32_bf16 v[212:215], v[192:195], v[96:99], v[212:215]
    v_mul_f32 v117, v169, v117
    v_mul_f32 v118, v169, v118
    v_mul_f32 v119, v169, v119
    v_mfma_f32_16x16x32_bf16 v[216:219], v[196:199], v[104:107], v[216:219]
    v_cvt_pk_bf16_f32 v206, v116, v117
    v_cvt_pk_bf16_f32 v207, v118, v119
    buffer_store_dwordx4 v[204:207], v3, s[32:35], s82 offen sc1
    v_mfma_f32_16x16x32_bf16 v[220:223], v[192:195], v[136:139], v[220:223]
    v_mul_f32 v124, v60, v124
    v_mul_f32 v125, v60, v125
    v_mul_f32 v126, v60, v126
    v_mfma_f32_16x16x32_bf16 v[224:227], v[196:199], v[144:147], v[224:227]
    v_mul_f32 v127, v60, v127
    v_cvt_pk_bf16_f32 v208, v124, v125
    v_cvt_pk_bf16_f32 v209, v126, v127
    v_cndmask_b32 v169, v60, v61, s[76:77]
    v_mul_f32 v132, v169, v132
    v_mul_f32 v133, v169, v133
    v_mul_f32 v134, v169, v134
    v_mul_f32 v135, v169, v135
    v_cvt_pk_bf16_f32 v210, v132, v133
    v_cvt_pk_bf16_f32 v211, v134, v135
    buffer_store_dwordx4 v[208:211], v3, s[32:35], s83 offen sc1
    v_add_u32 v3, 4096, v3
    s_waitcnt lgkmcnt(0)
    ds_read_b128 v[188:191], v1 offset:12288
    ds_read_b128 v[192:195], v1 offset:13312
    ds_read_b128 v[200:203], v1 offset:15360
    ds_read_b128 v[196:199], v1 offset:14336
    v_mfma_f32_16x16x32_bf16 v[20:23], v[240:243], v[24:27], 0
    v_cndmask_b32 v169, v13, v14, s[78:79]
    v_mul_f32 v140, v169, v140
    v_mul_f32 v141, v169, v141
    v_mfma_f32_16x16x32_bf16 v[36:39], v[240:243], v[64:67], 0
    v_mul_f32 v142, v169, v142
    v_mul_f32 v143, v169, v143
    v_cvt_pk_bf16_f32 v204, v140, v141
    v_mfma_f32_16x16x32_bf16 v[52:55], v[240:243], v[104:107], 0
    v_cvt_pk_bf16_f32 v205, v142, v143
    v_cndmask_b32 v169, v14, v15, s[80:81]
    v_mul_f32 v148, v169, v148
    v_mfma_f32_16x16x32_bf16 v[68:71], v[240:243], v[144:147], 0
    v_mul_f32 v149, v169, v149
    v_mul_f32 v150, v169, v150
    v_mul_f32 v151, v169, v151
    v_mfma_f32_16x16x32_bf16 v[20:23], v[244:247], v[32:35], v[20:23]
    v_cvt_pk_bf16_f32 v206, v148, v149
    v_cvt_pk_bf16_f32 v207, v150, v151
    buffer_store_dwordx4 v[204:207], v3, s[32:35], s74 offen sc1
    v_mfma_f32_16x16x32_bf16 v[36:39], v[244:247], v[72:75], v[36:39]
    v_cndmask_b32 v169, v29, v30, s[78:79]
    v_mul_f32 v156, v169, v156
    v_mul_f32 v157, v169, v157
    v_mfma_f32_16x16x32_bf16 v[52:55], v[244:247], v[112:115], v[52:55]
    v_mul_f32 v158, v169, v158
    v_mul_f32 v159, v169, v159
    v_cvt_pk_bf16_f32 v208, v156, v157
    v_mfma_f32_16x16x32_bf16 v[68:71], v[244:247], v[152:155], v[68:71]
    v_cvt_pk_bf16_f32 v209, v158, v159
    v_cndmask_b32 v169, v30, v31, s[80:81]
    v_mul_f32 v164, v169, v164
    v_mfma_f32_16x16x32_bf16 v[20:23], v[4:7], v[40:43], v[20:23]
    v_mul_f32 v165, v169, v165
    v_mul_f32 v166, v169, v166
    v_mul_f32 v167, v169, v167
    v_mfma_f32_16x16x32_bf16 v[36:39], v[4:7], v[80:83], v[36:39]
    v_cvt_pk_bf16_f32 v210, v164, v165
    v_cvt_pk_bf16_f32 v211, v166, v167
    buffer_store_dwordx4 v[208:211], v3, s[32:35], s75 offen sc1
    v_mfma_f32_16x16x32_bf16 v[52:55], v[4:7], v[120:123], v[52:55]
    v_cndmask_b32 v169, v45, v46, s[78:79]
    v_mul_f32 v212, v169, v212
    v_mul_f32 v213, v169, v213
    v_mfma_f32_16x16x32_bf16 v[68:71], v[4:7], v[160:163], v[68:71]
    v_mul_f32 v214, v169, v214
    v_mul_f32 v215, v169, v215
    v_cvt_pk_bf16_f32 v204, v212, v213
    v_mfma_f32_16x16x32_bf16 v[76:79], v[176:179], v[16:19], 0
    v_cvt_pk_bf16_f32 v205, v214, v215
    v_cndmask_b32 v169, v46, v47, s[80:81]
    v_mul_f32 v216, v169, v216
    v_mfma_f32_16x16x32_bf16 v[84:87], v[180:183], v[24:27], 0
    v_mul_f32 v217, v169, v217
    v_mul_f32 v218, v169, v218
    v_mul_f32 v219, v169, v219
    v_mfma_f32_16x16x32_bf16 v[92:95], v[176:179], v[56:59], 0
    v_cvt_pk_bf16_f32 v206, v216, v217
    v_cvt_pk_bf16_f32 v207, v218, v219
    buffer_store_dwordx4 v[204:207], v3, s[32:35], s82 offen sc1
    v_mfma_f32_16x16x32_bf16 v[100:103], v[180:183], v[64:67], 0
    v_cndmask_b32 v169, v61, v62, s[78:79]
    v_mul_f32 v220, v169, v220
    v_mul_f32 v221, v169, v221
    v_mfma_f32_16x16x32_bf16 v[108:111], v[176:179], v[96:99], 0
    v_mul_f32 v222, v169, v222
    v_mul_f32 v223, v169, v223
    v_cvt_pk_bf16_f32 v208, v220, v221
    v_mfma_f32_16x16x32_bf16 v[116:119], v[180:183], v[104:107], 0
    v_cvt_pk_bf16_f32 v209, v222, v223
    v_cndmask_b32 v169, v62, v63, s[80:81]
    v_mul_f32 v224, v169, v224
    v_mfma_f32_16x16x32_bf16 v[124:127], v[176:179], v[136:139], 0
    v_mul_f32 v225, v169, v225
    v_mul_f32 v226, v169, v226
    v_mul_f32 v227, v169, v227
    v_mfma_f32_16x16x32_bf16 v[132:135], v[180:183], v[144:147], 0
    v_cvt_pk_bf16_f32 v210, v224, v225
    v_cvt_pk_bf16_f32 v211, v226, v227
    buffer_store_dwordx4 v[208:211], v3, s[32:35], s83 offen sc1
    v_mfma_f32_16x16x32_bf16 v[76:79], v[172:175], v[24:27], v[76:79]
    v_add_u32 v3, 4096, v3
    v_add_f32 v20, v168, v20
    v_add_f32 v21, v168, v21
    v_mfma_f32_16x16x32_bf16 v[84:87], v[184:187], v[32:35], v[84:87]
    v_add_f32 v22, v168, v22
    v_add_f32 v23, v168, v23
    v_rcp_f32 v20, v20
    v_mfma_f32_16x16x32_bf16 v[92:95], v[172:175], v[64:67], v[92:95]
    v_rcp_f32 v21, v21
    v_rcp_f32 v22, v22
    v_rcp_f32 v23, v23
    v_mfma_f32_16x16x32_bf16 v[100:103], v[184:187], v[72:75], v[100:103]
    v_add_f32 v36, v168, v36
    v_add_f32 v37, v168, v37
    v_add_f32 v38, v168, v38
    v_mfma_f32_16x16x32_bf16 v[108:111], v[172:175], v[104:107], v[108:111]
    v_add_f32 v39, v168, v39
    v_rcp_f32 v36, v36
    v_rcp_f32 v37, v37
    v_mfma_f32_16x16x32_bf16 v[116:119], v[184:187], v[112:115], v[116:119]
    v_rcp_f32 v38, v38
    v_rcp_f32 v39, v39
    v_add_f32 v52, v168, v52
    v_mfma_f32_16x16x32_bf16 v[124:127], v[172:175], v[144:147], v[124:127]
    v_add_f32 v53, v168, v53
    v_add_f32 v54, v168, v54
    v_add_f32 v55, v168, v55
    v_mfma_f32_16x16x32_bf16 v[132:135], v[184:187], v[152:155], v[132:135]
    v_rcp_f32 v52, v52
    v_rcp_f32 v53, v53
    v_rcp_f32 v54, v54
    v_rcp_f32 v55, v55
    v_add_f32 v68, v168, v68
    v_add_f32 v69, v168, v69
    v_add_f32 v70, v168, v70
    v_add_f32 v71, v168, v71
    v_rcp_f32 v68, v68
    v_rcp_f32 v69, v69
    v_rcp_f32 v70, v70
    v_rcp_f32 v71, v71
    s_waitcnt lgkmcnt(0)
    ds_read_b128 v[176:179], v1 offset:17408
    ds_read_b128 v[172:175], v1 offset:16384
    ds_read_b128 v[180:183], v1 offset:18432
    v_mfma_f32_16x16x32_bf16 v[140:143], v[188:191], v[24:27], 0
    v_mul_f32 v76, v15, v76
    v_mul_f32 v77, v15, v77
    v_mul_f32 v78, v15, v78
    v_mfma_f32_16x16x32_bf16 v[148:151], v[200:203], v[32:35], 0
    v_mul_f32 v79, v15, v79
    v_cvt_pk_bf16_f32 v204, v76, v77
    v_cvt_pk_bf16_f32 v205, v78, v79
    v_mfma_f32_16x16x32_bf16 v[156:159], v[188:191], v[64:67], 0
    v_mul_f32 v84, v20, v84
    v_mul_f32 v85, v20, v85
    v_mul_f32 v86, v20, v86
    v_mfma_f32_16x16x32_bf16 v[164:167], v[200:203], v[72:75], 0
    v_mul_f32 v87, v20, v87
    v_cvt_pk_bf16_f32 v206, v84, v85
    v_cvt_pk_bf16_f32 v207, v86, v87
    v_mfma_f32_16x16x32_bf16 v[212:215], v[188:191], v[104:107], 0
    buffer_store_dwordx4 v[204:207], v3, s[32:35], s74 offen sc1
    v_mul_f32 v92, v31, v92
    v_mul_f32 v93, v31, v93
    v_mfma_f32_16x16x32_bf16 v[216:219], v[200:203], v[112:115], 0
    v_mul_f32 v94, v31, v94
    v_mul_f32 v95, v31, v95
    v_cvt_pk_bf16_f32 v208, v92, v93
    v_mfma_f32_16x16x32_bf16 v[220:223], v[188:191], v[144:147], 0
    v_cvt_pk_bf16_f32 v209, v94, v95
    v_mul_f32 v100, v36, v100
    v_mul_f32 v101, v36, v101
    v_mfma_f32_16x16x32_bf16 v[224:227], v[200:203], v[152:155], 0
    v_mul_f32 v102, v36, v102
    v_mul_f32 v103, v36, v103
    v_cvt_pk_bf16_f32 v210, v100, v101
    v_mfma_f32_16x16x32_bf16 v[140:143], v[192:195], v[32:35], v[140:143]
    v_cvt_pk_bf16_f32 v211, v102, v103
    buffer_store_dwordx4 v[208:211], v3, s[32:35], s75 offen sc1
    s_waitcnt vmcnt(6)
    s_mov_b64 exec, 1
    ds_add_rtn_u32 v254, v253, v252 offset:32
    s_mov_b64 exec, -1
    v_mfma_f32_16x16x32_bf16 v[148:151], v[196:199], v[40:43], v[148:151]
    v_mul_f32 v108, v47, v108
    v_mul_f32 v109, v47, v109
    v_mul_f32 v110, v47, v110
    v_mfma_f32_16x16x32_bf16 v[156:159], v[192:195], v[72:75], v[156:159]
    v_mul_f32 v111, v47, v111
    v_cvt_pk_bf16_f32 v204, v108, v109
    v_cvt_pk_bf16_f32 v205, v110, v111
    v_mfma_f32_16x16x32_bf16 v[164:167], v[196:199], v[80:83], v[164:167]
    v_mul_f32 v116, v52, v116
    v_mul_f32 v117, v52, v117
    v_mul_f32 v118, v52, v118
    v_mfma_f32_16x16x32_bf16 v[212:215], v[192:195], v[112:115], v[212:215]
    v_mul_f32 v119, v52, v119
    v_cvt_pk_bf16_f32 v206, v116, v117
    v_cvt_pk_bf16_f32 v207, v118, v119
    v_mfma_f32_16x16x32_bf16 v[216:219], v[196:199], v[120:123], v[216:219]
    buffer_store_dwordx4 v[204:207], v3, s[32:35], s82 offen sc1
    s_waitcnt lgkmcnt(0)
    v_readfirstlane_b32 s85, v254
    s_nop 0
    s_cmp_eq_u32 s85, 3
    s_cselect_b32 s85, s72, 2130706432
    s_nop 1
    buffer_store_dword v252, v251, s[36:39], s85 offen offset:0 sc1
    v_mul_f32 v124, v63, v124
    v_mfma_f32_16x16x32_bf16 v[220:223], v[192:195], v[152:155], v[220:223]
    v_mul_f32 v125, v63, v125
    v_mul_f32 v126, v63, v126
    v_mul_f32 v127, v63, v127
    v_mfma_f32_16x16x32_bf16 v[224:227], v[196:199], v[160:163], v[224:227]
    v_cvt_pk_bf16_f32 v208, v124, v125
    v_cvt_pk_bf16_f32 v209, v126, v127
    v_mul_f32 v132, v68, v132
    v_mul_f32 v133, v68, v133
    v_mul_f32 v134, v68, v134
    v_mul_f32 v135, v68, v135
    v_cvt_pk_bf16_f32 v210, v132, v133
    v_cvt_pk_bf16_f32 v211, v134, v135
    buffer_store_dwordx4 v[208:211], v3, s[32:35], s83 offen sc1
    v_add_u32 v3, 4096, v3
    s_waitcnt lgkmcnt(0)
    v_mfma_f32_16x16x32_bf16 v[76:79], v[176:179], v[32:35], 0
    v_cndmask_b32 v169, v20, v21, s[76:77]
    v_mul_f32 v140, v169, v140
    v_mul_f32 v141, v169, v141
    v_mul_f32 v142, v169, v142
    v_mul_f32 v143, v169, v143
    v_mfma_f32_16x16x32_bf16 v[84:87], v[180:183], v[40:43], 0
    v_cvt_pk_bf16_f32 v204, v140, v141
    v_cvt_pk_bf16_f32 v205, v142, v143
    v_cndmask_b32 v169, v21, v22, s[78:79]
    v_mul_f32 v148, v169, v148
    v_mul_f32 v149, v169, v149
    v_mfma_f32_16x16x32_bf16 v[92:95], v[176:179], v[72:75], 0
    v_mul_f32 v150, v169, v150
    v_mul_f32 v151, v169, v151
    v_cvt_pk_bf16_f32 v206, v148, v149
    v_cvt_pk_bf16_f32 v207, v150, v151
    buffer_store_dwordx4 v[204:207], v3, s[32:35], s74 offen sc1
    v_mfma_f32_16x16x32_bf16 v[100:103], v[180:183], v[80:83], 0
    v_cndmask_b32 v169, v36, v37, s[76:77]
    v_mul_f32 v156, v169, v156
    v_mul_f32 v157, v169, v157
    v_mul_f32 v158, v169, v158
    v_mul_f32 v159, v169, v159
    v_mfma_f32_16x16x32_bf16 v[108:111], v[176:179], v[112:115], 0
    v_cvt_pk_bf16_f32 v208, v156, v157
    v_cvt_pk_bf16_f32 v209, v158, v159
    v_cndmask_b32 v169, v37, v38, s[78:79]
    v_mul_f32 v164, v169, v164
    v_mul_f32 v165, v169, v165
    v_mfma_f32_16x16x32_bf16 v[116:119], v[180:183], v[120:123], 0
    v_mul_f32 v166, v169, v166
    v_mul_f32 v167, v169, v167
    v_cvt_pk_bf16_f32 v210, v164, v165
    v_cvt_pk_bf16_f32 v211, v166, v167
    buffer_store_dwordx4 v[208:211], v3, s[32:35], s75 offen sc1
    v_mfma_f32_16x16x32_bf16 v[124:127], v[176:179], v[152:155], 0
    s_waitcnt vmcnt(7)
    s_mov_b64 exec, 1
    ds_add_rtn_u32 v254, v253, v252 offset:36
    s_mov_b64 exec, -1
    v_cndmask_b32 v169, v52, v53, s[76:77]
    v_mul_f32 v212, v169, v212
    v_mul_f32 v213, v169, v213
    v_mul_f32 v214, v169, v214
    v_mfma_f32_16x16x32_bf16 v[132:135], v[180:183], v[160:163], 0
    v_mul_f32 v215, v169, v215
    v_cvt_pk_bf16_f32 v204, v212, v213
    v_cvt_pk_bf16_f32 v205, v214, v215
    v_cndmask_b32 v169, v53, v54, s[78:79]
    v_mul_f32 v216, v169, v216
    v_mfma_f32_16x16x32_bf16 v[76:79], v[172:175], v[40:43], v[76:79]
    v_mul_f32 v217, v169, v217
    v_mul_f32 v218, v169, v218
    v_mul_f32 v219, v169, v219
    v_cvt_pk_bf16_f32 v206, v216, v217
    v_cvt_pk_bf16_f32 v207, v218, v219
    v_mfma_f32_16x16x32_bf16 v[92:95], v[172:175], v[80:83], v[92:95]
    buffer_store_dwordx4 v[204:207], v3, s[32:35], s82 offen sc1
    s_waitcnt lgkmcnt(0)
    v_readfirstlane_b32 s85, v254
    s_nop 0
    s_cmp_eq_u32 s85, 3
    s_cselect_b32 s85, s72, 2130706432
    s_nop 1
    buffer_store_dword v252, v251, s[36:39], s85 offen offset:128 sc1
    v_cndmask_b32 v169, v68, v69, s[76:77]
    v_mul_f32 v220, v169, v220
    v_mul_f32 v221, v169, v221
    v_mfma_f32_16x16x32_bf16 v[108:111], v[172:175], v[120:123], v[108:111]
    v_mul_f32 v222, v169, v222
    v_mul_f32 v223, v169, v223
    v_cvt_pk_bf16_f32 v208, v220, v221
    v_cvt_pk_bf16_f32 v209, v222, v223
    v_cndmask_b32 v169, v69, v70, s[78:79]
    v_mfma_f32_16x16x32_bf16 v[124:127], v[172:175], v[160:163], v[124:127]
    v_mul_f32 v224, v169, v224
    v_mul_f32 v225, v169, v225
    v_mul_f32 v226, v169, v226
    v_mul_f32 v227, v169, v227
    v_cvt_pk_bf16_f32 v210, v224, v225
    v_cvt_pk_bf16_f32 v211, v226, v227
    buffer_store_dwordx4 v[208:211], v3, s[32:35], s83 offen sc1
    v_add_u32 v3, 4096, v3
    v_cndmask_b32 v169, v22, v23, s[80:81]
    v_mul_f32 v76, v169, v76
    v_mul_f32 v77, v169, v77
    v_mul_f32 v78, v169, v78
    v_mul_f32 v79, v169, v79
    v_cvt_pk_bf16_f32 v204, v76, v77
    v_cvt_pk_bf16_f32 v205, v78, v79
    v_mul_f32 v84, v23, v84
    v_mul_f32 v85, v23, v85
    v_mul_f32 v86, v23, v86
    v_mul_f32 v87, v23, v87
    v_cvt_pk_bf16_f32 v206, v84, v85
    v_cvt_pk_bf16_f32 v207, v86, v87
    buffer_store_dwordx4 v[204:207], v3, s[32:35], s74 offen sc1
    v_cndmask_b32 v169, v38, v39, s[80:81]
    v_mul_f32 v92, v169, v92
    v_mul_f32 v93, v169, v93
    v_mul_f32 v94, v169, v94
    v_mul_f32 v95, v169, v95
    v_cvt_pk_bf16_f32 v208, v92, v93
    v_cvt_pk_bf16_f32 v209, v94, v95
    v_mul_f32 v100, v39, v100
    v_mul_f32 v101, v39, v101
    v_mul_f32 v102, v39, v102
    v_mul_f32 v103, v39, v103
    v_cvt_pk_bf16_f32 v210, v100, v101
    v_cvt_pk_bf16_f32 v211, v102, v103
    buffer_store_dwordx4 v[208:211], v3, s[32:35], s75 offen sc1
    s_waitcnt vmcnt(7)
    s_mov_b64 exec, 1
    ds_add_rtn_u32 v254, v253, v252 offset:40
    s_mov_b64 exec, -1
    v_cndmask_b32 v169, v54, v55, s[80:81]
    v_mul_f32 v108, v169, v108
    v_mul_f32 v109, v169, v109
    v_mul_f32 v110, v169, v110
    v_mul_f32 v111, v169, v111
    v_cvt_pk_bf16_f32 v204, v108, v109
    v_cvt_pk_bf16_f32 v205, v110, v111
    v_mul_f32 v116, v55, v116
    v_mul_f32 v117, v55, v117
    v_mul_f32 v118, v55, v118
    v_mul_f32 v119, v55, v119
    v_cvt_pk_bf16_f32 v206, v116, v117
    v_cvt_pk_bf16_f32 v207, v118, v119
    buffer_store_dwordx4 v[204:207], v3, s[32:35], s82 offen sc1
    s_waitcnt lgkmcnt(0)
    v_readfirstlane_b32 s85, v254
    s_nop 0
    s_cmp_eq_u32 s85, 3
    s_cselect_b32 s85, s72, 2130706432
    s_nop 1
    buffer_store_dword v252, v251, s[36:39], s85 offen offset:256 sc1
    v_cndmask_b32 v169, v70, v71, s[80:81]
    v_mul_f32 v124, v169, v124
    v_mul_f32 v125, v169, v125
    v_mul_f32 v126, v169, v126
    v_mul_f32 v127, v169, v127
    v_cvt_pk_bf16_f32 v208, v124, v125
    v_cvt_pk_bf16_f32 v209, v126, v127
    v_mul_f32 v132, v71, v132
    v_mul_f32 v133, v71, v133
    v_mul_f32 v134, v71, v134
    v_mul_f32 v135, v71, v135
    v_cvt_pk_bf16_f32 v210, v132, v133
    v_cvt_pk_bf16_f32 v211, v134, v135
    buffer_store_dwordx4 v[208:211], v3, s[32:35], s83 offen sc1
    s_waitcnt vmcnt(5)
    s_mov_b64 exec, 1
    ds_add_rtn_u32 v254, v253, v252 offset:44
    s_mov_b64 exec, -1
    s_waitcnt lgkmcnt(0)
    v_readfirstlane_b32 s85, v254
    s_nop 0
    s_cmp_eq_u32 s85, 3
    s_cselect_b32 s85, s72, 2130706432
    s_nop 1
    buffer_store_dword v252, v251, s[36:39], s85 offen offset:384 sc1
    s_waitcnt vmcnt(1)
    s_mov_b64 exec, 1
    ds_add_rtn_u32 v254, v253, v252 offset:48
    s_mov_b64 exec, -1
    s_waitcnt lgkmcnt(0)
    v_readfirstlane_b32 s85, v254
    s_nop 0
    s_cmp_eq_u32 s85, 3
    s_cselect_b32 s85, s72, 2130706432
    s_nop 1
    buffer_store_dword v252, v251, s[36:39], s85 offen offset:512 sc1
    s_endpgm
L_svcc:
    s_waitcnt vmcnt(0)
    s_waitcnt vmcnt(5)
    v_lshlrev_b32 v216, 16, v204
    v_and_b32 v217, 0xffff0000, v204
    v_lshlrev_b32 v218, 16, v205
    v_and_b32 v219, 0xffff0000, v205
    v_lshlrev_b32 v220, 16, v206
    v_and_b32 v221, 0xffff0000, v206
    v_lshlrev_b32 v222, 16, v207
    v_and_b32 v223, 0xffff0000, v207
    v_lshlrev_b32 v224, 16, v208
    v_and_b32 v225, 0xffff0000, v208
    v_lshlrev_b32 v226, 16, v209
    v_and_b32 v227, 0xffff0000, v209
    v_lshlrev_b32 v228, 16, v210
    v_and_b32 v229, 0xffff0000, v210
    v_lshlrev_b32 v230, 16, v211
    v_and_b32 v231, 0xffff0000, v211
    v_lshlrev_b32 v232, 16, v212
    v_and_b32 v233, 0xffff0000, v212
    v_lshlrev_b32 v234, 16, v213
    v_and_b32 v235, 0xffff0000, v213
    v_lshlrev_b32 v236, 16, v214
    v_and_b32 v237, 0xffff0000, v214
    v_lshlrev_b32 v238, 16, v215
    v_and_b32 v239, 0xffff0000, v215
    v_pk_add_f32 v[240:241], v[216:217], v[218:219]
    v_pk_add_f32 v[240:241], v[240:241], v[220:221]
    v_pk_add_f32 v[240:241], v[240:241], v[222:223]
    v_pk_add_f32 v[240:241], v[240:241], v[224:225]
    v_pk_add_f32 v[240:241], v[240:241], v[226:227]
    v_pk_add_f32 v[240:241], v[240:241], v[228:229]
    v_pk_add_f32 v[240:241], v[240:241], v[230:231]
    v_pk_add_f32 v[240:241], v[240:241], v[232:233]
    v_pk_add_f32 v[240:241], v[240:241], v[234:235]
    v_pk_add_f32 v[240:241], v[240:241], v[236:237]
    v_pk_add_f32 v[240:241], v[240:241], v[238:239]
    v_add_f32 v240, v240, v241
    s_nop 1
    v_add_f32_dpp v240, v240, v240 row_ror:8 row_mask:0xf bank_mask:0xf
    s_nop 1
    v_add_f32_dpp v240, v240, v240 row_ror:4 row_mask:0xf bank_mask:0xf
    s_nop 1
    v_add_f32_dpp v240, v240, v240 row_ror:2 row_mask:0xf bank_mask:0xf
    s_nop 1
    v_add_f32_dpp v240, v240, v240 row_ror:1 row_mask:0xf bank_mask:0xf
    v_mov_b32 v242, v240
    s_nop 1
    v_permlane16_swap_b32 v240, v242
    v_add_f32 v240, v240, v242
    v_mul_f32 v240, 0xbacccccd, v240
    v_cndmask_b32 v241, 0, v240, s[80:81]
    v_pk_add_f32 v[216:217], v[216:217], v[240:241] op_sel_hi:[1,0]
    v_pk_add_f32 v[218:219], v[218:219], v[240:241] op_sel_hi:[1,0]
    v_pk_add_f32 v[220:221], v[220:221], v[240:241] op_sel_hi:[1,0]
    v_pk_add_f32 v[222:223], v[222:223], v[240:241] op_sel_hi:[1,0]
    v_pk_add_f32 v[224:225], v[224:225], v[240:241] op_sel_hi:[1,0]
    v_pk_add_f32 v[226:227], v[226:227], v[240:241] op_sel_hi:[1,0]
    v_pk_add_f32 v[228:229], v[228:229], v[240:241] op_sel_hi:[1,0]
    v_pk_add_f32 v[230:231], v[230:231], v[240:241] op_sel_hi:[1,0]
    v_pk_add_f32 v[232:233], v[232:233], v[240:241] op_sel:[0,1] op_sel_hi:[1,1]
    v_pk_add_f32 v[234:235], v[234:235], v[240:241] op_sel:[0,1] op_sel_hi:[1,1]
    v_pk_add_f32 v[236:237], v[236:237], v[240:241] op_sel:[0,1] op_sel_hi:[1,1]
    v_pk_add_f32 v[238:239], v[238:239], v[240:241] op_sel:[0,1] op_sel_hi:[1,1]
    v_pk_mul_f32 v[244:245], v[216:217], v[216:217]
    v_pk_fma_f32 v[244:245], v[218:219], v[218:219], v[244:245]
    v_pk_fma_f32 v[244:245], v[220:221], v[220:221], v[244:245]
    v_pk_fma_f32 v[244:245], v[222:223], v[222:223], v[244:245]
    v_pk_fma_f32 v[244:245], v[224:225], v[224:225], v[244:245]
    v_pk_fma_f32 v[244:245], v[226:227], v[226:227], v[244:245]
    v_pk_fma_f32 v[244:245], v[228:229], v[228:229], v[244:245]
    v_pk_fma_f32 v[244:245], v[230:231], v[230:231], v[244:245]
    v_pk_fma_f32 v[244:245], v[232:233], v[232:233], v[244:245]
    v_pk_fma_f32 v[244:245], v[234:235], v[234:235], v[244:245]
    v_pk_fma_f32 v[244:245], v[236:237], v[236:237], v[244:245]
    v_pk_fma_f32 v[244:245], v[238:239], v[238:239], v[244:245]
    v_add_f32 v244, v244, v245
    s_nop 1
    v_add_f32_dpp v244, v244, v244 row_ror:8 row_mask:0xf bank_mask:0xf
    s_nop 1
    v_add_f32_dpp v244, v244, v244 row_ror:4 row_mask:0xf bank_mask:0xf
    s_nop 1
    v_add_f32_dpp v244, v244, v244 row_ror:2 row_mask:0xf bank_mask:0xf
    s_nop 1
    v_add_f32_dpp v244, v244, v244 row_ror:1 row_mask:0xf bank_mask:0xf
    v_mov_b32 v242, v244
    s_nop 1
    v_permlane16_swap_b32 v244, v242
    v_add_f32 v244, v244, v242
    v_mul_f32 v244, 0x3acccccd, v244
    v_cvt_pk_bf16_f32 v242, v240, v240
    v_lshlrev_b32 v240, 16, v242
    v_cvt_pk_bf16_f32 v242, v244, v244
    v_lshlrev_b32 v244, 16, v242
    v_add_f32 v244, 0x3727c5ac, v244
    v_cvt_pk_bf16_f32 v242, v244, v244
    v_lshlrev_b32 v244, 16, v242
    v_sqrt_f32 v244, v244
    s_nop 0
    v_cvt_pk_bf16_f32 v242, v244, v244
    v_lshlrev_b32 v244, 16, v242
    v_rcp_f32 v244, v244
    v_lshrrev_b32 v242, 5, v0
    s_lshl_b32 s72, s56, 3
    s_add_u32 s72, s72, 160768
    v_lshl_add_u32 v242, v242, 2, s72
    ds_write_b32 v242, v240
    ds_write_b32 v242, v244 offset:32
    s_waitcnt lgkmcnt(0)
    s_barrier
    s_endpgm
L_svcl:
    s_sub_u32 s72, s56, 4
    s_sub_u32 s75, s62, 13
    v_lshlrev_b32 v1, 4, v0
    v_mov_b32 v4, -1
    v_mov_b32 v8, 0
    v_mov_b32 v5, -1
    v_mov_b32 v9, 0
    v_mov_b32 v6, -1
    v_mov_b32 v10, 0
    v_mov_b32 v7, -1
    v_mov_b32 v11, 0
    s_lshl2_add_u32 s76, s75, s72
    s_lshl_b32 s73, s76, 10
    s_waitcnt lgkmcnt(0)
    s_add_u32 s36, s20, 10485760
    s_addc_u32 s37, s21, 0
    s_mov_b32 s38, 393216
    s_mov_b32 s39, 0x20000
    s_mov_b32 s38, 75776
    buffer_store_dwordx4 v[4:7], v1, s[36:39], s73 offen sc1
    s_add_u32 s73, s73, 12288
    buffer_store_dwordx4 v[4:7], v1, s[36:39], s73 offen sc1
    s_add_u32 s73, s73, 12288
    buffer_store_dwordx4 v[4:7], v1, s[36:39], s73 offen sc1
    s_add_u32 s73, s73, 12288
    buffer_store_dwordx4 v[4:7], v1, s[36:39], s73 offen sc1
    s_add_u32 s73, s73, 12288
    buffer_store_dwordx4 v[4:7], v1, s[36:39], s73 offen sc1
    s_add_u32 s73, s73, 12288
    buffer_store_dwordx4 v[4:7], v1, s[36:39], s73 offen sc1
    s_add_u32 s73, s73, 12288
    buffer_store_dwordx4 v[4:7], v1, s[36:39], s73 offen sc1
    s_add_u32 s73, s73, 12288
    s_mov_b32 s40, s18
    s_mov_b32 s41, s19
    s_mov_b32 s42, 256
    s_mov_b32 s43, 0x20000
    s_mov_b32 s48, s8
    s_mov_b32 s49, s9
    s_mov_b32 s50, 819200
    s_mov_b32 s51, 0x20000
    v_mov_b32 v2, 2130706432
    v_writelane_b32 v2, 0, 0
    v_mov_b32 v3, 1
    s_lshl_b32 s74, s75, 4
    s_cmp_eq_u32 s72, 0
    s_cselect_b32 s74, s74, 2130706432
    s_waitcnt vmcnt(0)
    s_barrier
    buffer_store_dword v3, v2, s[40:43], s74 offen offset:64 sc1
    s_mov_b32 s38, 131072
    s_lshl_b32 s73, s76, 10
    s_add_u32 s73, s73, 75776
    buffer_store_dwordx4 v[8:11], v1, s[36:39], s73 offen sc1
    s_add_u32 s73, s73, 12288
    buffer_store_dwordx4 v[8:11], v1, s[36:39], s73 offen sc1
    s_add_u32 s73, s73, 12288
    buffer_store_dwordx4 v[8:11], v1, s[36:39], s73 offen sc1
    s_add_u32 s73, s73, 12288
    buffer_store_dwordx4 v[8:11], v1, s[36:39], s73 offen sc1
    s_add_u32 s73, s73, 12288
    buffer_store_dwordx4 v[8:11], v1, s[36:39], s73 offen sc1
    s_add_u32 s73, s73, 12288
    s_mov_b32 s38, 393216
    v_lshlrev_b32 v12, 8, v0
    s_lshl_b32 s73, s76, 14
    s_add_u32 s73, s73, 131072
    buffer_store_dword v8, v12, s[36:39], s73 offen offset:0 sc1
    buffer_store_dword v8, v12, s[36:39], s73 offen offset:128 sc1
    s_waitcnt vmcnt(0)
    s_barrier
    buffer_store_dword v3, v2, s[40:43], s74 offen offset:128 sc1
    s_cmp_lg_u32 s72, 0
    s_cbranch_scc1 svc_50
    v_min_u32 v12, 2, v0
    v_lshl_add_u32 v12, v12, 4, 64
    s_mov_b32 s85, 200000
poll_51:
    buffer_load_dword v13, v12, s[40:43], 0 offen sc1
    s_waitcnt vmcnt(0)
    v_cmp_ne_u32 vcc, 1, v13
    s_nop 1
    s_cmp_eq_u64 vcc, 0
    s_cbranch_scc1 pdone_53
    s_sleep 4
    s_sub_u32 s85, s85, 1
    s_cmp_lg_u32 s85, 0
    s_cbranch_scc1 poll_51
pdone_53:
    s_and_b32 s73, s2, 7
    s_lshl_b32 s68, s73, 8
    s_and_b32 s73, s2, 0xf8
    s_add_u32 s68, s68, s73
    v_lshlrev_b32 v12, 2, v0
    v_add_u32 v12, 160768, v12
    ds_read_b32 v13, v12
    v_lshrrev_b32 v14, 3, v0
    v_lshlrev_b32 v14, 13, v14
    v_and_b32 v15, 7, v0
    v_add_u32 v15, s68, v15
    v_lshl_add_u32 v14, v15, 2, v14
    s_mov_b64 exec, 0xffff
    s_waitcnt lgkmcnt(0)
    buffer_store_dword v13, v14, s[36:39], 0 offen sc1
    s_mov_b64 exec, -1
svc_50:
    v_lshlrev_b32 v12, 7, v0
    s_lshl_b32 s73, s76, 13
    buffer_load_dword v13, v12, s[48:51], s73 offen
    s_add_u32 s73, s73, 98304
    buffer_load_dword v13, v12, s[48:51], s73 offen
    s_add_u32 s73, s73, 98304
    buffer_load_dword v13, v12, s[48:51], s73 offen
    s_add_u32 s73, s73, 98304
    buffer_load_dword v13, v12, s[48:51], s73 offen
    s_add_u32 s73, s73, 98304
    buffer_load_dword v13, v12, s[48:51], s73 offen
    s_add_u32 s73, s73, 98304
    buffer_load_dword v13, v12, s[48:51], s73 offen
    s_add_u32 s73, s73, 98304
    buffer_load_dword v13, v12, s[48:51], s73 offen
    s_add_u32 s73, s73, 98304
    buffer_load_dword v13, v12, s[48:51], s73 offen
    s_add_u32 s73, s73, 98304
    buffer_load_dword v13, v12, s[48:51], s73 offen
    s_add_u32 s73, s73, 98304
    s_endpgm
.p2align 12
L_lH:
    s_mov_b32 s28, s12
    s_mov_b32 s29, s13
    s_mov_b32 s30, 2211840
    s_mov_b32 s31, 0x20000
    s_mul_i32 s76, s72, 6144
    s_add_u32 s76, s76, 20480
    v_and_b32 v4, 2, v1
    v_xor_b32 v4, v4, v2
    v_mul_u32_u24 v3, 3456, v1
    v_lshl_add_u32 v3, v4, 4, v3
    v_xor_b32 v4, 64, v3
    s_mul_i32 s75, s59, 384
    s_mul_i32 s73, s72, 6
    s_add_u32 s73, s73, 0
    s_lshr_b32 s74, s73, 3
    s_and_b32 s73, s73, 7
    s_mul_i32 s73, s73, 27648
    s_lshl_b32 s74, s74, 7
    s_add_u32 s73, s73, s74
    s_add_u32 s73, s73, s75
    v_add_u32 v16, s73, v3
    s_add_u32 m0, s76, 0
    s_nop 0
    buffer_load_dwordx4 v16, s[28:31], 0 offen lds
    s_mul_i32 s73, s72, 6
    s_add_u32 s73, s73, 1
    s_lshr_b32 s74, s73, 3
    s_and_b32 s73, s73, 7
    s_mul_i32 s73, s73, 27648
    s_lshl_b32 s74, s74, 7
    s_add_u32 s73, s73, s74
    s_add_u32 s73, s73, s75
    v_add_u32 v17, s73, v4
    s_add_u32 m0, s76, 1024
    s_nop 0
    buffer_load_dwordx4 v17, s[28:31], 0 offen lds
    s_mul_i32 s73, s72, 6
    s_add_u32 s73, s73, 2
    s_lshr_b32 s74, s73, 3
    s_and_b32 s73, s73, 7
    s_mul_i32 s73, s73, 27648
    s_lshl_b32 s74, s74, 7
    s_add_u32 s73, s73, s74
    s_add_u32 s73, s73, s75
    v_add_u32 v18, s73, v3
    s_add_u32 m0, s76, 2048
    s_nop 0
    buffer_load_dwordx4 v18, s[28:31], 0 offen lds
    s_mul_i32 s73, s72, 6
    s_add_u32 s73, s73, 3
    s_lshr_b32 s74, s73, 3
    s_and_b32 s73, s73, 7
    s_mul_i32 s73, s73, 27648
    s_lshl_b32 s74, s74, 7
    s_add_u32 s73, s73, s74
    s_add_u32 s73, s73, s75
    v_add_u32 v19, s73, v4
    s_add_u32 m0, s76, 3072
    s_nop 0
    buffer_load_dwordx4 v19, s[28:31], 0 offen lds
    s_mul_i32 s73, s72, 6
    s_add_u32 s73, s73, 4
    s_lshr_b32 s74, s73, 3
    s_and_b32 s73, s73, 7
    s_mul_i32 s73, s73, 27648
    s_lshl_b32 s74, s74, 7
    s_add_u32 s73, s73, s74
    s_add_u32 s73, s73, s75
    v_add_u32 v20, s73, v3
    s_add_u32 m0, s76, 4096
    s_nop 0
    buffer_load_dwordx4 v20, s[28:31], 0 offen lds
    s_mul_i32 s73, s72, 6
    s_add_u32 s73, s73, 5
    s_lshr_b32 s74, s73, 3
    s_and_b32 s73, s73, 7
    s_mul_i32 s73, s73, 27648
    s_lshl_b32 s74, s74, 7
    s_add_u32 s73, s73, s74
    s_add_u32 s73, s73, s75
    v_add_u32 v21, s73, v4
    s_add_u32 m0, s76, 5120
    s_nop 0
    buffer_load_dwordx4 v21, s[28:31], 0 offen lds
    s_mov_b32 s78, 128
    s_mov_b32 s79, 221184
    s_bfe_u32 s70, s2, 0x20002
    s_and_b32 s73, s2, 3
    s_lshr_b32 s74, s2, 4
    s_sub_u32 s74, s74, 6
    s_mul_i32 s75, s74, 86
    s_lshr_b32 s75, s75, 8
    s_mul_i32 s75, s75, 7
    s_lshr_b32 s69, s74, 1
    s_lshl3_add_u32 s69, s69, 3
    s_bitcmp1_b32 s2, 0
    s_cselect_b32 s69, s69, s75
    s_add_u32 s69, s69, s74
    s_lshr_b32 s75, s73, 1
    s_mul_i32 s75, s75, 5
    s_add_u32 s69, s69, s75
    s_add_u32 s75, s74, s73
    s_add_u32 s75, s75, 47
    s_cmp_ge_u32 s69, 30
    s_cselect_b32 s69, s75, s69
    s_lshl_b32 s75, s73, 2
    s_lshr_b32 s75, 0x7989, s75
    s_and_b32 s75, s75, 15
    s_cmp_lt_i32 s74, s75
    s_cselect_b32 s70, s70, 4
    s_mul_i32 s75, s73, 6
    s_add_u32 s75, s75, s74
    s_add_u32 s75, s75, 36
    s_cmp_lt_i32 s74, 0
    s_cselect_b32 s69, s75, s69
    s_add_u32 m0, s76, 45056
    s_nop 0
    buffer_load_dwordx4 v16, s[28:31], s79 offen lds
    s_add_u32 m0, s77, 45056
    s_nop 0
    buffer_load_dwordx4 v8, s[24:27], s78 offen lds
    s_add_u32 m0, s76, 46080
    s_nop 0
    buffer_load_dwordx4 v17, s[28:31], s79 offen lds
    s_add_u32 m0, s77, 46080
    s_nop 0
    buffer_load_dwordx4 v9, s[24:27], s78 offen lds
    s_add_u32 s36, s20, 10485760
    s_addc_u32 s37, s21, 0
    s_mov_b32 s38, 393216
    s_mov_b32 s39, 0x20000
    s_mov_b32 s40, s18
    s_mov_b32 s41, s19
    s_mov_b32 s42, 256
    s_mov_b32 s43, 0x20000
    s_mov_b32 s44, s14
    s_mov_b32 s45, s15
    s_mov_b32 s46, 2211840
    s_mov_b32 s47, 0x20000
    s_mov_b32 s48, s8
    s_mov_b32 s49, s9
    s_mov_b32 s50, 819200
    s_mov_b32 s51, 0x20000
    s_and_b32 s73, s2, 7
    s_lshl_b32 s68, s73, 8
    s_and_b32 s73, s2, 0xf8
    s_add_u32 s68, s68, s73
    s_bfe_u32 s73, s2, 0x20001
    s_mul_i32 s73, s73, 28
    s_lshr_b32 s74, s2, 3
    s_add_u32 s73, s73, s74
    s_sub_u32 s73, s73, 4
    s_cmp_lt_u32 s73, 110
    s_cselect_b32 s63, 1, 0
    s_mul_i32 s60, s73, 13108
    s_lshr_b32 s60, s60, 16
    s_mul_i32 s61, s60, 5
    s_sub_u32 s61, s73, s61
    s_and_b32 s73, s2, 1
    s_mul_i32 s73, s73, 5
    s_add_u32 s61, s61, s73
    s_cmp_eq_u32 s2, 246
    s_cselect_b32 s63, 1, s63
    s_cselect_b32 s60, 21, s60
    s_cselect_b32 s61, 9, s61
    v_min_u32 v54, 2, v0
    v_lshlrev_b32 v54, 4, v54
    s_cmp_eq_u32 s72, 3
    s_cselect_b32 s73, 64, 2130706432
    s_cselect_b32 s74, 1, 0
    v_add3_u32 v62, s73, v54, 64
    v_mov_b32 v64, s74
    s_cmp_lt_u32 s72, 2
    s_cselect_b32 s73, 64, 2130706432
    s_cselect_b32 s74, 1, 0
    v_add_u32 v54, s73, v54
    v_mov_b32 v63, s74
    s_lshl_b32 s73, s72, 6
    v_add_u32 v56, s73, v0
    v_mov_b32 v59, 2130706432
    s_mul_i32 s73, s70, 14592
    s_lshl_b32 s74, s69, 8
    s_add_u32 s73, s73, s74
    s_add_u32 s73, s73, 16384
    s_cmp_lt_u32 s70, 4
    s_cselect_b32 s73, s73, 2130706432
    v_lshl_add_u32 v60, v0, 2, s73
    v_lshlrev_b32 v3, 13, v1
    v_add_u32 v4, s68, v2
    v_lshl_add_u32 v3, v4, 2, v3
    v_cmp_gt_u32 vcc, 64, v56
    s_nop 1
    v_cndmask_b32 v60, v3, v60, vcc
    v_cmp_gt_u32 vcc, 80, v56
    s_nop 1
    v_cndmask_b32 v60, v59, v60, vcc
    v_lshlrev_b32 v61, 2, v0
    v_add_u32 v61, 159744, v61
    v_add_u32 v3, s58, v56
    v_lshlrev_b32 v57, 2, v3
    v_cmp_gt_u32 vcc, 2048, v3
    s_nop 1
    v_cndmask_b32 v57, v59, v57, vcc
    v_cmp_gt_u32 vcc, 160, v56
    s_nop 1
    v_cndmask_b32 v57, v59, v57, vcc
    s_mul_i32 s73, s59, 192
    s_add_u32 s73, s73, 1920
    v_add_u32 v3, s73, v56
    v_lshlrev_b32 v58, 2, v3
    v_add_u32 v58, 16384, v58
    v_cmp_gt_u32 vcc, 192, v56
    s_nop 1
    v_cndmask_b32 v58, v59, v58, vcc
    s_mov_b32 s80, 14592
    s_mov_b32 s81, 29184
    s_mov_b32 s82, 43776
    s_mov_b32 s83, 8192
    v_and_b32 v3, 6, v1
    v_xor_b32 v3, v3, v2
    v_mul_u32_u24 v4, 1280, v1
    v_lshl_add_u32 v3, v3, 4, v4
    s_and_b32 s73, s72, 1
    s_mul_i32 s73, s73, 20480
    s_lshl_b32 s74, s61, 7
    s_add_u32 s73, s73, s74
    s_cmp_eq_u32 s63, 0
    s_cselect_b32 s73, 2130706432, s73
    s_lshr_b32 s74, s72, 1
    s_mul_i32 s75, s74, 122880
    s_add_u32 s75, s75, s73
    v_add_u32 v92, s75, v3
    v_add_u32 v93, 10240, v92
    s_mul_i32 s75, s74, 204800
    s_add_u32 s75, s75, s73
    v_add_u32 v94, s75, v3
    v_add_u32 v95, 10240, v94
    s_lshl_b32 s84, s72, 11
    s_waitcnt vmcnt(4)
    s_barrier
    s_add_u32 m0, s76, 47104
    s_nop 0
    buffer_load_dwordx4 v18, s[28:31], s79 offen lds
    s_add_u32 m0, s77, 47104
    s_nop 0
    buffer_load_dwordx4 v10, s[24:27], s78 offen lds
    s_add_u32 m0, s76, 48128
    s_nop 0
    buffer_load_dwordx4 v19, s[28:31], s79 offen lds
    s_add_u32 m0, s77, 48128
    s_nop 0
    buffer_load_dwordx4 v11, s[24:27], s78 offen lds
    s_add_u32 m0, s76, 49152
    s_nop 0
    buffer_load_dwordx4 v20, s[28:31], s79 offen lds
    s_add_u32 m0, s77, 49152
    s_nop 0
    buffer_load_dwordx4 v12, s[24:27], s78 offen lds
    s_add_u32 m0, s76, 50176
    s_nop 0
    buffer_load_dwordx4 v21, s[28:31], s79 offen lds
    s_add_u32 s78, s78, 128
    s_add_u32 s79, s79, 221184
    s_add_u32 m0, s76, 90112
    s_nop 0
    buffer_load_dwordx4 v16, s[28:31], s79 offen lds
    s_add_u32 m0, s77, 90112
    s_nop 0
    buffer_load_dwordx4 v8, s[24:27], s78 offen lds
    s_add_u32 m0, s76, 91136
    s_nop 0
    buffer_load_dwordx4 v17, s[28:31], s79 offen lds
    s_add_u32 m0, s77, 91136
    s_nop 0
    buffer_load_dwordx4 v9, s[24:27], s78 offen lds
    s_waitcnt vmcnt(4)
    s_barrier
    buffer_load_dword v55, v54, s[40:43], 0 offen sc1
    s_add_u32 m0, s76, 92160
    s_nop 0
    buffer_load_dwordx4 v18, s[28:31], s79 offen lds
    s_add_u32 m0, s77, 92160
    s_nop 0
    buffer_load_dwordx4 v10, s[24:27], s78 offen lds
    s_add_u32 m0, s76, 93184
    s_nop 0
    buffer_load_dwordx4 v19, s[28:31], s79 offen lds
    s_add_u32 m0, s77, 93184
    s_nop 0
    buffer_load_dwordx4 v11, s[24:27], s78 offen lds
    s_add_u32 m0, s76, 94208
    s_nop 0
    buffer_load_dwordx4 v20, s[28:31], s79 offen lds
    s_add_u32 m0, s77, 94208
    s_nop 0
    buffer_load_dwordx4 v12, s[24:27], s78 offen lds
    s_add_u32 m0, s76, 95232
    s_nop 0
    buffer_load_dwordx4 v21, s[28:31], s79 offen lds
    s_add_u32 s78, s78, 128
    s_add_u32 s79, s79, 221184
    s_add_u32 m0, s76, 0
    s_nop 0
    buffer_load_dwordx4 v16, s[28:31], s79 offen lds
    s_add_u32 m0, s77, 0
    s_nop 0
    buffer_load_dwordx4 v8, s[24:27], s78 offen lds
    s_add_u32 m0, s76, 1024
    s_nop 0
    buffer_load_dwordx4 v17, s[28:31], s79 offen lds
    s_add_u32 m0, s77, 1024
    s_nop 0
    buffer_load_dwordx4 v9, s[24:27], s78 offen lds
    s_add_u32 m0, s76, 2048
    s_nop 0
    buffer_load_dwordx4 v18, s[28:31], s79 offen lds
    s_add_u32 m0, s77, 2048
    s_nop 0
    buffer_load_dwordx4 v10, s[24:27], s78 offen lds
    s_add_u32 m0, s76, 3072
    s_nop 0
    buffer_load_dwordx4 v19, s[28:31], s79 offen lds
    s_add_u32 m0, s77, 3072
    s_nop 0
    buffer_load_dwordx4 v11, s[24:27], s78 offen lds
    s_mov_b32 s23, 0
    s_mov_b64 exec, 0
    s_cmp_eq_u32 s56, 4
    s_cbranch_scc1 L_pad_1
    s_cmp_eq_u32 s56, 5
    s_cbranch_scc1 L_pad_3
    s_cmp_eq_u32 s56, 6
    s_cbranch_scc1 L_pad_4
    s_cmp_eq_u32 s56, 7
    s_cbranch_scc1 L_pad_2
L_tramp:
    s_cmp_eq_u32 s23, 1
    s_cbranch_scc1 L_padret_K
L_padret_H:
    s_mov_b64 exec, -1
    s_waitcnt vmcnt(8)
    s_barrier
    s_add_u32 m0, s76, 4096
    s_nop 0
    buffer_load_dwordx4 v20, s[28:31], s79 offen lds
    s_add_u32 m0, s77, 4096
    s_nop 0
    buffer_load_dwordx4 v12, s[24:27], s78 offen lds
    s_add_u32 m0, s76, 5120
    s_nop 0
    buffer_load_dwordx4 v21, s[28:31], s79 offen lds
    s_add_u32 s78, s78, 128
    s_add_u32 s79, s79, 221184
    s_add_u32 m0, s76, 45056
    s_nop 0
    buffer_load_dwordx4 v16, s[28:31], s79 offen lds
    s_add_u32 m0, s77, 45056
    s_nop 0
    buffer_load_dwordx4 v8, s[24:27], s78 offen lds
    s_add_u32 m0, s76, 46080
    s_nop 0
    buffer_load_dwordx4 v17, s[28:31], s79 offen lds
    s_add_u32 m0, s77, 46080
    s_nop 0
    buffer_load_dwordx4 v9, s[24:27], s78 offen lds
    s_add_u32 m0, s76, 47104
    s_nop 0
    buffer_load_dwordx4 v18, s[28:31], s79 offen lds
    s_add_u32 m0, s77, 47104
    s_nop 0
    buffer_load_dwordx4 v10, s[24:27], s78 offen lds
    s_add_u32 m0, s76, 48128
    s_nop 0
    buffer_load_dwordx4 v19, s[28:31], s79 offen lds
    s_add_u32 m0, s77, 48128
    s_nop 0
    buffer_load_dwordx4 v11, s[24:27], s78 offen lds
    s_add_u32 m0, s76, 49152
    s_nop 0
    buffer_load_dwordx4 v20, s[28:31], s79 offen lds
    s_add_u32 m0, s77, 49152
    s_nop 0
    buffer_load_dwordx4 v12, s[24:27], s78 offen lds
    s_add_u32 m0, s76, 50176
    s_nop 0
    buffer_load_dwordx4 v21, s[28:31], s79 offen lds
    s_add_u32 s78, s78, 128
    s_add_u32 s79, s79, 221184
    v_cmp_ne_u32 vcc, v63, v55
    s_nop 1
    s_cmp_lg_u64 vcc, 0
    s_cbranch_scc1 pslow_55
pdone_56:
    ds_read_b32 v66, v61 offset:0
    ds_read_b32 v67, v61 offset:256
    ds_read_b32 v68, v61 offset:512
    ds_read_b32 v69, v61 offset:768
    ds_read_b32 v70, v61 offset:1024
    s_waitcnt lgkmcnt(0)
    v_add_f32 v66, v66, v67
    v_add_f32 v68, v68, v69
    v_add_f32 v66, v66, v68
    v_cmp_gt_u32 vcc, 64, v56
    s_nop 1
    v_cndmask_b32 v66, v70, v66, vcc
    buffer_store_dword v66, v60, s[36:39], 0 offen sc1
    s_mul_i32 s73, s62, 9
    s_add_u32 s73, s73, s59
    s_lshl2_add_u32 s73, s73, s72
    s_mul_i32 s73, s73, 4736
    v_min_u32 v3, 36, v0
    v_lshlrev_b32 v3, 7, v3
    buffer_load_dword v255, v3, s[44:47], s73 offen
    s_waitcnt vmcnt(13)
    s_barrier
    s_add_u32 m0, s76, 90112
    s_nop 0
    buffer_load_dwordx4 v16, s[28:31], s79 offen lds
    s_add_u32 m0, s77, 90112
    s_nop 0
    buffer_load_dwordx4 v8, s[24:27], s78 offen lds
    s_add_u32 m0, s76, 91136
    s_nop 0
    buffer_load_dwordx4 v17, s[28:31], s79 offen lds
    s_add_u32 m0, s77, 91136
    s_nop 0
    buffer_load_dwordx4 v9, s[24:27], s78 offen lds
    s_add_u32 m0, s76, 92160
    s_nop 0
    buffer_load_dwordx4 v18, s[28:31], s79 offen lds
    s_add_u32 m0, s77, 92160
    s_nop 0
    buffer_load_dwordx4 v10, s[24:27], s78 offen lds
    s_add_u32 m0, s76, 93184
    s_nop 0
    buffer_load_dwordx4 v19, s[28:31], s79 offen lds
    s_add_u32 m0, s77, 93184
    s_nop 0
    buffer_load_dwordx4 v11, s[24:27], s78 offen lds
    s_add_u32 m0, s76, 94208
    s_nop 0
    buffer_load_dwordx4 v20, s[28:31], s79 offen lds
    s_add_u32 m0, s77, 94208
    s_nop 0
    buffer_load_dwordx4 v12, s[24:27], s78 offen lds
    s_add_u32 m0, s76, 95232
    s_nop 0
    buffer_load_dwordx4 v21, s[28:31], s79 offen lds
    s_add_u32 s78, s78, 128
    s_add_u32 s79, s79, 221184
    s_waitcnt vmcnt(13)
    s_barrier
    s_add_u32 m0, s76, 0
    s_nop 0
    buffer_load_dwordx4 v16, s[28:31], s79 offen lds
    s_add_u32 m0, s77, 0
    s_nop 0
    buffer_load_dwordx4 v8, s[24:27], s78 offen lds
    s_add_u32 m0, s76, 1024
    s_nop 0
    buffer_load_dwordx4 v17, s[28:31], s79 offen lds
    s_add_u32 m0, s77, 1024
    s_nop 0
    buffer_load_dwordx4 v9, s[24:27], s78 offen lds
    s_add_u32 m0, s76, 2048
    s_nop 0
    buffer_load_dwordx4 v18, s[28:31], s79 offen lds
    s_add_u32 m0, s77, 2048
    s_nop 0
    buffer_load_dwordx4 v10, s[24:27], s78 offen lds
    s_add_u32 m0, s76, 3072
    s_nop 0
    buffer_load_dwordx4 v19, s[28:31], s79 offen lds
    s_add_u32 m0, s77, 3072
    s_nop 0
    buffer_load_dwordx4 v11, s[24:27], s78 offen lds
    s_add_u32 m0, s76, 4096
    s_nop 0
    buffer_load_dwordx4 v20, s[28:31], s79 offen lds
    s_add_u32 m0, s77, 4096
    s_nop 0
    buffer_load_dwordx4 v12, s[24:27], s78 offen lds
    s_add_u32 m0, s76, 5120
    s_nop 0
    buffer_load_dwordx4 v21, s[28:31], s79 offen lds
    s_add_u32 s78, s78, 128
    s_add_u32 s79, s79, 221184
    s_waitcnt vmcnt(11)
    s_barrier
    s_add_u32 m0, s76, 45056
    s_nop 0
    buffer_load_dwordx4 v16, s[28:31], s79 offen lds
    s_add_u32 m0, s77, 45056
    s_nop 0
    buffer_load_dwordx4 v8, s[24:27], s78 offen lds
    s_add_u32 m0, s76, 46080
    s_nop 0
    buffer_load_dwordx4 v17, s[28:31], s79 offen lds
    s_add_u32 m0, s77, 46080
    s_nop 0
    buffer_load_dwordx4 v9, s[24:27], s78 offen lds
    s_add_u32 m0, s76, 47104
    s_nop 0
    buffer_load_dwordx4 v18, s[28:31], s79 offen lds
    s_add_u32 m0, s77, 47104
    s_nop 0
    buffer_load_dwordx4 v10, s[24:27], s78 offen lds
    s_add_u32 m0, s76, 48128
    s_nop 0
    buffer_load_dwordx4 v19, s[28:31], s79 offen lds
    s_add_u32 m0, s77, 48128
    s_nop 0
    buffer_load_dwordx4 v11, s[24:27], s78 offen lds
    s_add_u32 m0, s76, 49152
    s_nop 0
    buffer_load_dwordx4 v20, s[28:31], s79 offen lds
    s_add_u32 m0, s77, 49152
    s_nop 0
    buffer_load_dwordx4 v12, s[24:27], s78 offen lds
    s_add_u32 m0, s76, 50176
    s_nop 0
    buffer_load_dwordx4 v21, s[28:31], s79 offen lds
    s_add_u32 s78, s78, 128
    s_add_u32 s79, s79, 221184
    s_mov_b32 s74, 81920
    buffer_load_dwordx4 v[100:103], v92, s[44:47], s74 offen
    buffer_load_dwordx4 v[104:107], v93, s[44:47], s74 offen
    s_waitcnt vmcnt(13)
    s_barrier
    s_add_u32 m0, s76, 90112
    s_nop 0
    buffer_load_dwordx4 v16, s[28:31], s79 offen lds
    s_add_u32 m0, s77, 90112
    s_nop 0
    buffer_load_dwordx4 v8, s[24:27], s78 offen lds
    s_add_u32 m0, s76, 91136
    s_nop 0
    buffer_load_dwordx4 v17, s[28:31], s79 offen lds
    s_add_u32 m0, s77, 91136
    s_nop 0
    buffer_load_dwordx4 v9, s[24:27], s78 offen lds
    s_add_u32 m0, s76, 92160
    s_nop 0
    buffer_load_dwordx4 v18, s[28:31], s79 offen lds
    s_add_u32 m0, s77, 92160
    s_nop 0
    buffer_load_dwordx4 v10, s[24:27], s78 offen lds
    s_add_u32 m0, s76, 93184
    s_nop 0
    buffer_load_dwordx4 v19, s[28:31], s79 offen lds
    s_add_u32 m0, s77, 93184
    s_nop 0
    buffer_load_dwordx4 v11, s[24:27], s78 offen lds
    s_add_u32 m0, s76, 94208
    s_nop 0
    buffer_load_dwordx4 v20, s[28:31], s79 offen lds
    s_add_u32 m0, s77, 94208
    s_nop 0
    buffer_load_dwordx4 v12, s[24:27], s78 offen lds
    s_add_u32 m0, s76, 95232
    s_nop 0
    buffer_load_dwordx4 v21, s[28:31], s79 offen lds
    s_add_u32 s78, s78, 128
    s_add_u32 s79, s79, 221184
    s_mov_b32 s74, 327680
    buffer_load_dwordx4 v[108:111], v92, s[44:47], s74 offen
    buffer_load_dwordx4 v[112:115], v93, s[44:47], s74 offen
    s_waitcnt vmcnt(15)
    s_barrier
    buffer_load_dword v55, v62, s[40:43], 0 offen sc1
    buffer_load_dword v66, v57, s[36:39], 0 offen sc1
    buffer_load_dword v67, v57, s[36:39], s83 offen sc1
    buffer_load_dword v68, v58, s[36:39], 0 offen sc1
    buffer_load_dword v69, v58, s[36:39], s80 offen sc1
    buffer_load_dword v70, v58, s[36:39], s81 offen sc1
    buffer_load_dword v71, v58, s[36:39], s82 offen sc1
    s_add_u32 m0, s76, 0
    s_nop 0
    buffer_load_dwordx4 v16, s[28:31], s79 offen lds
    s_add_u32 m0, s77, 0
    s_nop 0
    buffer_load_dwordx4 v8, s[24:27], s78 offen lds
    s_add_u32 m0, s76, 1024
    s_nop 0
    buffer_load_dwordx4 v17, s[28:31], s79 offen lds
    s_add_u32 m0, s77, 1024
    s_nop 0
    buffer_load_dwordx4 v9, s[24:27], s78 offen lds
    s_add_u32 m0, s76, 2048
    s_nop 0
    buffer_load_dwordx4 v18, s[28:31], s79 offen lds
    s_add_u32 m0, s77, 2048
    s_nop 0
    buffer_load_dwordx4 v10, s[24:27], s78 offen lds
    s_add_u32 m0, s76, 3072
    s_nop 0
    buffer_load_dwordx4 v19, s[28:31], s79 offen lds
    s_add_u32 m0, s77, 3072
    s_nop 0
    buffer_load_dwordx4 v11, s[24:27], s78 offen lds
    s_add_u32 m0, s76, 4096
    s_nop 0
    buffer_load_dwordx4 v20, s[28:31], s79 offen lds
    s_add_u32 m0, s77, 4096
    s_nop 0
    buffer_load_dwordx4 v12, s[24:27], s78 offen lds
    s_add_u32 m0, s76, 5120
    s_nop 0
    buffer_load_dwordx4 v21, s[28:31], s79 offen lds
    s_add_u32 s78, s78, 128
    s_add_u32 s79, s79, 221184
    s_mov_b32 s74, 573440
    buffer_load_dwordx4 v[116:119], v92, s[44:47], s74 offen
    buffer_load_dwordx4 v[120:123], v93, s[44:47], s74 offen
    s_waitcnt vmcnt(22)
    s_barrier
    s_mov_b32 s74, 819200
    buffer_load_dwordx4 v[124:127], v92, s[44:47], s74 offen
    buffer_load_dwordx4 v[128:131], v93, s[44:47], s74 offen
    s_mov_b32 s74, 1064960
    buffer_load_dwordx4 v[132:135], v92, s[44:47], s74 offen
    buffer_load_dwordx4 v[136:139], v93, s[44:47], s74 offen
    s_waitcnt vmcnt(17)
    v_cmp_ne_u32 vcc, v64, v55
    s_nop 1
    s_cmp_lg_u64 vcc, 0
    s_cbranch_scc1 pslow_58
pdone_59:
    s_mov_b32 s85, 200000
    s_branch tabc_61
tab_60:
    buffer_load_dword v66, v57, s[36:39], 0 offen sc1
    buffer_load_dword v67, v57, s[36:39], s83 offen sc1
    buffer_load_dword v68, v58, s[36:39], 0 offen sc1
    buffer_load_dword v69, v58, s[36:39], s80 offen sc1
    buffer_load_dword v70, v58, s[36:39], s81 offen sc1
    buffer_load_dword v71, v58, s[36:39], s82 offen sc1
    s_waitcnt vmcnt(0)
tabc_61:
    v_max_u32 v3, v66, v67
    v_max3_u32 v3, v3, v68, v69
    v_max3_u32 v3, v3, v70, v71
    v_cmp_eq_u32 vcc, -1, v3
    s_nop 1
    s_cmp_eq_u64 vcc, 0
    s_cbranch_scc1 tabd_62
    s_sleep 4
    s_sub_u32 s85, s85, 1
    s_cmp_lg_u32 s85, 0
    s_cbranch_scc1 tab_60
tabd_62:
    v_add_f32 v68, v68, v69
    v_add_f32 v70, v70, v71
    v_add_f32 v68, v68, v70
    v_lshlrev_b32 v3, 2, v56
    v_add_u32 v3, 160896, v3
    ds_write_b32 v3, v66
    ds_write_b32 v3, v67 offset:1024
    v_min_u32 v4, 192, v56
    v_lshlrev_b32 v4, 2, v4
    v_add_u32 v4, 162944, v4
    ds_write_b32 v4, v68
    s_waitcnt lgkmcnt(0)
    s_mov_b32 s74, 1310720
    buffer_load_dwordx4 v[140:143], v92, s[44:47], s74 offen
    buffer_load_dwordx4 v[144:147], v93, s[44:47], s74 offen
    s_mov_b32 s74, 1556480
    buffer_load_dwordx4 v[148:151], v92, s[44:47], s74 offen
    buffer_load_dwordx4 v[152:155], v93, s[44:47], s74 offen
    s_mov_b32 s74, 1802240
    buffer_load_dwordx4 v[156:159], v92, s[44:47], s74 offen
    buffer_load_dwordx4 v[160:163], v93, s[44:47], s74 offen
    s_mov_b32 s74, 2048000
    buffer_load_dwordx4 v[164:167], v92, s[44:47], s74 offen
    buffer_load_dwordx4 v[168:171], v93, s[44:47], s74 offen
    s_waitcnt vmcnt(14)
    s_barrier
    s_cmp_eq_u32 s63, 0
    s_cbranch_scc1 L_fin
    s_mov_b32 s76, s84
    s_mov_b32 s74, 0
    s_waitcnt vmcnt(5)
    buffer_load_dwordx4 v[172:175], v94, s[48:51], s74 offen
    buffer_load_dwordx4 v[176:179], v95, s[48:51], s74 offen
    s_mov_b32 s74, 409600
    s_waitcnt vmcnt(5)
    buffer_load_dwordx4 v[180:183], v94, s[48:51], s74 offen
    buffer_load_dwordx4 v[184:187], v95, s[48:51], s74 offen
    s_mov_b32 s74, 40960
    s_waitcnt vmcnt(5)
    buffer_load_dwordx4 v[188:191], v94, s[48:51], s74 offen
    buffer_load_dwordx4 v[192:195], v95, s[48:51], s74 offen
    s_mul_i32 s73, s60, 96
    s_add_u32 s77, s73, 95
    s_min_u32 s77, s77, 2047
    v_mov_b32 v29, 163744
    v_mov_b32 v30, 1
    s_mov_b32 s74, 450560
    s_waitcnt vmcnt(5)
    buffer_load_dwordx4 v[196:199], v94, s[48:51], s74 offen
    buffer_load_dwordx4 v[200:203], v95, s[48:51], s74 offen
    s_mov_b32 s74, 81920
    s_waitcnt vmcnt(5)
    buffer_load_dwordx4 v[204:207], v94, s[48:51], s74 offen
    buffer_load_dwordx4 v[208:211], v95, s[48:51], s74 offen
    s_mov_b32 s74, 491520
    s_waitcnt vmcnt(5)
    buffer_load_dwordx4 v[212:215], v94, s[48:51], s74 offen
    buffer_load_dwordx4 v[216:219], v95, s[48:51], s74 offen
    s_mov_b32 s74, 0
    s_waitcnt vmcnt(5)
    s_add_u32 m0, s76, 49152
    s_nop 0
    buffer_load_dwordx4 v92, s[44:47], s74 offen lds
    s_add_u32 m0, s76, 50176
    s_nop 0
    buffer_load_dwordx4 v93, s[44:47], s74 offen lds
    s_mov_b32 s74, 245760
    s_waitcnt vmcnt(5)
    s_add_u32 m0, s76, 57344
    s_nop 0
    buffer_load_dwordx4 v92, s[44:47], s74 offen lds
    s_add_u32 m0, s76, 58368
    s_nop 0
    buffer_load_dwordx4 v93, s[44:47], s74 offen lds
    s_mov_b32 s74, 491520
    s_waitcnt vmcnt(5)
    s_add_u32 m0, s76, 65536
    s_nop 0
    buffer_load_dwordx4 v92, s[44:47], s74 offen lds
    s_add_u32 m0, s76, 66560
    s_nop 0
    buffer_load_dwordx4 v93, s[44:47], s74 offen lds
    s_mov_b32 s74, 737280
    s_waitcnt vmcnt(5)
    s_add_u32 m0, s76, 73728
    s_nop 0
    buffer_load_dwordx4 v92, s[44:47], s74 offen lds
    s_add_u32 m0, s76, 74752
    s_nop 0
    buffer_load_dwordx4 v93, s[44:47], s74 offen lds
    s_mov_b32 s74, 983040
    s_waitcnt vmcnt(5)
    s_add_u32 m0, s76, 81920
    s_nop 0
    buffer_load_dwordx4 v92, s[44:47], s74 offen lds
    s_add_u32 m0, s76, 82944
    s_nop 0
    buffer_load_dwordx4 v93, s[44:47], s74 offen lds
    s_mov_b32 s74, 1228800
    s_waitcnt vmcnt(5)
    s_add_u32 m0, s76, 90112
    s_nop 0
    buffer_load_dwordx4 v92, s[44:47], s74 offen lds
    s_add_u32 m0, s76, 91136
    s_nop 0
    buffer_load_dwordx4 v93, s[44:47], s74 offen lds
    s_mov_b32 s74, 1474560
    s_waitcnt vmcnt(5)
    s_add_u32 m0, s76, 98304
    s_nop 0
    buffer_load_dwordx4 v92, s[44:47], s74 offen lds
    s_add_u32 m0, s76, 99328
    s_nop 0
    buffer_load_dwordx4 v93, s[44:47], s74 offen lds
    s_mov_b32 s74, 1720320
    s_waitcnt vmcnt(5)
    s_add_u32 m0, s76, 106496
    s_nop 0
    buffer_load_dwordx4 v92, s[44:47], s74 offen lds
    s_add_u32 m0, s76, 107520
    s_nop 0
    buffer_load_dwordx4 v93, s[44:47], s74 offen lds
    s_mov_b32 s74, 1966080
    s_waitcnt vmcnt(5)
    s_add_u32 m0, s76, 114688
    s_nop 0
    buffer_load_dwordx4 v92, s[44:47], s74 offen lds
    s_add_u32 m0, s76, 115712
    s_nop 0
    buffer_load_dwordx4 v93, s[44:47], s74 offen lds
    s_waitcnt vmcnt(8)
    s_mov_b64 exec, 1
    ds_add_u32 v29, v30 offset:16
    s_mov_b64 exec, -1
    s_mov_b32 s74, 40960
    s_waitcnt vmcnt(5)
    s_add_u32 m0, s76, 122880
    s_nop 0
    buffer_load_dwordx4 v92, s[44:47], s74 offen lds
    s_add_u32 m0, s76, 123904
    s_nop 0
    buffer_load_dwordx4 v93, s[44:47], s74 offen lds
    s_mov_b32 s74, 286720
    s_waitcnt vmcnt(5)
    s_add_u32 m0, s76, 131072
    s_nop 0
    buffer_load_dwordx4 v92, s[44:47], s74 offen lds
    s_add_u32 m0, s76, 132096
    s_nop 0
    buffer_load_dwordx4 v93, s[44:47], s74 offen lds
    s_mov_b32 s74, 532480
    s_waitcnt vmcnt(5)
    s_add_u32 m0, s76, 139264
    s_nop 0
    buffer_load_dwordx4 v92, s[44:47], s74 offen lds
    s_add_u32 m0, s76, 140288
    s_nop 0
    buffer_load_dwordx4 v93, s[44:47], s74 offen lds
    ds_read_b32 v22, v29 offset:0
    s_waitcnt lgkmcnt(0)
    v_readfirstlane_b32 s85, v22
    s_nop 0
    s_cmp_lt_u32 s85, 256
    s_cbranch_scc1 lws_64
lwd_65:
    s_mov_b32 s74, 778240
    s_waitcnt vmcnt(5)
    s_add_u32 m0, s76, 0
    s_nop 0
    buffer_load_dwordx4 v92, s[44:47], s74 offen lds
    s_add_u32 m0, s76, 1024
    s_nop 0
    buffer_load_dwordx4 v93, s[44:47], s74 offen lds
    s_mov_b32 s74, 1024000
    s_waitcnt vmcnt(5)
    s_add_u32 m0, s76, 8192
    s_nop 0
    buffer_load_dwordx4 v92, s[44:47], s74 offen lds
    s_add_u32 m0, s76, 9216
    s_nop 0
    buffer_load_dwordx4 v93, s[44:47], s74 offen lds
    s_mov_b32 s74, 1269760
    s_waitcnt vmcnt(5)
    s_add_u32 m0, s76, 16384
    s_nop 0
    buffer_load_dwordx4 v92, s[44:47], s74 offen lds
    s_add_u32 m0, s76, 17408
    s_nop 0
    buffer_load_dwordx4 v93, s[44:47], s74 offen lds
    s_mov_b32 s74, 1515520
    s_waitcnt vmcnt(5)
    s_add_u32 m0, s76, 24576
    s_nop 0
    buffer_load_dwordx4 v92, s[44:47], s74 offen lds
    s_add_u32 m0, s76, 25600
    s_nop 0
    buffer_load_dwordx4 v93, s[44:47], s74 offen lds
    s_mov_b32 s74, 1761280
    s_waitcnt vmcnt(5)
    s_add_u32 m0, s76, 32768
    s_nop 0
    buffer_load_dwordx4 v92, s[44:47], s74 offen lds
    s_add_u32 m0, s76, 33792
    s_nop 0
    buffer_load_dwordx4 v93, s[44:47], s74 offen lds
    s_mov_b32 s74, 2007040
    s_waitcnt vmcnt(5)
    s_add_u32 m0, s76, 40960
    s_nop 0
    buffer_load_dwordx4 v92, s[44:47], s74 offen lds
    s_add_u32 m0, s76, 41984
    s_nop 0
    buffer_load_dwordx4 v93, s[44:47], s74 offen lds
    s_mov_b32 s74, 122880
    s_waitcnt vmcnt(5)
    buffer_load_dwordx4 v[220:223], v94, s[48:51], s74 offen
    buffer_load_dwordx4 v[224:227], v95, s[48:51], s74 offen
    s_mov_b32 s74, 532480
    s_waitcnt vmcnt(5)
    buffer_load_dwordx4 v[228:231], v94, s[48:51], s74 offen
    buffer_load_dwordx4 v[232:235], v95, s[48:51], s74 offen
    s_mov_b32 s74, 163840
    s_waitcnt vmcnt(5)
    buffer_load_dwordx4 v[236:239], v94, s[48:51], s74 offen
    buffer_load_dwordx4 v[240:243], v95, s[48:51], s74 offen
    s_mov_b32 s74, 573440
    s_waitcnt vmcnt(5)
    buffer_load_dwordx4 v[244:247], v94, s[48:51], s74 offen
    buffer_load_dwordx4 v[248:251], v95, s[48:51], s74 offen
    s_mul_i32 s75, s72, 24
    s_add_u32 s75, s75, s73
    s_mul_i32 s75, s75, 1280
    s_lshl_b32 s81, s61, 7
    s_add_u32 s75, s75, s81
    v_mul_u32_u24 v26, 1280, v1
    v_xor_b32 v22, v1, v2
    v_lshl_add_u32 v26, v22, 4, v26
    v_add_u32 v26, s75, v26
    s_lshr_b32 s73, s73, 8
    s_lshr_b32 s77, s77, 8
    v_mov_b32 v23, s73
    v_mov_b32 v25, s77
    v_cmp_gt_u32 vcc, 4, v2
    s_nop 1
    v_cndmask_b32 v23, v25, v23, vcc
    v_and_b32 v22, 3, v0
    v_lshl_add_u32 v22, v23, 2, v22
    v_lshlrev_b32 v22, 10, v22
    v_min_u32 v23, 4, v1
    v_lshl_add_u32 v22, v23, 7, v22
    v_add_u32 v25, 294912, v22
    s_lshl_b32 s73, s72, 11
    v_lshl_add_u32 v24, v0, 4, s73
    v_add_u32 v27, 65536, v24
    v_add_u32 v28, 131072, v24
    s_waitcnt vmcnt(20)
    s_barrier
    ds_write_b128 v24, v[100:103] offset:49152
    ds_write_b128 v24, v[104:107] offset:50176
    ds_write_b128 v24, v[108:111] offset:57344
    ds_write_b128 v24, v[112:115] offset:58368
    ds_write_b128 v27, v[116:119] offset:0
    ds_write_b128 v27, v[120:123] offset:1024
    ds_write_b128 v27, v[124:127] offset:8192
    ds_write_b128 v27, v[128:131] offset:9216
    ds_write_b128 v27, v[132:135] offset:16384
    ds_write_b128 v27, v[136:139] offset:17408
    s_waitcnt vmcnt(8)
    s_waitcnt lgkmcnt(0)
    s_barrier
    ds_write_b128 v27, v[140:143] offset:24576
    ds_write_b128 v27, v[144:147] offset:25600
    ds_write_b128 v27, v[148:151] offset:32768
    ds_write_b128 v27, v[152:155] offset:33792
    ds_write_b128 v27, v[156:159] offset:40960
    ds_write_b128 v27, v[160:163] offset:41984
    ds_write_b128 v27, v[164:167] offset:49152
    ds_write_b128 v27, v[168:171] offset:50176
    ds_write_b128 v27, v[172:175] offset:57344
    ds_write_b128 v27, v[176:179] offset:58368
    ds_write_b128 v28, v[180:183] offset:0
    ds_write_b128 v28, v[184:187] offset:1024
    ds_write_b128 v28, v[188:191] offset:8192
    ds_write_b128 v28, v[192:195] offset:9216
    s_waitcnt vmcnt(0) lgkmcnt(0)
    s_mov_b32 s73, 0
    v_mov_b32 v32, 0
    s_barrier
    s_cmp_lg_u32 s56, 7
    s_cbranch_scc1 o1_69
    s_lshl_b32 s75, s73, 3
    s_bfm_b64 exec, 8, s75
    s_and_b32 exec_hi, exec_hi, 0xff
    buffer_load_dword v32, v25, s[36:39], 0 offen sc1
    s_mov_b64 exec, -1
    s_waitcnt vmcnt(0)
    v_cmp_ne_u32 vcc, 1, v32
    s_nop 1
    s_ff1_i32_b64 s73, vcc
    s_lshr_b32 s73, s73, 3
    v_mov_b32 v23, s73
    s_mov_b64 exec, 1
    ds_max_u32 v29, v23 offset:12
    s_mov_b64 exec, -1
    s_min_u32 s73, s73, 4
    s_lshl_b32 s75, s73, 3
    s_bfm_b64 exec, 16, s75
    s_and_b32 exec_hi, exec_hi, 0xff
    buffer_load_dword v32, v25, s[36:39], 0 offen sc1
    s_mov_b64 exec, -1
o1_69:
    s_mul_i32 s81, s72, 3072
    s_mov_b32 s77, 0
    s_add_u32 m0, s81, 147456
    s_nop 0
    buffer_load_dwordx4 v26, s[24:27], s77 offen lds
    s_add_u32 s77, s77, 10240
    s_add_u32 m0, s81, 148480
    s_nop 0
    buffer_load_dwordx4 v26, s[24:27], s77 offen lds
    s_add_u32 s77, s77, 10240
    s_add_u32 m0, s81, 149504
    s_nop 0
    buffer_load_dwordx4 v26, s[24:27], s77 offen lds
    s_add_u32 s77, s77, 10240
    ds_write_b128 v24, v[196:199] offset:0
    ds_write_b128 v24, v[200:203] offset:1024
    ds_write_b128 v24, v[204:207] offset:8192
    ds_write_b128 v24, v[208:211] offset:9216
    ds_write_b128 v24, v[212:215] offset:16384
    ds_write_b128 v24, v[216:219] offset:17408
    ds_write_b128 v24, v[220:223] offset:24576
    ds_write_b128 v24, v[224:227] offset:25600
    ds_write_b128 v24, v[228:231] offset:32768
    ds_write_b128 v24, v[232:235] offset:33792
    ds_write_b128 v24, v[236:239] offset:40960
    ds_write_b128 v24, v[240:243] offset:41984
    ds_write_b128 v24, v[244:247] offset:49152
    ds_write_b128 v24, v[248:251] offset:50176
    s_waitcnt lgkmcnt(0)
    s_cmp_lg_u32 s56, 7
    s_cbranch_scc1 oo_68
    s_mov_b32 s85, 200000
op_66:
    s_waitcnt vmcnt(0)
    v_cmp_ne_u32 vcc, 1, v32
    s_nop 1
    s_ff1_i32_b64 s73, vcc
    s_lshr_b32 s73, s73, 3
    v_mov_b32 v23, s73
    s_mov_b64 exec, 1
    ds_max_u32 v29, v23 offset:12
    s_mov_b64 exec, -1
    s_mov_b64 exec, 1
    ds_add_u32 v29, v30 offset:72
    s_mov_b64 exec, -1
    v_mov_b32 v30, 0
    s_cmp_ge_u32 s73, 5
    s_cbranch_scc1 od_67
    s_sleep 2
    s_lshl_b32 s75, s73, 3
    s_bfm_b64 exec, 16, s75
    s_and_b32 exec_hi, exec_hi, 0xff
    buffer_load_dword v32, v25, s[36:39], 0 offen sc1
    s_mov_b64 exec, -1
    s_sub_u32 s85, s85, 1
    s_cmp_lg_u32 s85, 0
    s_cbranch_scc1 op_66
    s_branch od_67
oo_68:
    s_waitcnt vmcnt(0)
    s_mov_b64 exec, 1
    ds_add_u32 v29, v30 offset:72
    s_mov_b64 exec, -1
od_67:
    s_branch L_fin
pslow_55:
    s_mov_b32 s85, 200000
poll_54:
    s_sleep 8
    buffer_load_dword v55, v54, s[40:43], 0 offen sc1
    s_waitcnt vmcnt(0)
    v_cmp_ne_u32 vcc, v63, v55
    s_nop 1
    s_cmp_eq_u64 vcc, 0
    s_cbranch_scc1 pdone_56
    s_sub_u32 s85, s85, 1
    s_cmp_lg_u32 s85, 0
    s_cbranch_scc1 poll_54
    s_branch pdone_56
pslow_58:
    s_mov_b32 s85, 200000
poll_57:
    s_sleep 8
    buffer_load_dword v55, v62, s[40:43], 0 offen sc1
    s_waitcnt vmcnt(0)
    v_cmp_ne_u32 vcc, v64, v55
    s_nop 1
    s_cmp_eq_u64 vcc, 0
    s_cbranch_scc1 pdone_59
    s_sub_u32 s85, s85, 1
    s_cmp_lg_u32 s85, 0
    s_cbranch_scc1 poll_57
    s_branch pdone_59
lws_64:
    s_mov_b32 s84, 1600000
lw_63:
    s_sleep 1
    ds_read_b32 v22, v29 offset:0
    s_waitcnt lgkmcnt(0)
    v_readfirstlane_b32 s85, v22
    s_nop 0
    s_cmp_ge_u32 s85, 256
    s_cbranch_scc1 lwd_65
    s_sub_u32 s84, s84, 1
    s_cmp_lg_u32 s84, 0
    s_cbranch_scc1 lw_63
    s_branch lwd_65
.p2align 12
L_lK:
    s_mov_b32 s28, s6
    s_mov_b32 s29, s7
    s_mov_b32 s30, 2457600
    s_mov_b32 s31, 0x20000
    s_mul_i32 s76, s72, 5120
    s_add_u32 s76, s76, 20480
    s_mul_i32 s74, s59, 160
    s_mul_i32 s73, s72, 61440
    s_add_u32 s74, s74, s73
    s_add_u32 s74, s74, 1280
    v_add_u32 v3, 0, v0
    v_mul_u32_u24 v4, 52429, v3
    v_lshrrev_b32 v4, 20, v4
    v_mul_u32_u24 v5, 20, v4
    v_sub_u32 v3, v3, v5
    v_lshrrev_b32 v5, 2, v4
    v_and_b32 v5, 2, v5
    v_xor_b32 v3, v3, v5
    v_mul_u32_u24 v4, 3840, v4
    v_lshl_add_u32 v4, v3, 4, v4
    v_mul_u32_u24 v5, 209716, v3
    v_lshrrev_b32 v5, 20, v5
    v_and_b32 v6, 1, v5
    v_mul_u32_u24 v6, 1240, v6
    v_mul_u32_u24 v5, 40, v5
    v_sub_u32 v6, v6, v5
    v_add3_u32 v16, v6, v4, s74
    s_add_u32 m0, s76, 0
    s_nop 0
    buffer_load_dwordx4 v16, s[28:31], 0 offen lds
    v_add_u32 v3, 64, v0
    v_mul_u32_u24 v4, 52429, v3
    v_lshrrev_b32 v4, 20, v4
    v_mul_u32_u24 v5, 20, v4
    v_sub_u32 v3, v3, v5
    v_lshrrev_b32 v5, 2, v4
    v_and_b32 v5, 2, v5
    v_xor_b32 v3, v3, v5
    v_mul_u32_u24 v4, 3840, v4
    v_lshl_add_u32 v4, v3, 4, v4
    v_mul_u32_u24 v5, 209716, v3
    v_lshrrev_b32 v5, 20, v5
    v_and_b32 v6, 1, v5
    v_mul_u32_u24 v6, 1240, v6
    v_mul_u32_u24 v5, 40, v5
    v_sub_u32 v6, v6, v5
    v_add3_u32 v17, v6, v4, s74
    s_add_u32 m0, s76, 1024
    s_nop 0
    buffer_load_dwordx4 v17, s[28:31], 0 offen lds
    v_add_u32 v3, 128, v0
    v_mul_u32_u24 v4, 52429, v3
    v_lshrrev_b32 v4, 20, v4
    v_mul_u32_u24 v5, 20, v4
    v_sub_u32 v3, v3, v5
    v_lshrrev_b32 v5, 2, v4
    v_and_b32 v5, 2, v5
    v_xor_b32 v3, v3, v5
    v_mul_u32_u24 v4, 3840, v4
    v_lshl_add_u32 v4, v3, 4, v4
    v_mul_u32_u24 v5, 209716, v3
    v_lshrrev_b32 v5, 20, v5
    v_and_b32 v6, 1, v5
    v_mul_u32_u24 v6, 1240, v6
    v_mul_u32_u24 v5, 40, v5
    v_sub_u32 v6, v6, v5
    v_add3_u32 v18, v6, v4, s74
    s_add_u32 m0, s76, 2048
    s_nop 0
    buffer_load_dwordx4 v18, s[28:31], 0 offen lds
    v_add_u32 v3, 192, v0
    v_mul_u32_u24 v4, 52429, v3
    v_lshrrev_b32 v4, 20, v4
    v_mul_u32_u24 v5, 20, v4
    v_sub_u32 v3, v3, v5
    v_lshrrev_b32 v5, 2, v4
    v_and_b32 v5, 2, v5
    v_xor_b32 v3, v3, v5
    v_mul_u32_u24 v4, 3840, v4
    v_lshl_add_u32 v4, v3, 4, v4
    v_mul_u32_u24 v5, 209716, v3
    v_lshrrev_b32 v5, 20, v5
    v_and_b32 v6, 1, v5
    v_mul_u32_u24 v6, 1240, v6
    v_mul_u32_u24 v5, 40, v5
    v_sub_u32 v6, v6, v5
    v_add3_u32 v19, v6, v4, s74
    s_add_u32 m0, s76, 3072
    s_nop 0
    buffer_load_dwordx4 v19, s[28:31], 0 offen lds
    v_add_u32 v3, 256, v0
    v_mul_u32_u24 v4, 52429, v3
    v_lshrrev_b32 v4, 20, v4
    v_mul_u32_u24 v5, 20, v4
    v_sub_u32 v3, v3, v5
    v_lshrrev_b32 v5, 2, v4
    v_and_b32 v5, 2, v5
    v_xor_b32 v3, v3, v5
    v_mul_u32_u24 v4, 3840, v4
    v_lshl_add_u32 v4, v3, 4, v4
    v_mul_u32_u24 v5, 209716, v3
    v_lshrrev_b32 v5, 20, v5
    v_and_b32 v6, 1, v5
    v_mul_u32_u24 v6, 1240, v6
    v_mul_u32_u24 v5, 40, v5
    v_sub_u32 v6, v6, v5
    v_add3_u32 v20, v6, v4, s74
    s_add_u32 m0, s76, 4096
    s_nop 0
    buffer_load_dwordx4 v20, s[28:31], 0 offen lds
    s_mov_b32 s78, 128
    s_mov_b32 s79, 245760
    s_bfe_u32 s70, s2, 0x20002
    s_and_b32 s73, s2, 3
    s_lshr_b32 s74, s2, 4
    s_sub_u32 s74, s74, 6
    s_mul_i32 s75, s74, 86
    s_lshr_b32 s75, s75, 8
    s_mul_i32 s75, s75, 7
    s_lshr_b32 s69, s74, 1
    s_lshl3_add_u32 s69, s69, 3
    s_bitcmp1_b32 s2, 0
    s_cselect_b32 s69, s69, s75
    s_add_u32 s69, s69, s74
    s_lshr_b32 s75, s73, 1
    s_mul_i32 s75, s75, 5
    s_add_u32 s69, s69, s75
    s_add_u32 s75, s74, s73
    s_add_u32 s75, s75, 47
    s_cmp_ge_u32 s69, 30
    s_cselect_b32 s69, s75, s69
    s_lshl_b32 s75, s73, 2
    s_lshr_b32 s75, 0x7989, s75
    s_and_b32 s75, s75, 15
    s_cmp_lt_i32 s74, s75
    s_cselect_b32 s70, s70, 4
    s_mul_i32 s75, s73, 6
    s_add_u32 s75, s75, s74
    s_add_u32 s75, s75, 36
    s_cmp_lt_i32 s74, 0
    s_cselect_b32 s69, s75, s69
    s_add_u32 m0, s76, 40960
    s_nop 0
    buffer_load_dwordx4 v16, s[28:31], s79 offen lds
    s_add_u32 m0, s77, 40960
    s_nop 0
    buffer_load_dwordx4 v8, s[24:27], s78 offen lds
    s_add_u32 m0, s76, 41984
    s_nop 0
    buffer_load_dwordx4 v17, s[28:31], s79 offen lds
    s_add_u32 m0, s77, 41984
    s_nop 0
    buffer_load_dwordx4 v9, s[24:27], s78 offen lds
    s_add_u32 s36, s20, 10485760
    s_addc_u32 s37, s21, 0
    s_mov_b32 s38, 393216
    s_mov_b32 s39, 0x20000
    s_mov_b32 s40, s18
    s_mov_b32 s41, s19
    s_mov_b32 s42, 256
    s_mov_b32 s43, 0x20000
    s_mov_b32 s44, s14
    s_mov_b32 s45, s15
    s_mov_b32 s46, 2211840
    s_mov_b32 s47, 0x20000
    s_mov_b32 s48, s8
    s_mov_b32 s49, s9
    s_mov_b32 s50, 819200
    s_mov_b32 s51, 0x20000
    s_and_b32 s73, s2, 7
    s_lshl_b32 s68, s73, 8
    s_and_b32 s73, s2, 0xf8
    s_add_u32 s68, s68, s73
    s_bfe_u32 s73, s2, 0x20001
    s_mul_i32 s73, s73, 28
    s_lshr_b32 s74, s2, 3
    s_add_u32 s73, s73, s74
    s_sub_u32 s73, s73, 4
    s_cmp_lt_u32 s73, 110
    s_cselect_b32 s63, 1, 0
    s_mul_i32 s60, s73, 13108
    s_lshr_b32 s60, s60, 16
    s_mul_i32 s61, s60, 5
    s_sub_u32 s61, s73, s61
    s_and_b32 s73, s2, 1
    s_mul_i32 s73, s73, 5
    s_add_u32 s61, s61, s73
    s_cmp_eq_u32 s2, 246
    s_cselect_b32 s63, 1, s63
    s_cselect_b32 s60, 21, s60
    s_cselect_b32 s61, 9, s61
    v_min_u32 v54, 2, v0
    v_lshlrev_b32 v54, 4, v54
    s_cmp_eq_u32 s72, 3
    s_cselect_b32 s73, 64, 2130706432
    s_cselect_b32 s74, 1, 0
    v_add3_u32 v62, s73, v54, 64
    v_mov_b32 v64, s74
    s_cmp_lt_u32 s72, 2
    s_cselect_b32 s73, 64, 2130706432
    s_cselect_b32 s74, 1, 0
    v_add_u32 v54, s73, v54
    v_mov_b32 v63, s74
    s_lshl_b32 s73, s72, 6
    v_add_u32 v56, s73, v0
    v_mov_b32 v59, 2130706432
    s_mul_i32 s73, s70, 14592
    s_lshl_b32 s74, s69, 8
    s_add_u32 s73, s73, s74
    s_add_u32 s73, s73, 16384
    s_cmp_lt_u32 s70, 4
    s_cselect_b32 s73, s73, 2130706432
    v_lshl_add_u32 v60, v0, 2, s73
    v_lshlrev_b32 v3, 13, v1
    v_add_u32 v4, s68, v2
    v_lshl_add_u32 v3, v4, 2, v3
    v_cmp_gt_u32 vcc, 64, v56
    s_nop 1
    v_cndmask_b32 v60, v3, v60, vcc
    v_cmp_gt_u32 vcc, 80, v56
    s_nop 1
    v_cndmask_b32 v60, v59, v60, vcc
    v_lshlrev_b32 v61, 2, v0
    v_add_u32 v61, 159744, v61
    v_add_u32 v3, s58, v56
    v_lshlrev_b32 v57, 2, v3
    v_cmp_gt_u32 vcc, 2048, v3
    s_nop 1
    v_cndmask_b32 v57, v59, v57, vcc
    v_cmp_gt_u32 vcc, 160, v56
    s_nop 1
    v_cndmask_b32 v57, v59, v57, vcc
    v_mul_u32_u24 v4, 26215, v56
    v_lshrrev_b32 v4, 20, v4
    v_and_b32 v5, 1, v4
    v_mul_u32_u24 v5, 620, v5
    v_mul_u32_u24 v4, 20, v4
    v_sub_u32 v5, v5, v4
    s_mul_i32 s73, s59, 80
    s_add_u32 s73, s73, 640
    v_add3_u32 v3, v5, v56, s73
    v_lshlrev_b32 v58, 2, v3
    v_add_u32 v58, 16384, v58
    v_cmp_gt_u32 vcc, 160, v56
    s_nop 1
    v_cndmask_b32 v58, v59, v58, vcc
    s_mov_b32 s80, 14592
    s_mov_b32 s81, 29184
    s_mov_b32 s82, 43776
    s_mov_b32 s83, 8192
    v_and_b32 v3, 6, v1
    v_xor_b32 v3, v3, v2
    v_mul_u32_u24 v4, 1280, v1
    v_lshl_add_u32 v3, v3, 4, v4
    s_and_b32 s73, s72, 1
    s_mul_i32 s73, s73, 20480
    s_lshl_b32 s74, s61, 7
    s_add_u32 s73, s73, s74
    s_cmp_eq_u32 s63, 0
    s_cselect_b32 s73, 2130706432, s73
    s_lshr_b32 s74, s72, 1
    s_mul_i32 s75, s74, 122880
    s_add_u32 s75, s75, s73
    v_add_u32 v92, s75, v3
    v_add_u32 v93, 10240, v92
    s_mul_i32 s75, s74, 204800
    s_add_u32 s75, s75, s73
    v_add_u32 v94, s75, v3
    v_add_u32 v95, 10240, v94
    s_lshl_b32 s84, s72, 11
    s_waitcnt vmcnt(4)
    s_barrier
    s_add_u32 m0, s76, 43008
    s_nop 0
    buffer_load_dwordx4 v18, s[28:31], s79 offen lds
    s_add_u32 m0, s77, 43008
    s_nop 0
    buffer_load_dwordx4 v10, s[24:27], s78 offen lds
    s_add_u32 m0, s76, 44032
    s_nop 0
    buffer_load_dwordx4 v19, s[28:31], s79 offen lds
    s_add_u32 m0, s77, 44032
    s_nop 0
    buffer_load_dwordx4 v11, s[24:27], s78 offen lds
    s_add_u32 m0, s76, 45056
    s_nop 0
    buffer_load_dwordx4 v20, s[28:31], s79 offen lds
    s_add_u32 m0, s77, 45056
    s_nop 0
    buffer_load_dwordx4 v12, s[24:27], s78 offen lds
    s_add_u32 s78, s78, 128
    s_add_u32 s79, s79, 245760
    s_add_u32 m0, s76, 81920
    s_nop 0
    buffer_load_dwordx4 v16, s[28:31], s79 offen lds
    s_add_u32 m0, s77, 81920
    s_nop 0
    buffer_load_dwordx4 v8, s[24:27], s78 offen lds
    s_add_u32 m0, s76, 82944
    s_nop 0
    buffer_load_dwordx4 v17, s[28:31], s79 offen lds
    s_add_u32 m0, s77, 82944
    s_nop 0
    buffer_load_dwordx4 v9, s[24:27], s78 offen lds
    s_waitcnt vmcnt(4)
    s_barrier
    buffer_load_dword v55, v54, s[40:43], 0 offen sc1
    s_add_u32 m0, s76, 83968
    s_nop 0
    buffer_load_dwordx4 v18, s[28:31], s79 offen lds
    s_add_u32 m0, s77, 83968
    s_nop 0
    buffer_load_dwordx4 v10, s[24:27], s78 offen lds
    s_add_u32 m0, s76, 84992
    s_nop 0
    buffer_load_dwordx4 v19, s[28:31], s79 offen lds
    s_add_u32 m0, s77, 84992
    s_nop 0
    buffer_load_dwordx4 v11, s[24:27], s78 offen lds
    s_add_u32 m0, s76, 86016
    s_nop 0
    buffer_load_dwordx4 v20, s[28:31], s79 offen lds
    s_add_u32 m0, s77, 86016
    s_nop 0
    buffer_load_dwordx4 v12, s[24:27], s78 offen lds
    s_add_u32 s78, s78, 128
    s_add_u32 s79, s79, 245760
    s_add_u32 m0, s76, 0
    s_nop 0
    buffer_load_dwordx4 v16, s[28:31], s79 offen lds
    s_add_u32 m0, s77, 0
    s_nop 0
    buffer_load_dwordx4 v8, s[24:27], s78 offen lds
    s_add_u32 m0, s76, 1024
    s_nop 0
    buffer_load_dwordx4 v17, s[28:31], s79 offen lds
    s_add_u32 m0, s77, 1024
    s_nop 0
    buffer_load_dwordx4 v9, s[24:27], s78 offen lds
    s_add_u32 m0, s76, 2048
    s_nop 0
    buffer_load_dwordx4 v18, s[28:31], s79 offen lds
    s_add_u32 m0, s77, 2048
    s_nop 0
    buffer_load_dwordx4 v10, s[24:27], s78 offen lds
    s_add_u32 m0, s76, 3072
    s_nop 0
    buffer_load_dwordx4 v19, s[28:31], s79 offen lds
    s_add_u32 m0, s77, 3072
    s_nop 0
    buffer_load_dwordx4 v11, s[24:27], s78 offen lds
    s_mov_b32 s23, 1
    s_mov_b64 exec, 0
    s_cmp_eq_u32 s56, 4
    s_cbranch_scc1 L_pad_5
    s_cmp_eq_u32 s56, 5
    s_cbranch_scc1 L_pad_3
    s_cmp_eq_u32 s56, 6
    s_cbranch_scc1 L_pad_4
    s_cmp_eq_u32 s56, 7
    s_cbranch_scc1 L_pad_0
L_padret_K:
    s_mov_b64 exec, -1
    s_waitcnt vmcnt(8)
    s_barrier
    s_add_u32 m0, s76, 4096
    s_nop 0
    buffer_load_dwordx4 v20, s[28:31], s79 offen lds
    s_add_u32 m0, s77, 4096
    s_nop 0
    buffer_load_dwordx4 v12, s[24:27], s78 offen lds
    s_add_u32 s78, s78, 128
    s_add_u32 s79, s79, 245760
    s_add_u32 m0, s76, 40960
    s_nop 0
    buffer_load_dwordx4 v16, s[28:31], s79 offen lds
    s_add_u32 m0, s77, 40960
    s_nop 0
    buffer_load_dwordx4 v8, s[24:27], s78 offen lds
    s_add_u32 m0, s76, 41984
    s_nop 0
    buffer_load_dwordx4 v17, s[28:31], s79 offen lds
    s_add_u32 m0, s77, 41984
    s_nop 0
    buffer_load_dwordx4 v9, s[24:27], s78 offen lds
    s_add_u32 m0, s76, 43008
    s_nop 0
    buffer_load_dwordx4 v18, s[28:31], s79 offen lds
    s_add_u32 m0, s77, 43008
    s_nop 0
    buffer_load_dwordx4 v10, s[24:27], s78 offen lds
    s_add_u32 m0, s76, 44032
    s_nop 0
    buffer_load_dwordx4 v19, s[28:31], s79 offen lds
    s_add_u32 m0, s77, 44032
    s_nop 0
    buffer_load_dwordx4 v11, s[24:27], s78 offen lds
    s_add_u32 m0, s76, 45056
    s_nop 0
    buffer_load_dwordx4 v20, s[28:31], s79 offen lds
    s_add_u32 m0, s77, 45056
    s_nop 0
    buffer_load_dwordx4 v12, s[24:27], s78 offen lds
    s_add_u32 s78, s78, 128
    s_add_u32 s79, s79, 245760
    v_cmp_ne_u32 vcc, v63, v55
    s_nop 1
    s_cmp_lg_u64 vcc, 0
    s_cbranch_scc1 pslow_72
pdone_73:
    ds_read_b32 v66, v61 offset:0
    ds_read_b32 v67, v61 offset:256
    ds_read_b32 v68, v61 offset:512
    ds_read_b32 v69, v61 offset:768
    ds_read_b32 v70, v61 offset:1024
    s_waitcnt lgkmcnt(0)
    v_add_f32 v66, v66, v67
    v_add_f32 v68, v68, v69
    v_add_f32 v66, v66, v68
    v_cmp_gt_u32 vcc, 64, v56
    s_nop 1
    v_cndmask_b32 v66, v70, v66, vcc
    buffer_store_dword v66, v60, s[36:39], 0 offen sc1
    s_waitcnt vmcnt(11)
    s_barrier
    s_add_u32 m0, s76, 81920
    s_nop 0
    buffer_load_dwordx4 v16, s[28:31], s79 offen lds
    s_add_u32 m0, s77, 81920
    s_nop 0
    buffer_load_dwordx4 v8, s[24:27], s78 offen lds
    s_add_u32 m0, s76, 82944
    s_nop 0
    buffer_load_dwordx4 v17, s[28:31], s79 offen lds
    s_add_u32 m0, s77, 82944
    s_nop 0
    buffer_load_dwordx4 v9, s[24:27], s78 offen lds
    s_add_u32 m0, s76, 83968
    s_nop 0
    buffer_load_dwordx4 v18, s[28:31], s79 offen lds
    s_add_u32 m0, s77, 83968
    s_nop 0
    buffer_load_dwordx4 v10, s[24:27], s78 offen lds
    s_add_u32 m0, s76, 84992
    s_nop 0
    buffer_load_dwordx4 v19, s[28:31], s79 offen lds
    s_add_u32 m0, s77, 84992
    s_nop 0
    buffer_load_dwordx4 v11, s[24:27], s78 offen lds
    s_add_u32 m0, s76, 86016
    s_nop 0
    buffer_load_dwordx4 v20, s[28:31], s79 offen lds
    s_add_u32 m0, s77, 86016
    s_nop 0
    buffer_load_dwordx4 v12, s[24:27], s78 offen lds
    s_add_u32 s78, s78, 128
    s_add_u32 s79, s79, 245760
    s_waitcnt vmcnt(11)
    s_barrier
    s_add_u32 m0, s76, 0
    s_nop 0
    buffer_load_dwordx4 v16, s[28:31], s79 offen lds
    s_add_u32 m0, s77, 0
    s_nop 0
    buffer_load_dwordx4 v8, s[24:27], s78 offen lds
    s_add_u32 m0, s76, 1024
    s_nop 0
    buffer_load_dwordx4 v17, s[28:31], s79 offen lds
    s_add_u32 m0, s77, 1024
    s_nop 0
    buffer_load_dwordx4 v9, s[24:27], s78 offen lds
    s_add_u32 m0, s76, 2048
    s_nop 0
    buffer_load_dwordx4 v18, s[28:31], s79 offen lds
    s_add_u32 m0, s77, 2048
    s_nop 0
    buffer_load_dwordx4 v10, s[24:27], s78 offen lds
    s_add_u32 m0, s76, 3072
    s_nop 0
    buffer_load_dwordx4 v19, s[28:31], s79 offen lds
    s_add_u32 m0, s77, 3072
    s_nop 0
    buffer_load_dwordx4 v11, s[24:27], s78 offen lds
    s_add_u32 m0, s76, 4096
    s_nop 0
    buffer_load_dwordx4 v20, s[28:31], s79 offen lds
    s_add_u32 m0, s77, 4096
    s_nop 0
    buffer_load_dwordx4 v12, s[24:27], s78 offen lds
    s_add_u32 s78, s78, 128
    s_add_u32 s79, s79, 245760
    s_waitcnt vmcnt(10)
    s_barrier
    s_add_u32 m0, s76, 40960
    s_nop 0
    buffer_load_dwordx4 v16, s[28:31], s79 offen lds
    s_add_u32 m0, s77, 40960
    s_nop 0
    buffer_load_dwordx4 v8, s[24:27], s78 offen lds
    s_add_u32 m0, s76, 41984
    s_nop 0
    buffer_load_dwordx4 v17, s[28:31], s79 offen lds
    s_add_u32 m0, s77, 41984
    s_nop 0
    buffer_load_dwordx4 v9, s[24:27], s78 offen lds
    s_add_u32 m0, s76, 43008
    s_nop 0
    buffer_load_dwordx4 v18, s[28:31], s79 offen lds
    s_add_u32 m0, s77, 43008
    s_nop 0
    buffer_load_dwordx4 v10, s[24:27], s78 offen lds
    s_add_u32 m0, s76, 44032
    s_nop 0
    buffer_load_dwordx4 v19, s[28:31], s79 offen lds
    s_add_u32 m0, s77, 44032
    s_nop 0
    buffer_load_dwordx4 v11, s[24:27], s78 offen lds
    s_add_u32 m0, s76, 45056
    s_nop 0
    buffer_load_dwordx4 v20, s[28:31], s79 offen lds
    s_add_u32 m0, s77, 45056
    s_nop 0
    buffer_load_dwordx4 v12, s[24:27], s78 offen lds
    s_add_u32 s78, s78, 128
    s_add_u32 s79, s79, 245760
    s_waitcnt vmcnt(10)
    s_barrier
    s_add_u32 m0, s76, 81920
    s_nop 0
    buffer_load_dwordx4 v16, s[28:31], s79 offen lds
    s_add_u32 m0, s77, 81920
    s_nop 0
    buffer_load_dwordx4 v8, s[24:27], s78 offen lds
    s_add_u32 m0, s76, 82944
    s_nop 0
    buffer_load_dwordx4 v17, s[28:31], s79 offen lds
    s_add_u32 m0, s77, 82944
    s_nop 0
    buffer_load_dwordx4 v9, s[24:27], s78 offen lds
    s_add_u32 m0, s76, 83968
    s_nop 0
    buffer_load_dwordx4 v18, s[28:31], s79 offen lds
    s_add_u32 m0, s77, 83968
    s_nop 0
    buffer_load_dwordx4 v10, s[24:27], s78 offen lds
    s_add_u32 m0, s76, 84992
    s_nop 0
    buffer_load_dwordx4 v19, s[28:31], s79 offen lds
    s_add_u32 m0, s77, 84992
    s_nop 0
    buffer_load_dwordx4 v11, s[24:27], s78 offen lds
    s_add_u32 m0, s76, 86016
    s_nop 0
    buffer_load_dwordx4 v20, s[28:31], s79 offen lds
    s_add_u32 m0, s77, 86016
    s_nop 0
    buffer_load_dwordx4 v12, s[24:27], s78 offen lds
    s_add_u32 s78, s78, 128
    s_add_u32 s79, s79, 245760
    s_waitcnt vmcnt(10)
    s_barrier
    buffer_load_dword v55, v62, s[40:43], 0 offen sc1
    buffer_load_dword v66, v57, s[36:39], 0 offen sc1
    buffer_load_dword v67, v57, s[36:39], s83 offen sc1
    buffer_load_dword v68, v58, s[36:39], 0 offen sc1
    buffer_load_dword v69, v58, s[36:39], s80 offen sc1
    buffer_load_dword v70, v58, s[36:39], s81 offen sc1
    buffer_load_dword v71, v58, s[36:39], s82 offen sc1
    s_add_u32 m0, s76, 0
    s_nop 0
    buffer_load_dwordx4 v16, s[28:31], s79 offen lds
    s_add_u32 m0, s77, 0
    s_nop 0
    buffer_load_dwordx4 v8, s[24:27], s78 offen lds
    s_add_u32 m0, s76, 1024
    s_nop 0
    buffer_load_dwordx4 v17, s[28:31], s79 offen lds
    s_add_u32 m0, s77, 1024
    s_nop 0
    buffer_load_dwordx4 v9, s[24:27], s78 offen lds
    s_add_u32 m0, s76, 2048
    s_nop 0
    buffer_load_dwordx4 v18, s[28:31], s79 offen lds
    s_add_u32 m0, s77, 2048
    s_nop 0
    buffer_load_dwordx4 v10, s[24:27], s78 offen lds
    s_add_u32 m0, s76, 3072
    s_nop 0
    buffer_load_dwordx4 v19, s[28:31], s79 offen lds
    s_add_u32 m0, s77, 3072
    s_nop 0
    buffer_load_dwordx4 v11, s[24:27], s78 offen lds
    s_add_u32 m0, s76, 4096
    s_nop 0
    buffer_load_dwordx4 v20, s[28:31], s79 offen lds
    s_add_u32 m0, s77, 4096
    s_nop 0
    buffer_load_dwordx4 v12, s[24:27], s78 offen lds
    s_add_u32 s78, s78, 128
    s_add_u32 s79, s79, 245760
    s_waitcnt vmcnt(17)
    s_barrier
    s_mov_b32 s74, 81920
    buffer_load_dwordx4 v[100:103], v92, s[44:47], s74 offen
    buffer_load_dwordx4 v[104:107], v93, s[44:47], s74 offen
    s_mov_b32 s74, 327680
    buffer_load_dwordx4 v[108:111], v92, s[44:47], s74 offen
    buffer_load_dwordx4 v[112:115], v93, s[44:47], s74 offen
    s_waitcnt vmcnt(14)
    v_cmp_ne_u32 vcc, v64, v55
    s_nop 1
    s_cmp_lg_u64 vcc, 0
    s_cbranch_scc1 pslow_75
pdone_76:
    s_mov_b32 s85, 200000
    s_branch tabc_78
tab_77:
    buffer_load_dword v66, v57, s[36:39], 0 offen sc1
    buffer_load_dword v67, v57, s[36:39], s83 offen sc1
    buffer_load_dword v68, v58, s[36:39], 0 offen sc1
    buffer_load_dword v69, v58, s[36:39], s80 offen sc1
    buffer_load_dword v70, v58, s[36:39], s81 offen sc1
    buffer_load_dword v71, v58, s[36:39], s82 offen sc1
    s_waitcnt vmcnt(0)
tabc_78:
    v_max_u32 v3, v66, v67
    v_max3_u32 v3, v3, v68, v69
    v_max3_u32 v3, v3, v70, v71
    v_cmp_eq_u32 vcc, -1, v3
    s_nop 1
    s_cmp_eq_u64 vcc, 0
    s_cbranch_scc1 tabd_79
    s_sleep 4
    s_sub_u32 s85, s85, 1
    s_cmp_lg_u32 s85, 0
    s_cbranch_scc1 tab_77
tabd_79:
    v_add_f32 v68, v68, v69
    v_add_f32 v70, v70, v71
    v_add_f32 v68, v68, v70
    v_lshlrev_b32 v3, 2, v56
    v_add_u32 v3, 160896, v3
    ds_write_b32 v3, v66
    ds_write_b32 v3, v67 offset:1024
    v_min_u32 v4, 192, v56
    v_lshlrev_b32 v4, 2, v4
    v_add_u32 v4, 162944, v4
    ds_write_b32 v4, v68
    s_waitcnt lgkmcnt(0)
    s_mov_b32 s74, 573440
    buffer_load_dwordx4 v[116:119], v92, s[44:47], s74 offen
    buffer_load_dwordx4 v[120:123], v93, s[44:47], s74 offen
    s_waitcnt vmcnt(6)
    s_barrier
    s_cmp_eq_u32 s63, 0
    s_cbranch_scc1 L_fin
    s_mov_b32 s76, s84
    s_mov_b32 s74, 819200
    s_waitcnt vmcnt(4)
    buffer_load_dwordx4 v[124:127], v92, s[44:47], s74 offen
    buffer_load_dwordx4 v[128:131], v93, s[44:47], s74 offen
    s_mov_b32 s74, 1064960
    s_waitcnt vmcnt(4)
    buffer_load_dwordx4 v[132:135], v92, s[44:47], s74 offen
    buffer_load_dwordx4 v[136:139], v93, s[44:47], s74 offen
    s_mov_b32 s74, 1310720
    s_waitcnt vmcnt(4)
    buffer_load_dwordx4 v[140:143], v92, s[44:47], s74 offen
    buffer_load_dwordx4 v[144:147], v93, s[44:47], s74 offen
    s_mov_b32 s74, 1556480
    s_waitcnt vmcnt(4)
    buffer_load_dwordx4 v[148:151], v92, s[44:47], s74 offen
    buffer_load_dwordx4 v[152:155], v93, s[44:47], s74 offen
    s_mov_b32 s74, 1802240
    s_waitcnt vmcnt(4)
    buffer_load_dwordx4 v[156:159], v92, s[44:47], s74 offen
    buffer_load_dwordx4 v[160:163], v93, s[44:47], s74 offen
    s_mov_b32 s74, 2048000
    s_waitcnt vmcnt(4)
    buffer_load_dwordx4 v[164:167], v92, s[44:47], s74 offen
    buffer_load_dwordx4 v[168:171], v93, s[44:47], s74 offen
    s_mov_b32 s74, 0
    s_waitcnt vmcnt(4)
    buffer_load_dwordx4 v[172:175], v94, s[48:51], s74 offen
    buffer_load_dwordx4 v[176:179], v95, s[48:51], s74 offen
    s_mov_b32 s74, 409600
    s_waitcnt vmcnt(4)
    buffer_load_dwordx4 v[180:183], v94, s[48:51], s74 offen
    buffer_load_dwordx4 v[184:187], v95, s[48:51], s74 offen
    s_mov_b32 s74, 40960
    s_waitcnt vmcnt(4)
    buffer_load_dwordx4 v[188:191], v94, s[48:51], s74 offen
    buffer_load_dwordx4 v[192:195], v95, s[48:51], s74 offen
    s_mov_b32 s74, 450560
    s_waitcnt vmcnt(4)
    buffer_load_dwordx4 v[196:199], v94, s[48:51], s74 offen
    buffer_load_dwordx4 v[200:203], v95, s[48:51], s74 offen
    s_mov_b32 s74, 81920
    s_waitcnt vmcnt(4)
    buffer_load_dwordx4 v[204:207], v94, s[48:51], s74 offen
    buffer_load_dwordx4 v[208:211], v95, s[48:51], s74 offen
    s_mov_b32 s74, 491520
    s_waitcnt vmcnt(4)
    buffer_load_dwordx4 v[212:215], v94, s[48:51], s74 offen
    buffer_load_dwordx4 v[216:219], v95, s[48:51], s74 offen
    s_mov_b32 s74, 122880
    s_waitcnt vmcnt(4)
    buffer_load_dwordx4 v[220:223], v94, s[48:51], s74 offen
    buffer_load_dwordx4 v[224:227], v95, s[48:51], s74 offen
    s_mul_i32 s73, s60, 96
    s_add_u32 s77, s73, 95
    s_min_u32 s77, s77, 2047
    v_mov_b32 v29, 163744
    v_mov_b32 v30, 1
    s_mov_b32 s74, 532480
    s_waitcnt vmcnt(4)
    buffer_load_dwordx4 v[228:231], v94, s[48:51], s74 offen
    buffer_load_dwordx4 v[232:235], v95, s[48:51], s74 offen
    s_mov_b32 s74, 163840
    s_waitcnt vmcnt(4)
    buffer_load_dwordx4 v[236:239], v94, s[48:51], s74 offen
    buffer_load_dwordx4 v[240:243], v95, s[48:51], s74 offen
    s_mov_b32 s74, 573440
    s_waitcnt vmcnt(4)
    buffer_load_dwordx4 v[244:247], v94, s[48:51], s74 offen
    buffer_load_dwordx4 v[248:251], v95, s[48:51], s74 offen
    s_mov_b32 s74, 0
    s_waitcnt vmcnt(4)
    s_add_u32 m0, s76, 49152
    s_nop 0
    buffer_load_dwordx4 v92, s[44:47], s74 offen lds
    s_add_u32 m0, s76, 50176
    s_nop 0
    buffer_load_dwordx4 v93, s[44:47], s74 offen lds
    s_mov_b32 s74, 245760
    s_waitcnt vmcnt(4)
    s_add_u32 m0, s76, 57344
    s_nop 0
    buffer_load_dwordx4 v92, s[44:47], s74 offen lds
    s_add_u32 m0, s76, 58368
    s_nop 0
    buffer_load_dwordx4 v93, s[44:47], s74 offen lds
    s_mov_b32 s74, 491520
    s_waitcnt vmcnt(4)
    s_add_u32 m0, s76, 65536
    s_nop 0
    buffer_load_dwordx4 v92, s[44:47], s74 offen lds
    s_add_u32 m0, s76, 66560
    s_nop 0
    buffer_load_dwordx4 v93, s[44:47], s74 offen lds
    s_mov_b32 s74, 737280
    s_waitcnt vmcnt(4)
    s_add_u32 m0, s76, 73728
    s_nop 0
    buffer_load_dwordx4 v92, s[44:47], s74 offen lds
    s_add_u32 m0, s76, 74752
    s_nop 0
    buffer_load_dwordx4 v93, s[44:47], s74 offen lds
    s_mov_b32 s74, 983040
    s_waitcnt vmcnt(4)
    s_add_u32 m0, s76, 81920
    s_nop 0
    buffer_load_dwordx4 v92, s[44:47], s74 offen lds
    s_add_u32 m0, s76, 82944
    s_nop 0
    buffer_load_dwordx4 v93, s[44:47], s74 offen lds
    s_mov_b32 s74, 1228800
    s_waitcnt vmcnt(4)
    s_add_u32 m0, s76, 90112
    s_nop 0
    buffer_load_dwordx4 v92, s[44:47], s74 offen lds
    s_add_u32 m0, s76, 91136
    s_nop 0
    buffer_load_dwordx4 v93, s[44:47], s74 offen lds
    s_mov_b32 s74, 1474560
    s_waitcnt vmcnt(4)
    s_add_u32 m0, s76, 98304
    s_nop 0
    buffer_load_dwordx4 v92, s[44:47], s74 offen lds
    s_add_u32 m0, s76, 99328
    s_nop 0
    buffer_load_dwordx4 v93, s[44:47], s74 offen lds
    s_mov_b32 s74, 1720320
    s_waitcnt vmcnt(4)
    s_add_u32 m0, s76, 106496
    s_nop 0
    buffer_load_dwordx4 v92, s[44:47], s74 offen lds
    s_add_u32 m0, s76, 107520
    s_nop 0
    buffer_load_dwordx4 v93, s[44:47], s74 offen lds
    s_mov_b32 s74, 1966080
    s_waitcnt vmcnt(4)
    s_add_u32 m0, s76, 114688
    s_nop 0
    buffer_load_dwordx4 v92, s[44:47], s74 offen lds
    s_add_u32 m0, s76, 115712
    s_nop 0
    buffer_load_dwordx4 v93, s[44:47], s74 offen lds
    s_waitcnt vmcnt(8)
    s_mov_b64 exec, 1
    ds_add_u32 v29, v30 offset:16
    s_mov_b64 exec, -1
    s_mov_b32 s74, 40960
    s_waitcnt vmcnt(4)
    s_add_u32 m0, s76, 122880
    s_nop 0
    buffer_load_dwordx4 v92, s[44:47], s74 offen lds
    s_add_u32 m0, s76, 123904
    s_nop 0
    buffer_load_dwordx4 v93, s[44:47], s74 offen lds
    s_mov_b32 s74, 286720
    s_waitcnt vmcnt(4)
    s_add_u32 m0, s76, 131072
    s_nop 0
    buffer_load_dwordx4 v92, s[44:47], s74 offen lds
    s_add_u32 m0, s76, 132096
    s_nop 0
    buffer_load_dwordx4 v93, s[44:47], s74 offen lds
    s_mov_b32 s74, 532480
    s_waitcnt vmcnt(4)
    s_add_u32 m0, s76, 139264
    s_nop 0
    buffer_load_dwordx4 v92, s[44:47], s74 offen lds
    s_add_u32 m0, s76, 140288
    s_nop 0
    buffer_load_dwordx4 v93, s[44:47], s74 offen lds
    ds_read_b32 v22, v29 offset:0
    s_waitcnt lgkmcnt(0)
    v_readfirstlane_b32 s85, v22
    s_nop 0
    s_cmp_lt_u32 s85, 256
    s_cbranch_scc1 lws_81
lwd_82:
    s_mov_b32 s74, 778240
    s_waitcnt vmcnt(4)
    s_add_u32 m0, s76, 0
    s_nop 0
    buffer_load_dwordx4 v92, s[44:47], s74 offen lds
    s_add_u32 m0, s76, 1024
    s_nop 0
    buffer_load_dwordx4 v93, s[44:47], s74 offen lds
    s_mov_b32 s74, 1024000
    s_waitcnt vmcnt(4)
    s_add_u32 m0, s76, 8192
    s_nop 0
    buffer_load_dwordx4 v92, s[44:47], s74 offen lds
    s_add_u32 m0, s76, 9216
    s_nop 0
    buffer_load_dwordx4 v93, s[44:47], s74 offen lds
    s_mov_b32 s74, 1269760
    s_waitcnt vmcnt(4)
    s_add_u32 m0, s76, 16384
    s_nop 0
    buffer_load_dwordx4 v92, s[44:47], s74 offen lds
    s_add_u32 m0, s76, 17408
    s_nop 0
    buffer_load_dwordx4 v93, s[44:47], s74 offen lds
    s_mov_b32 s74, 1515520
    s_waitcnt vmcnt(4)
    s_add_u32 m0, s76, 24576
    s_nop 0
    buffer_load_dwordx4 v92, s[44:47], s74 offen lds
    s_add_u32 m0, s76, 25600
    s_nop 0
    buffer_load_dwordx4 v93, s[44:47], s74 offen lds
    s_mov_b32 s74, 1761280
    s_waitcnt vmcnt(4)
    s_add_u32 m0, s76, 32768
    s_nop 0
    buffer_load_dwordx4 v92, s[44:47], s74 offen lds
    s_add_u32 m0, s76, 33792
    s_nop 0
    buffer_load_dwordx4 v93, s[44:47], s74 offen lds
    s_mov_b32 s74, 2007040
    s_waitcnt vmcnt(4)
    s_add_u32 m0, s76, 40960
    s_nop 0
    buffer_load_dwordx4 v92, s[44:47], s74 offen lds
    s_add_u32 m0, s76, 41984
    s_nop 0
    buffer_load_dwordx4 v93, s[44:47], s74 offen lds
    s_mul_i32 s75, s72, 24
    s_add_u32 s75, s75, s73
    s_mul_i32 s75, s75, 1280
    s_lshl_b32 s81, s61, 7
    s_add_u32 s75, s75, s81
    v_mul_u32_u24 v26, 1280, v1
    v_xor_b32 v22, v1, v2
    v_lshl_add_u32 v26, v22, 4, v26
    v_add_u32 v26, s75, v26
    s_lshr_b32 s73, s73, 8
    s_lshr_b32 s77, s77, 8
    v_mov_b32 v23, s73
    v_mov_b32 v25, s77
    v_cmp_gt_u32 vcc, 4, v2
    s_nop 1
    v_cndmask_b32 v23, v25, v23, vcc
    v_and_b32 v22, 3, v0
    v_lshl_add_u32 v22, v23, 2, v22
    v_lshlrev_b32 v22, 10, v22
    v_min_u32 v23, 4, v1
    v_lshl_add_u32 v22, v23, 7, v22
    v_add_u32 v25, 294912, v22
    s_lshl_b32 s73, s72, 11
    v_lshl_add_u32 v24, v0, 4, s73
    v_add_u32 v27, 65536, v24
    v_add_u32 v28, 131072, v24
    s_waitcnt vmcnt(12)
    s_barrier
    ds_write_b128 v24, v[100:103] offset:49152
    ds_write_b128 v24, v[104:107] offset:50176
    ds_write_b128 v24, v[108:111] offset:57344
    ds_write_b128 v24, v[112:115] offset:58368
    ds_write_b128 v27, v[116:119] offset:0
    ds_write_b128 v27, v[120:123] offset:1024
    ds_write_b128 v27, v[124:127] offset:8192
    ds_write_b128 v27, v[128:131] offset:9216
    ds_write_b128 v27, v[132:135] offset:16384
    ds_write_b128 v27, v[136:139] offset:17408
    s_waitcnt vmcnt(0)
    s_waitcnt lgkmcnt(0)
    s_barrier
    ds_write_b128 v27, v[140:143] offset:24576
    ds_write_b128 v27, v[144:147] offset:25600
    ds_write_b128 v27, v[148:151] offset:32768
    ds_write_b128 v27, v[152:155] offset:33792
    ds_write_b128 v27, v[156:159] offset:40960
    ds_write_b128 v27, v[160:163] offset:41984
    ds_write_b128 v27, v[164:167] offset:49152
    ds_write_b128 v27, v[168:171] offset:50176
    ds_write_b128 v27, v[172:175] offset:57344
    ds_write_b128 v27, v[176:179] offset:58368
    ds_write_b128 v28, v[180:183] offset:0
    ds_write_b128 v28, v[184:187] offset:1024
    ds_write_b128 v28, v[188:191] offset:8192
    ds_write_b128 v28, v[192:195] offset:9216
    s_waitcnt vmcnt(0) lgkmcnt(0)
    s_mov_b32 s73, 0
    v_mov_b32 v32, 0
    s_barrier
    s_cmp_lg_u32 s56, 7
    s_cbranch_scc1 o1_86
    s_lshl_b32 s75, s73, 3
    s_bfm_b64 exec, 8, s75
    s_and_b32 exec_hi, exec_hi, 0xff
    buffer_load_dword v32, v25, s[36:39], 0 offen sc1
    s_mov_b64 exec, -1
    s_waitcnt vmcnt(0)
    v_cmp_ne_u32 vcc, 1, v32
    s_nop 1
    s_ff1_i32_b64 s73, vcc
    s_lshr_b32 s73, s73, 3
    v_mov_b32 v23, s73
    s_mov_b64 exec, 1
    ds_max_u32 v29, v23 offset:12
    s_mov_b64 exec, -1
    s_min_u32 s73, s73, 4
    s_lshl_b32 s75, s73, 3
    s_bfm_b64 exec, 16, s75
    s_and_b32 exec_hi, exec_hi, 0xff
    buffer_load_dword v32, v25, s[36:39], 0 offen sc1
    s_mov_b64 exec, -1
o1_86:
    s_mul_i32 s81, s72, 3072
    s_mov_b32 s77, 0
    s_add_u32 m0, s81, 147456
    s_nop 0
    buffer_load_dwordx4 v26, s[24:27], s77 offen lds
    s_add_u32 s77, s77, 10240
    s_add_u32 m0, s81, 148480
    s_nop 0
    buffer_load_dwordx4 v26, s[24:27], s77 offen lds
    s_add_u32 s77, s77, 10240
    s_add_u32 m0, s81, 149504
    s_nop 0
    buffer_load_dwordx4 v26, s[24:27], s77 offen lds
    s_add_u32 s77, s77, 10240
    ds_write_b128 v24, v[196:199] offset:0
    ds_write_b128 v24, v[200:203] offset:1024
    ds_write_b128 v24, v[204:207] offset:8192
    ds_write_b128 v24, v[208:211] offset:9216
    ds_write_b128 v24, v[212:215] offset:16384
    ds_write_b128 v24, v[216:219] offset:17408
    ds_write_b128 v24, v[220:223] offset:24576
    ds_write_b128 v24, v[224:227] offset:25600
    ds_write_b128 v24, v[228:231] offset:32768
    ds_write_b128 v24, v[232:235] offset:33792
    ds_write_b128 v24, v[236:239] offset:40960
    ds_write_b128 v24, v[240:243] offset:41984
    ds_write_b128 v24, v[244:247] offset:49152
    ds_write_b128 v24, v[248:251] offset:50176
    s_waitcnt lgkmcnt(0)
    s_cmp_lg_u32 s56, 7
    s_cbranch_scc1 oo_85
    s_mov_b32 s85, 200000
op_83:
    s_waitcnt vmcnt(0)
    v_cmp_ne_u32 vcc, 1, v32
    s_nop 1
    s_ff1_i32_b64 s73, vcc
    s_lshr_b32 s73, s73, 3
    v_mov_b32 v23, s73
    s_mov_b64 exec, 1
    ds_max_u32 v29, v23 offset:12
    s_mov_b64 exec, -1
    s_mov_b64 exec, 1
    ds_add_u32 v29, v30 offset:72
    s_mov_b64 exec, -1
    v_mov_b32 v30, 0
    s_cmp_ge_u32 s73, 5
    s_cbranch_scc1 od_84
    s_sleep 2
    s_lshl_b32 s75, s73, 3
    s_bfm_b64 exec, 16, s75
    s_and_b32 exec_hi, exec_hi, 0xff
    buffer_load_dword v32, v25, s[36:39], 0 offen sc1
    s_mov_b64 exec, -1
    s_sub_u32 s85, s85, 1
    s_cmp_lg_u32 s85, 0
    s_cbranch_scc1 op_83
    s_branch od_84
oo_85:
    s_waitcnt vmcnt(0)
    s_mov_b64 exec, 1
    ds_add_u32 v29, v30 offset:72
    s_mov_b64 exec, -1
od_84:
    s_branch L_fin
pslow_72:
    s_mov_b32 s85, 200000
poll_71:
    s_sleep 8
    buffer_load_dword v55, v54, s[40:43], 0 offen sc1
    s_waitcnt vmcnt(0)
    v_cmp_ne_u32 vcc, v63, v55
    s_nop 1
    s_cmp_eq_u64 vcc, 0
    s_cbranch_scc1 pdone_73
    s_sub_u32 s85, s85, 1
    s_cmp_lg_u32 s85, 0
    s_cbranch_scc1 poll_71
    s_branch pdone_73
pslow_75:
    s_mov_b32 s85, 200000
poll_74:
    s_sleep 8
    buffer_load_dword v55, v62, s[40:43], 0 offen sc1
    s_waitcnt vmcnt(0)
    v_cmp_ne_u32 vcc, v64, v55
    s_nop 1
    s_cmp_eq_u64 vcc, 0
    s_cbranch_scc1 pdone_76
    s_sub_u32 s85, s85, 1
    s_cmp_lg_u32 s85, 0
    s_cbranch_scc1 poll_74
    s_branch pdone_76
lws_81:
    s_mov_b32 s84, 1600000
lw_80:
    s_sleep 1
    ds_read_b32 v22, v29 offset:0
    s_waitcnt lgkmcnt(0)
    v_readfirstlane_b32 s85, v22
    s_nop 0
    s_cmp_ge_u32 s85, 256
    s_cbranch_scc1 lwd_82
    s_sub_u32 s84, s84, 1
    s_cmp_lg_u32 s84, 0
    s_cbranch_scc1 lw_80
    s_branch lwd_82
.p2align 12
L_lQ:
    v_add_u32 v13, 20480, v11
    s_add_u32 m0, s77, 5120
    s_nop 0
    buffer_load_dwordx4 v13, s[24:27], 0 offen lds
    v_add_u32 v14, 20480, v12
    s_add_u32 m0, s77, 6144
    s_nop 0
    buffer_load_dwordx4 v14, s[24:27], 0 offen lds
    v_add_u32 v15, 20480, v13
    s_add_u32 m0, s77, 7168
    s_nop 0
    buffer_load_dwordx4 v15, s[24:27], 0 offen lds
    s_mov_b32 s28, s6
    s_mov_b32 s29, s7
    s_mov_b32 s30, 2457600
    s_mov_b32 s31, 0x20000
    s_mul_i32 s76, s72, 5120
    s_add_u32 s76, s76, 32768
    s_mul_i32 s74, s59, 320
    s_mul_i32 s73, s72, 61440
    s_add_u32 s74, s74, s73
    v_add_u32 v3, 0, v0
    v_mul_u32_u24 v4, 52429, v3
    v_lshrrev_b32 v4, 20, v4
    v_mul_u32_u24 v5, 20, v4
    v_sub_u32 v3, v3, v5
    v_lshrrev_b32 v5, 2, v4
    v_and_b32 v5, 2, v5
    v_xor_b32 v3, v3, v5
    v_mul_u32_u24 v4, 3840, v4
    v_lshl_add_u32 v4, v3, 4, v4
    v_add_u32 v16, s74, v4
    s_add_u32 m0, s76, 0
    s_nop 0
    buffer_load_dwordx4 v16, s[28:31], 0 offen lds
    v_add_u32 v3, 64, v0
    v_mul_u32_u24 v4, 52429, v3
    v_lshrrev_b32 v4, 20, v4
    v_mul_u32_u24 v5, 20, v4
    v_sub_u32 v3, v3, v5
    v_lshrrev_b32 v5, 2, v4
    v_and_b32 v5, 2, v5
    v_xor_b32 v3, v3, v5
    v_mul_u32_u24 v4, 3840, v4
    v_lshl_add_u32 v4, v3, 4, v4
    v_add_u32 v17, s74, v4
    s_add_u32 m0, s76, 1024
    s_nop 0
    buffer_load_dwordx4 v17, s[28:31], 0 offen lds
    v_add_u32 v3, 128, v0
    v_mul_u32_u24 v4, 52429, v3
    v_lshrrev_b32 v4, 20, v4
    v_mul_u32_u24 v5, 20, v4
    v_sub_u32 v3, v3, v5
    v_lshrrev_b32 v5, 2, v4
    v_and_b32 v5, 2, v5
    v_xor_b32 v3, v3, v5
    v_mul_u32_u24 v4, 3840, v4
    v_lshl_add_u32 v4, v3, 4, v4
    v_add_u32 v18, s74, v4
    s_add_u32 m0, s76, 2048
    s_nop 0
    buffer_load_dwordx4 v18, s[28:31], 0 offen lds
    v_add_u32 v3, 192, v0
    v_mul_u32_u24 v4, 52429, v3
    v_lshrrev_b32 v4, 20, v4
    v_mul_u32_u24 v5, 20, v4
    v_sub_u32 v3, v3, v5
    v_lshrrev_b32 v5, 2, v4
    v_and_b32 v5, 2, v5
    v_xor_b32 v3, v3, v5
    v_mul_u32_u24 v4, 3840, v4
    v_lshl_add_u32 v4, v3, 4, v4
    v_add_u32 v19, s74, v4
    s_add_u32 m0, s76, 3072
    s_nop 0
    buffer_load_dwordx4 v19, s[28:31], 0 offen lds
    v_add_u32 v3, 256, v0
    v_mul_u32_u24 v4, 52429, v3
    v_lshrrev_b32 v4, 20, v4
    v_mul_u32_u24 v5, 20, v4
    v_sub_u32 v3, v3, v5
    v_lshrrev_b32 v5, 2, v4
    v_and_b32 v5, 2, v5
    v_xor_b32 v3, v3, v5
    v_mul_u32_u24 v4, 3840, v4
    v_lshl_add_u32 v4, v3, 4, v4
    v_add_u32 v20, s74, v4
    s_add_u32 m0, s76, 4096
    s_nop 0
    buffer_load_dwordx4 v20, s[28:31], 0 offen lds
    s_mov_b32 s78, 128
    s_mov_b32 s79, 245760
    s_bfe_u32 s70, s2, 0x20002
    s_and_b32 s73, s2, 3
    s_lshr_b32 s74, s2, 4
    s_sub_u32 s74, s74, 6
    s_mul_i32 s75, s74, 86
    s_lshr_b32 s75, s75, 8
    s_mul_i32 s75, s75, 7
    s_lshr_b32 s69, s74, 1
    s_lshl3_add_u32 s69, s69, 3
    s_bitcmp1_b32 s2, 0
    s_cselect_b32 s69, s69, s75
    s_add_u32 s69, s69, s74
    s_lshr_b32 s75, s73, 1
    s_mul_i32 s75, s75, 5
    s_add_u32 s69, s69, s75
    s_add_u32 s75, s74, s73
    s_add_u32 s75, s75, 47
    s_cmp_ge_u32 s69, 30
    s_cselect_b32 s69, s75, s69
    s_lshl_b32 s75, s73, 2
    s_lshr_b32 s75, 0x7989, s75
    s_and_b32 s75, s75, 15
    s_cmp_lt_i32 s74, s75
    s_cselect_b32 s70, s70, 4
    s_mul_i32 s75, s73, 6
    s_add_u32 s75, s75, s74
    s_add_u32 s75, s75, 36
    s_cmp_lt_i32 s74, 0
    s_cselect_b32 s69, s75, s69
    s_add_u32 m0, s76, 53248
    s_nop 0
    buffer_load_dwordx4 v16, s[28:31], s79 offen lds
    s_add_u32 m0, s77, 53248
    s_nop 0
    buffer_load_dwordx4 v8, s[24:27], s78 offen lds
    s_add_u32 m0, s76, 54272
    s_nop 0
    buffer_load_dwordx4 v17, s[28:31], s79 offen lds
    s_add_u32 m0, s77, 54272
    s_nop 0
    buffer_load_dwordx4 v9, s[24:27], s78 offen lds
    s_add_u32 s36, s20, 10485760
    s_addc_u32 s37, s21, 0
    s_mov_b32 s38, 393216
    s_mov_b32 s39, 0x20000
    s_mov_b32 s40, s18
    s_mov_b32 s41, s19
    s_mov_b32 s42, 256
    s_mov_b32 s43, 0x20000
    s_mov_b32 s44, s14
    s_mov_b32 s45, s15
    s_mov_b32 s46, 2211840
    s_mov_b32 s47, 0x20000
    s_mov_b32 s48, s8
    s_mov_b32 s49, s9
    s_mov_b32 s50, 819200
    s_mov_b32 s51, 0x20000
    s_and_b32 s73, s2, 7
    s_lshl_b32 s68, s73, 8
    s_and_b32 s73, s2, 0xf8
    s_add_u32 s68, s68, s73
    v_min_u32 v54, 2, v0
    v_lshlrev_b32 v54, 4, v54
    s_cmp_eq_u32 s72, 3
    s_cselect_b32 s73, 64, 2130706432
    s_cselect_b32 s74, 1, 0
    v_add3_u32 v62, s73, v54, 64
    v_mov_b32 v64, s74
    s_cmp_lt_u32 s72, 2
    s_cselect_b32 s73, 64, 2130706432
    s_cselect_b32 s74, 1, 0
    v_add_u32 v54, s73, v54
    v_mov_b32 v63, s74
    s_lshl_b32 s73, s72, 6
    v_add_u32 v56, s73, v0
    v_mov_b32 v59, 2130706432
    s_mul_i32 s73, s70, 14592
    s_lshl_b32 s74, s69, 8
    s_add_u32 s73, s73, s74
    s_add_u32 s73, s73, 16384
    s_cmp_lt_u32 s70, 4
    s_cselect_b32 s73, s73, 2130706432
    v_lshl_add_u32 v60, v0, 2, s73
    v_lshlrev_b32 v3, 13, v1
    v_add_u32 v4, s68, v2
    v_lshl_add_u32 v3, v4, 2, v3
    v_cmp_gt_u32 vcc, 64, v56
    s_nop 1
    v_cndmask_b32 v60, v3, v60, vcc
    v_cmp_gt_u32 vcc, 80, v56
    s_nop 1
    v_cndmask_b32 v60, v59, v60, vcc
    v_lshlrev_b32 v61, 2, v0
    v_add_u32 v61, 159744, v61
    v_add_u32 v3, s58, v56
    v_lshlrev_b32 v57, 2, v3
    v_cmp_gt_u32 vcc, 2048, v3
    s_nop 1
    v_cndmask_b32 v57, v59, v57, vcc
    v_cmp_gt_u32 vcc, 256, v56
    s_nop 1
    v_cndmask_b32 v57, v59, v57, vcc
    s_mul_i32 s73, s59, 160
    v_add_u32 v3, s73, v56
    v_lshlrev_b32 v58, 2, v3
    v_add_u32 v58, 16384, v58
    v_cmp_gt_u32 vcc, 160, v56
    s_nop 1
    v_cndmask_b32 v58, v59, v58, vcc
    s_mov_b32 s80, 14592
    s_mov_b32 s81, 29184
    s_mov_b32 s82, 43776
    s_mov_b32 s83, 8192
    v_mov_b32 v120, 2130706432
    v_mov_b32 v121, 28672
    v_add_u32 v108, 0, v56
    v_lshlrev_b32 v104, 4, v108
    v_mul_u32_u24 v109, 9987, v108
    v_lshrrev_b32 v109, 20, v109
    v_mul_u32_u24 v114, 105, v109
    v_sub_u32 v110, v108, v114
    v_mul_u32_u24 v111, 209716, v110
    v_lshrrev_b32 v111, 20, v111
    v_mul_u32_u24 v114, 5, v111
    v_sub_u32 v112, v110, v114
    v_mul_u32_u24 v113, 20, v109
    v_lshl_add_u32 v113, v112, 2, v113
    v_bfe_u32 v114, v113, 2, 2
    v_lshlrev_b32 v114, 8, v114
    v_bfe_u32 v115, v113, 4, 1
    v_lshl_add_u32 v114, v115, 3, v114
    v_lshrrev_b32 v113, 5, v113
    v_lshrrev_b32 v115, 2, v109
    v_add3_u32 v115, v115, v113, 20
    v_lshl_add_u32 v116, v115, 10, v114
    v_and_b32 v115, 3, v109
    v_lshl_add_u32 v116, v115, 4, v116
    v_mul_u32_u24 v115, 20, v109
    v_add_u32 v115, v115, v111
    v_and_b32 v113, 1, v113
    v_lshl_add_u32 v114, v113, 10, v114
    v_lshrrev_b32 v113, 4, v115
    v_lshl_add_u32 v114, v113, 11, v114
    v_and_b32 v115, 15, v115
    v_lshl_add_u32 v100, v115, 4, v114
    v_cmp_eq_u32 vcc, 20, v111
    s_nop 1
    v_cndmask_b32 v100, v100, v116, vcc
    v_add_u32 v108, 256, v56
    v_lshlrev_b32 v105, 4, v108
    v_mul_u32_u24 v109, 9987, v108
    v_lshrrev_b32 v109, 20, v109
    v_mul_u32_u24 v114, 105, v109
    v_sub_u32 v110, v108, v114
    v_mul_u32_u24 v111, 209716, v110
    v_lshrrev_b32 v111, 20, v111
    v_mul_u32_u24 v114, 5, v111
    v_sub_u32 v112, v110, v114
    v_mul_u32_u24 v113, 20, v109
    v_lshl_add_u32 v113, v112, 2, v113
    v_bfe_u32 v114, v113, 2, 2
    v_lshlrev_b32 v114, 8, v114
    v_bfe_u32 v115, v113, 4, 1
    v_lshl_add_u32 v114, v115, 3, v114
    v_lshrrev_b32 v113, 5, v113
    v_lshrrev_b32 v115, 2, v109
    v_add3_u32 v115, v115, v113, 20
    v_lshl_add_u32 v116, v115, 10, v114
    v_and_b32 v115, 3, v109
    v_lshl_add_u32 v116, v115, 4, v116
    v_mul_u32_u24 v115, 20, v109
    v_add_u32 v115, v115, v111
    v_and_b32 v113, 1, v113
    v_lshl_add_u32 v114, v113, 10, v114
    v_lshrrev_b32 v113, 4, v115
    v_lshl_add_u32 v114, v113, 11, v114
    v_and_b32 v115, 15, v115
    v_lshl_add_u32 v101, v115, 4, v114
    v_cmp_eq_u32 vcc, 20, v111
    s_nop 1
    v_cndmask_b32 v101, v101, v116, vcc
    v_add_u32 v108, 512, v56
    v_lshlrev_b32 v106, 4, v108
    v_mul_u32_u24 v109, 9987, v108
    v_lshrrev_b32 v109, 20, v109
    v_mul_u32_u24 v114, 105, v109
    v_sub_u32 v110, v108, v114
    v_mul_u32_u24 v111, 209716, v110
    v_lshrrev_b32 v111, 20, v111
    v_mul_u32_u24 v114, 5, v111
    v_sub_u32 v112, v110, v114
    v_mul_u32_u24 v113, 20, v109
    v_lshl_add_u32 v113, v112, 2, v113
    v_bfe_u32 v114, v113, 2, 2
    v_lshlrev_b32 v114, 8, v114
    v_bfe_u32 v115, v113, 4, 1
    v_lshl_add_u32 v114, v115, 3, v114
    v_lshrrev_b32 v113, 5, v113
    v_lshrrev_b32 v115, 2, v109
    v_add3_u32 v115, v115, v113, 20
    v_lshl_add_u32 v116, v115, 10, v114
    v_and_b32 v115, 3, v109
    v_lshl_add_u32 v116, v115, 4, v116
    v_mul_u32_u24 v115, 20, v109
    v_add_u32 v115, v115, v111
    v_and_b32 v113, 1, v113
    v_lshl_add_u32 v114, v113, 10, v114
    v_lshrrev_b32 v113, 4, v115
    v_lshl_add_u32 v114, v113, 11, v114
    v_and_b32 v115, 15, v115
    v_lshl_add_u32 v102, v115, 4, v114
    v_cmp_eq_u32 vcc, 20, v111
    s_nop 1
    v_cndmask_b32 v102, v102, v116, vcc
    v_add_u32 v108, 768, v56
    v_subrev_u32 v114, 800, v108
    v_mul_u32_u24 v117, 26215, v114
    v_lshrrev_b32 v117, 20, v117
    v_mul_u32_u24 v115, 40, v117
    v_sub_u32 v114, v114, v115
    v_mul_u32_u24 v109, 209716, v114
    v_lshrrev_b32 v109, 20, v109
    v_mul_u32_u24 v115, 100, v109
    v_add_u32 v114, v114, v115
    v_add_u32 v114, 100, v114
    v_mov_b32 v110, v108
    v_cmp_gt_u32 vcc, 840, v108
    s_nop 1
    v_cndmask_b32 v108, v114, v108, vcc
    v_cndmask_b32 v117, v117, 0, vcc
    v_cmp_gt_u32 vcc, 960, v110
    s_nop 1
    v_cndmask_b32 v108, 0, v108, vcc
    v_cndmask_b32 v118, 0, 1, vcc
    v_lshlrev_b32 v107, 4, v108
    v_mul_u32_u24 v109, 9987, v108
    v_lshrrev_b32 v109, 20, v109
    v_mul_u32_u24 v114, 105, v109
    v_sub_u32 v110, v108, v114
    v_mul_u32_u24 v111, 209716, v110
    v_lshrrev_b32 v111, 20, v111
    v_mul_u32_u24 v114, 5, v111
    v_sub_u32 v112, v110, v114
    v_mul_u32_u24 v113, 20, v109
    v_lshl_add_u32 v113, v112, 2, v113
    v_bfe_u32 v114, v113, 2, 2
    v_lshlrev_b32 v114, 8, v114
    v_bfe_u32 v115, v113, 4, 1
    v_lshl_add_u32 v114, v115, 3, v114
    v_lshrrev_b32 v113, 5, v113
    v_lshrrev_b32 v115, 2, v109
    v_add3_u32 v115, v115, v113, 20
    v_lshl_add_u32 v116, v115, 10, v114
    v_and_b32 v115, 3, v109
    v_lshl_add_u32 v116, v115, 4, v116
    v_lshl_add_u32 v116, v117, 6, v116
    v_mul_u32_u24 v115, 20, v109
    v_add_u32 v115, v115, v111
    v_and_b32 v113, 1, v113
    v_lshl_add_u32 v114, v113, 10, v114
    v_lshrrev_b32 v113, 4, v115
    v_lshl_add_u32 v114, v113, 11, v114
    v_and_b32 v115, 15, v115
    v_lshl_add_u32 v103, v115, 4, v114
    v_cmp_eq_u32 vcc, 20, v111
    s_nop 1
    v_cndmask_b32 v103, v103, v116, vcc
    v_cmp_eq_u32 vcc, 1, v118
    s_nop 1
    v_cndmask_b32 v103, v121, v103, vcc
    v_cndmask_b32 v107, v120, v107, vcc
    v_min_u32 v114, 25, v0
    v_lshrrev_b32 v115, 1, v114
    v_and_b32 v114, 1, v114
    v_lshl_add_u32 v114, v115, 3, v114
    s_lshl_b32 s73, s59, 1
    v_add_u32 v114, s73, v114
    v_lshlrev_b32 v114, 7, v114
    v_add_u32 v114, 262144, v114
    v_lshlrev_b32 v115, 4, v56
    v_add_u32 v115, 53248, v115
    s_waitcnt vmcnt(4)
    s_barrier
    s_add_u32 m0, s76, 55296
    s_nop 0
    buffer_load_dwordx4 v18, s[28:31], s79 offen lds
    s_add_u32 m0, s77, 55296
    s_nop 0
    buffer_load_dwordx4 v10, s[24:27], s78 offen lds
    s_add_u32 m0, s76, 56320
    s_nop 0
    buffer_load_dwordx4 v19, s[28:31], s79 offen lds
    s_add_u32 m0, s77, 56320
    s_nop 0
    buffer_load_dwordx4 v11, s[24:27], s78 offen lds
    s_add_u32 m0, s76, 57344
    s_nop 0
    buffer_load_dwordx4 v20, s[28:31], s79 offen lds
    s_add_u32 m0, s77, 57344
    s_nop 0
    buffer_load_dwordx4 v12, s[24:27], s78 offen lds
    s_add_u32 m0, s77, 58368
    s_nop 0
    buffer_load_dwordx4 v13, s[24:27], s78 offen lds
    s_add_u32 m0, s77, 59392
    s_nop 0
    buffer_load_dwordx4 v14, s[24:27], s78 offen lds
    s_add_u32 m0, s77, 60416
    s_nop 0
    buffer_load_dwordx4 v15, s[24:27], s78 offen lds
    s_add_u32 s78, s78, 128
    s_add_u32 s79, s79, 245760
    s_add_u32 m0, s76, 106496
    s_nop 0
    buffer_load_dwordx4 v16, s[28:31], s79 offen lds
    s_add_u32 m0, s77, 106496
    s_nop 0
    buffer_load_dwordx4 v8, s[24:27], s78 offen lds
    s_add_u32 m0, s76, 107520
    s_nop 0
    buffer_load_dwordx4 v17, s[28:31], s79 offen lds
    s_add_u32 m0, s77, 107520
    s_nop 0
    buffer_load_dwordx4 v9, s[24:27], s78 offen lds
    s_waitcnt vmcnt(4)
    s_barrier
    buffer_load_dword v55, v54, s[40:43], 0 offen sc1
    s_add_u32 m0, s76, 108544
    s_nop 0
    buffer_load_dwordx4 v18, s[28:31], s79 offen lds
    s_add_u32 m0, s77, 108544
    s_nop 0
    buffer_load_dwordx4 v10, s[24:27], s78 offen lds
    s_add_u32 m0, s76, 109568
    s_nop 0
    buffer_load_dwordx4 v19, s[28:31], s79 offen lds
    s_add_u32 m0, s77, 109568
    s_nop 0
    buffer_load_dwordx4 v11, s[24:27], s78 offen lds
    s_add_u32 m0, s76, 110592
    s_nop 0
    buffer_load_dwordx4 v20, s[28:31], s79 offen lds
    s_add_u32 m0, s77, 110592
    s_nop 0
    buffer_load_dwordx4 v12, s[24:27], s78 offen lds
    s_add_u32 m0, s77, 111616
    s_nop 0
    buffer_load_dwordx4 v13, s[24:27], s78 offen lds
    s_add_u32 m0, s77, 112640
    s_nop 0
    buffer_load_dwordx4 v14, s[24:27], s78 offen lds
    s_add_u32 m0, s77, 113664
    s_nop 0
    buffer_load_dwordx4 v15, s[24:27], s78 offen lds
    s_add_u32 s78, s78, 128
    s_add_u32 s79, s79, 245760
    s_add_u32 m0, s76, 0
    s_nop 0
    buffer_load_dwordx4 v16, s[28:31], s79 offen lds
    s_add_u32 m0, s77, 0
    s_nop 0
    buffer_load_dwordx4 v8, s[24:27], s78 offen lds
    s_add_u32 m0, s76, 1024
    s_nop 0
    buffer_load_dwordx4 v17, s[28:31], s79 offen lds
    s_add_u32 m0, s77, 1024
    s_nop 0
    buffer_load_dwordx4 v9, s[24:27], s78 offen lds
    s_add_u32 m0, s76, 2048
    s_nop 0
    buffer_load_dwordx4 v18, s[28:31], s79 offen lds
    s_add_u32 m0, s77, 2048
    s_nop 0
    buffer_load_dwordx4 v10, s[24:27], s78 offen lds
    s_add_u32 m0, s76, 3072
    s_nop 0
    buffer_load_dwordx4 v19, s[28:31], s79 offen lds
    s_add_u32 m0, s77, 3072
    s_nop 0
    buffer_load_dwordx4 v11, s[24:27], s78 offen lds
    s_mov_b32 s23, 2
    s_mov_b64 exec, 0
    s_cmp_eq_u32 s56, 4
    s_cbranch_scc1 L_pad_6
    s_cmp_eq_u32 s56, 5
    s_cbranch_scc1 L_pad_7
    s_cmp_eq_u32 s56, 6
    s_cbranch_scc1 L_padret_Q
    s_cmp_eq_u32 s56, 7
    s_cbranch_scc1 L_padret_Q
L_padret_Q:
    s_mov_b64 exec, -1
    s_waitcnt vmcnt(8)
    s_barrier
    s_add_u32 m0, s76, 4096
    s_nop 0
    buffer_load_dwordx4 v20, s[28:31], s79 offen lds
    s_add_u32 m0, s77, 4096
    s_nop 0
    buffer_load_dwordx4 v12, s[24:27], s78 offen lds
    s_add_u32 m0, s77, 5120
    s_nop 0
    buffer_load_dwordx4 v13, s[24:27], s78 offen lds
    s_add_u32 m0, s77, 6144
    s_nop 0
    buffer_load_dwordx4 v14, s[24:27], s78 offen lds
    s_add_u32 m0, s77, 7168
    s_nop 0
    buffer_load_dwordx4 v15, s[24:27], s78 offen lds
    s_add_u32 s78, s78, 128
    s_add_u32 s79, s79, 245760
    s_add_u32 m0, s76, 53248
    s_nop 0
    buffer_load_dwordx4 v16, s[28:31], s79 offen lds
    s_add_u32 m0, s77, 53248
    s_nop 0
    buffer_load_dwordx4 v8, s[24:27], s78 offen lds
    s_add_u32 m0, s76, 54272
    s_nop 0
    buffer_load_dwordx4 v17, s[28:31], s79 offen lds
    s_add_u32 m0, s77, 54272
    s_nop 0
    buffer_load_dwordx4 v9, s[24:27], s78 offen lds
    s_add_u32 m0, s76, 55296
    s_nop 0
    buffer_load_dwordx4 v18, s[28:31], s79 offen lds
    s_add_u32 m0, s77, 55296
    s_nop 0
    buffer_load_dwordx4 v10, s[24:27], s78 offen lds
    s_add_u32 m0, s76, 56320
    s_nop 0
    buffer_load_dwordx4 v19, s[28:31], s79 offen lds
    s_add_u32 m0, s77, 56320
    s_nop 0
    buffer_load_dwordx4 v11, s[24:27], s78 offen lds
    s_add_u32 m0, s76, 57344
    s_nop 0
    buffer_load_dwordx4 v20, s[28:31], s79 offen lds
    s_add_u32 m0, s77, 57344
    s_nop 0
    buffer_load_dwordx4 v12, s[24:27], s78 offen lds
    s_add_u32 m0, s77, 58368
    s_nop 0
    buffer_load_dwordx4 v13, s[24:27], s78 offen lds
    s_add_u32 m0, s77, 59392
    s_nop 0
    buffer_load_dwordx4 v14, s[24:27], s78 offen lds
    s_add_u32 m0, s77, 60416
    s_nop 0
    buffer_load_dwordx4 v15, s[24:27], s78 offen lds
    s_add_u32 s78, s78, 128
    s_add_u32 s79, s79, 245760
    v_cmp_ne_u32 vcc, v63, v55
    s_nop 1
    s_cmp_lg_u64 vcc, 0
    s_cbranch_scc1 pslow_89
pdone_90:
    ds_read_b32 v66, v61 offset:0
    ds_read_b32 v67, v61 offset:256
    ds_read_b32 v68, v61 offset:512
    ds_read_b32 v69, v61 offset:768
    ds_read_b32 v70, v61 offset:1024
    s_waitcnt lgkmcnt(0)
    v_add_f32 v66, v66, v67
    v_add_f32 v68, v68, v69
    v_add_f32 v66, v66, v68
    v_cmp_gt_u32 vcc, 64, v56
    s_nop 1
    v_cndmask_b32 v66, v70, v66, vcc
    buffer_store_dword v66, v60, s[36:39], 0 offen sc1
    s_waitcnt vmcnt(14)
    s_barrier
    s_add_u32 m0, s76, 106496
    s_nop 0
    buffer_load_dwordx4 v16, s[28:31], s79 offen lds
    s_add_u32 m0, s77, 106496
    s_nop 0
    buffer_load_dwordx4 v8, s[24:27], s78 offen lds
    s_add_u32 m0, s76, 107520
    s_nop 0
    buffer_load_dwordx4 v17, s[28:31], s79 offen lds
    s_add_u32 m0, s77, 107520
    s_nop 0
    buffer_load_dwordx4 v9, s[24:27], s78 offen lds
    s_add_u32 m0, s76, 108544
    s_nop 0
    buffer_load_dwordx4 v18, s[28:31], s79 offen lds
    s_add_u32 m0, s77, 108544
    s_nop 0
    buffer_load_dwordx4 v10, s[24:27], s78 offen lds
    s_add_u32 m0, s76, 109568
    s_nop 0
    buffer_load_dwordx4 v19, s[28:31], s79 offen lds
    s_add_u32 m0, s77, 109568
    s_nop 0
    buffer_load_dwordx4 v11, s[24:27], s78 offen lds
    s_add_u32 m0, s76, 110592
    s_nop 0
    buffer_load_dwordx4 v20, s[28:31], s79 offen lds
    s_add_u32 m0, s77, 110592
    s_nop 0
    buffer_load_dwordx4 v12, s[24:27], s78 offen lds
    s_add_u32 m0, s77, 111616
    s_nop 0
    buffer_load_dwordx4 v13, s[24:27], s78 offen lds
    s_add_u32 m0, s77, 112640
    s_nop 0
    buffer_load_dwordx4 v14, s[24:27], s78 offen lds
    s_add_u32 m0, s77, 113664
    s_nop 0
    buffer_load_dwordx4 v15, s[24:27], s78 offen lds
    s_add_u32 s78, s78, 128
    s_add_u32 s79, s79, 245760
    s_waitcnt vmcnt(14)
    s_barrier
    s_add_u32 m0, s76, 0
    s_nop 0
    buffer_load_dwordx4 v16, s[28:31], s79 offen lds
    s_add_u32 m0, s77, 0
    s_nop 0
    buffer_load_dwordx4 v8, s[24:27], s78 offen lds
    s_add_u32 m0, s76, 1024
    s_nop 0
    buffer_load_dwordx4 v17, s[28:31], s79 offen lds
    s_add_u32 m0, s77, 1024
    s_nop 0
    buffer_load_dwordx4 v9, s[24:27], s78 offen lds
    s_add_u32 m0, s76, 2048
    s_nop 0
    buffer_load_dwordx4 v18, s[28:31], s79 offen lds
    s_add_u32 m0, s77, 2048
    s_nop 0
    buffer_load_dwordx4 v10, s[24:27], s78 offen lds
    s_add_u32 m0, s76, 3072
    s_nop 0
    buffer_load_dwordx4 v19, s[28:31], s79 offen lds
    s_add_u32 m0, s77, 3072
    s_nop 0
    buffer_load_dwordx4 v11, s[24:27], s78 offen lds
    s_add_u32 m0, s76, 4096
    s_nop 0
    buffer_load_dwordx4 v20, s[28:31], s79 offen lds
    s_add_u32 m0, s77, 4096
    s_nop 0
    buffer_load_dwordx4 v12, s[24:27], s78 offen lds
    s_add_u32 m0, s77, 5120
    s_nop 0
    buffer_load_dwordx4 v13, s[24:27], s78 offen lds
    s_add_u32 m0, s77, 6144
    s_nop 0
    buffer_load_dwordx4 v14, s[24:27], s78 offen lds
    s_add_u32 m0, s77, 7168
    s_nop 0
    buffer_load_dwordx4 v15, s[24:27], s78 offen lds
    s_add_u32 s78, s78, 128
    s_add_u32 s79, s79, 245760
    s_waitcnt vmcnt(13)
    s_barrier
    s_add_u32 m0, s76, 53248
    s_nop 0
    buffer_load_dwordx4 v16, s[28:31], s79 offen lds
    s_add_u32 m0, s77, 53248
    s_nop 0
    buffer_load_dwordx4 v8, s[24:27], s78 offen lds
    s_add_u32 m0, s76, 54272
    s_nop 0
    buffer_load_dwordx4 v17, s[28:31], s79 offen lds
    s_add_u32 m0, s77, 54272
    s_nop 0
    buffer_load_dwordx4 v9, s[24:27], s78 offen lds
    s_add_u32 m0, s76, 55296
    s_nop 0
    buffer_load_dwordx4 v18, s[28:31], s79 offen lds
    s_add_u32 m0, s77, 55296
    s_nop 0
    buffer_load_dwordx4 v10, s[24:27], s78 offen lds
    s_add_u32 m0, s76, 56320
    s_nop 0
    buffer_load_dwordx4 v19, s[28:31], s79 offen lds
    s_add_u32 m0, s77, 56320
    s_nop 0
    buffer_load_dwordx4 v11, s[24:27], s78 offen lds
    s_add_u32 m0, s76, 57344
    s_nop 0
    buffer_load_dwordx4 v20, s[28:31], s79 offen lds
    s_add_u32 m0, s77, 57344
    s_nop 0
    buffer_load_dwordx4 v12, s[24:27], s78 offen lds
    s_add_u32 m0, s77, 58368
    s_nop 0
    buffer_load_dwordx4 v13, s[24:27], s78 offen lds
    s_add_u32 m0, s77, 59392
    s_nop 0
    buffer_load_dwordx4 v14, s[24:27], s78 offen lds
    s_add_u32 m0, s77, 60416
    s_nop 0
    buffer_load_dwordx4 v15, s[24:27], s78 offen lds
    s_add_u32 s78, s78, 128
    s_add_u32 s79, s79, 245760
    s_waitcnt vmcnt(13)
    s_barrier
    s_add_u32 m0, s76, 106496
    s_nop 0
    buffer_load_dwordx4 v16, s[28:31], s79 offen lds
    s_add_u32 m0, s77, 106496
    s_nop 0
    buffer_load_dwordx4 v8, s[24:27], s78 offen lds
    s_add_u32 m0, s76, 107520
    s_nop 0
    buffer_load_dwordx4 v17, s[28:31], s79 offen lds
    s_add_u32 m0, s77, 107520
    s_nop 0
    buffer_load_dwordx4 v9, s[24:27], s78 offen lds
    s_add_u32 m0, s76, 108544
    s_nop 0
    buffer_load_dwordx4 v18, s[28:31], s79 offen lds
    s_add_u32 m0, s77, 108544
    s_nop 0
    buffer_load_dwordx4 v10, s[24:27], s78 offen lds
    s_add_u32 m0, s76, 109568
    s_nop 0
    buffer_load_dwordx4 v19, s[28:31], s79 offen lds
    s_add_u32 m0, s77, 109568
    s_nop 0
    buffer_load_dwordx4 v11, s[24:27], s78 offen lds
    s_add_u32 m0, s76, 110592
    s_nop 0
    buffer_load_dwordx4 v20, s[28:31], s79 offen lds
    s_add_u32 m0, s77, 110592
    s_nop 0
    buffer_load_dwordx4 v12, s[24:27], s78 offen lds
    s_add_u32 m0, s77, 111616
    s_nop 0
    buffer_load_dwordx4 v13, s[24:27], s78 offen lds
    s_add_u32 m0, s77, 112640
    s_nop 0
    buffer_load_dwordx4 v14, s[24:27], s78 offen lds
    s_add_u32 m0, s77, 113664
    s_nop 0
    buffer_load_dwordx4 v15, s[24:27], s78 offen lds
    s_add_u32 s78, s78, 128
    s_add_u32 s79, s79, 245760
    s_waitcnt vmcnt(13)
    s_barrier
    buffer_load_dword v55, v62, s[40:43], 0 offen sc1
    buffer_load_dword v66, v57, s[36:39], 0 offen sc1
    buffer_load_dword v67, v57, s[36:39], s83 offen sc1
    buffer_load_dword v68, v58, s[36:39], 0 offen sc1
    buffer_load_dword v69, v58, s[36:39], s80 offen sc1
    buffer_load_dword v70, v58, s[36:39], s81 offen sc1
    buffer_load_dword v71, v58, s[36:39], s82 offen sc1
    s_add_u32 m0, s76, 0
    s_nop 0
    buffer_load_dwordx4 v16, s[28:31], s79 offen lds
    s_add_u32 m0, s77, 0
    s_nop 0
    buffer_load_dwordx4 v8, s[24:27], s78 offen lds
    s_add_u32 m0, s76, 1024
    s_nop 0
    buffer_load_dwordx4 v17, s[28:31], s79 offen lds
    s_add_u32 m0, s77, 1024
    s_nop 0
    buffer_load_dwordx4 v9, s[24:27], s78 offen lds
    s_add_u32 m0, s76, 2048
    s_nop 0
    buffer_load_dwordx4 v18, s[28:31], s79 offen lds
    s_add_u32 m0, s77, 2048
    s_nop 0
    buffer_load_dwordx4 v10, s[24:27], s78 offen lds
    s_add_u32 m0, s76, 3072
    s_nop 0
    buffer_load_dwordx4 v19, s[28:31], s79 offen lds
    s_add_u32 m0, s77, 3072
    s_nop 0
    buffer_load_dwordx4 v11, s[24:27], s78 offen lds
    s_add_u32 m0, s76, 4096
    s_nop 0
    buffer_load_dwordx4 v20, s[28:31], s79 offen lds
    s_add_u32 m0, s77, 4096
    s_nop 0
    buffer_load_dwordx4 v12, s[24:27], s78 offen lds
    s_add_u32 m0, s77, 5120
    s_nop 0
    buffer_load_dwordx4 v13, s[24:27], s78 offen lds
    s_add_u32 m0, s77, 6144
    s_nop 0
    buffer_load_dwordx4 v14, s[24:27], s78 offen lds
    s_add_u32 m0, s77, 7168
    s_nop 0
    buffer_load_dwordx4 v15, s[24:27], s78 offen lds
    s_add_u32 s78, s78, 128
    s_add_u32 s79, s79, 245760
    s_waitcnt vmcnt(20)
    s_barrier
    s_waitcnt vmcnt(13)
    v_cmp_ne_u32 vcc, v64, v55
    s_nop 1
    s_cmp_lg_u64 vcc, 0
    s_cbranch_scc1 pslow_92
pdone_93:
    s_mov_b32 s85, 200000
    s_branch tabc_95
tab_94:
    buffer_load_dword v66, v57, s[36:39], 0 offen sc1
    buffer_load_dword v67, v57, s[36:39], s83 offen sc1
    buffer_load_dword v68, v58, s[36:39], 0 offen sc1
    buffer_load_dword v69, v58, s[36:39], s80 offen sc1
    buffer_load_dword v70, v58, s[36:39], s81 offen sc1
    buffer_load_dword v71, v58, s[36:39], s82 offen sc1
    s_waitcnt vmcnt(0)
tabc_95:
    v_max_u32 v3, v66, v67
    v_max3_u32 v3, v3, v68, v69
    v_max3_u32 v3, v3, v70, v71
    v_cmp_eq_u32 vcc, -1, v3
    s_nop 1
    s_cmp_eq_u64 vcc, 0
    s_cbranch_scc1 tabd_96
    s_sleep 4
    s_sub_u32 s85, s85, 1
    s_cmp_lg_u32 s85, 0
    s_cbranch_scc1 tab_94
tabd_96:
    v_add_f32 v68, v68, v69
    v_add_f32 v70, v70, v71
    v_add_f32 v68, v68, v70
    v_lshlrev_b32 v3, 2, v56
    v_add_u32 v3, 160896, v3
    ds_write_b32 v3, v66
    ds_write_b32 v3, v67 offset:1024
    v_min_u32 v4, 192, v56
    v_lshlrev_b32 v4, 2, v4
    v_add_u32 v4, 162944, v4
    ds_write_b32 v4, v68
    s_waitcnt lgkmcnt(0)
    s_waitcnt vmcnt(0)
    s_barrier
    v_mov_b32 v12, 0
    v_mov_b32 v13, 0
    v_mov_b32 v14, 0
    v_mov_b32 v15, 0
    ds_write_b128 v115, v[12:15] offset:0
    ds_write_b128 v115, v[12:15] offset:4096
    ds_write_b128 v115, v[12:15] offset:8192
    ds_write_b128 v115, v[12:15] offset:12288
    ds_write_b128 v115, v[12:15] offset:16384
    ds_write_b128 v115, v[12:15] offset:20480
    ds_write_b128 v115, v[12:15] offset:24576
    v_mov_b32 v10, 163744
    v_mov_b32 v11, 1
    s_waitcnt lgkmcnt(0)
    s_mov_b64 exec, 1
    ds_add_u32 v10, v11 offset:8
    s_mov_b64 exec, -1
    ds_read_b32 v11, v10 offset:8
    s_waitcnt lgkmcnt(0)
    v_readfirstlane_b32 s85, v11
    s_nop 0
    s_cmp_lt_u32 s85, 4
    s_cbranch_scc1 lws_98
lwd_99:
    s_mul_i32 s73, s59, 13440
    s_add_u32 s73, s73, 75776
    s_setprio 2
    s_cmp_lg_u32 s56, 7
    s_cbranch_scc1 qo_100
    s_mov_b32 s85, 200000
poll_102:
    buffer_load_dword v16, v114, s[36:39], 0 offen sc1
    s_waitcnt vmcnt(0)
    v_cmp_ne_u32 vcc, 1, v16
    s_nop 1
    s_cmp_eq_u64 vcc, 0
    s_cbranch_scc1 pdone_104
    s_sleep 4
    s_sub_u32 s85, s85, 1
    s_cmp_lg_u32 s85, 0
    s_cbranch_scc1 poll_102
pdone_104:
    v_mov_b32 v11, 1
    ds_write_b32 v10, v11 offset:12
    s_branch qg_101
qo_100:
    ds_read_b32 v11, v10 offset:12
    s_waitcnt lgkmcnt(0)
    v_readfirstlane_b32 s85, v11
    s_nop 0
    s_cmp_lt_u32 s85, 1
    s_cbranch_scc1 lws_106
lwd_107:
qg_101:
    buffer_load_dwordx4 v[52:55], v104, s[36:39], s73 offen sc1
    buffer_load_dwordx4 v[56:59], v105, s[36:39], s73 offen sc1
    buffer_load_dwordx4 v[60:63], v106, s[36:39], s73 offen sc1
    buffer_load_dwordx4 v[64:67], v107, s[36:39], s73 offen sc1
    s_waitcnt vmcnt(3)
    v_cvt_pk_bf16_f32 v52, v52, v53
    v_cvt_pk_bf16_f32 v53, v54, v55
    ds_write_b64 v100, v[52:53] offset:53248
    s_waitcnt vmcnt(2)
    v_cvt_pk_bf16_f32 v56, v56, v57
    v_cvt_pk_bf16_f32 v57, v58, v59
    ds_write_b64 v101, v[56:57] offset:53248
    s_waitcnt vmcnt(1)
    v_cvt_pk_bf16_f32 v60, v60, v61
    v_cvt_pk_bf16_f32 v61, v62, v63
    ds_write_b64 v102, v[60:61] offset:53248
    s_waitcnt vmcnt(0)
    v_cvt_pk_bf16_f32 v64, v64, v65
    v_cvt_pk_bf16_f32 v65, v66, v67
    ds_write_b64 v103, v[64:65] offset:53248
    s_waitcnt lgkmcnt(0)
    s_barrier
    s_endpgm
pslow_89:
    s_mov_b32 s85, 200000
poll_88:
    s_sleep 8
    buffer_load_dword v55, v54, s[40:43], 0 offen sc1
    s_waitcnt vmcnt(0)
    v_cmp_ne_u32 vcc, v63, v55
    s_nop 1
    s_cmp_eq_u64 vcc, 0
    s_cbranch_scc1 pdone_90
    s_sub_u32 s85, s85, 1
    s_cmp_lg_u32 s85, 0
    s_cbranch_scc1 poll_88
    s_branch pdone_90
pslow_92:
    s_mov_b32 s85, 200000
poll_91:
    s_sleep 8
    buffer_load_dword v55, v62, s[40:43], 0 offen sc1
    s_waitcnt vmcnt(0)
    v_cmp_ne_u32 vcc, v64, v55
    s_nop 1
    s_cmp_eq_u64 vcc, 0
    s_cbranch_scc1 pdone_93
    s_sub_u32 s85, s85, 1
    s_cmp_lg_u32 s85, 0
    s_cbranch_scc1 poll_91
    s_branch pdone_93
lws_98:
    s_mov_b32 s84, 1600000
lw_97:
    s_sleep 1
    ds_read_b32 v11, v10 offset:8
    s_waitcnt lgkmcnt(0)
    v_readfirstlane_b32 s85, v11
    s_nop 0
    s_cmp_ge_u32 s85, 4
    s_cbranch_scc1 lwd_99
    s_sub_u32 s84, s84, 1
    s_cmp_lg_u32 s84, 0
    s_cbranch_scc1 lw_97
    s_branch lwd_99
lws_106:
    s_mov_b32 s84, 1600000
lw_105:
    s_sleep 3
    ds_read_b32 v11, v10 offset:12
    s_waitcnt lgkmcnt(0)
    v_readfirstlane_b32 s85, v11
    s_nop 0
    s_cmp_ge_u32 s85, 1
    s_cbranch_scc1 lwd_107
    s_sub_u32 s84, s84, 1
    s_cmp_lg_u32 s84, 0
    s_cbranch_scc1 lw_105
    s_branch lwd_107
L_fin:
L_end:
    s_endpgm
.section .rodata,"a"
.p2align 6
.amdhsa_kernel recurrent_scan__linear_attn_block__dense_activation_silu__prompt_kernel
  .amdhsa_next_free_vgpr 256
  .amdhsa_next_free_sgpr 102
  .amdhsa_accum_offset 256
  .amdhsa_group_segment_fixed_size 0
  .amdhsa_kernarg_size 72
  .amdhsa_user_sgpr_count 2
  .amdhsa_user_sgpr_kernarg_segment_ptr 1
  .amdhsa_system_sgpr_workgroup_id_x 1
.end_amdhsa_kernel
```
